```python
import torch

def _softmax(x, axis=-1):
    return torch.softmax(x, dim=axis)
def _gelu(x):
    return torch.nn.functional.gelu(x, approximate="tanh")
def _silu(x):
    return torch.nn.functional.silu(x)
def _sigmoid(x):
    return torch.sigmoid(x)
def _layernorm(x, axis=-1, eps=1e-5):
    m = x.mean(dim=axis, keepdim=True)
    v = x.var(dim=axis, keepdim=True, unbiased=False)
    return (x - m) / torch.sqrt(v + eps)
def _scatter_add(tgt, idx, src, axis=0):
    return tgt.clone().index_add_(axis, idx, src)
def _segment_sum(src, seg, n):
    out = torch.zeros((n,) + src.shape[1:], dtype=src.dtype)
    return out.index_add_(0, seg, src)
def _pad(x, pw):
    flat = tuple(v for pair in reversed(pw) for v in pair)
    return torch.nn.functional.pad(x, flat)

kernel_name = 'standalone__gqa_block_cached__near_ridge'

def setup_inputs():

    _w = (lambda a: (lambda t: t.to(torch.bfloat16) if t.is_floating_point() else t)(torch.as_tensor(a)))
    B, Sq, D = 16, 80, 512
    Hq, Hkv, Sk, Dh = 32, 8, 1024, 128
    assert Hq % Hkv == 0, (Hq, Hkv)
    return {
        "x": _w((lambda *s: torch.randn(*s, dtype=torch.bfloat16) * 0.8)(B, Sq, D)),
        "k_cache": _w((lambda *s: torch.randn(*s, dtype=torch.bfloat16) * 0.8)(B, Hkv, Sk, Dh)),
        "v_cache": _w((lambda *s: torch.randn(*s, dtype=torch.bfloat16) * 0.05)(B, Hkv, Sk, Dh)),
        "wq": _w((lambda *s: torch.randn(*s, dtype=torch.bfloat16) * 0.8)(D, Hq * Dh) * (D ** -0.5)),
        "wo": _w((lambda *s: torch.randn(*s, dtype=torch.bfloat16) * 0.05)(Hq * Dh, D) * ((Hq * Dh) ** -0.5)),
    }

def reference(x, k_cache, v_cache, wq, wo):
    B, Sq, D = x.shape
    Hq, Dh = 32, 128
    Hkv = k_cache.shape[1]
    rep = Hq // Hkv
    q = (lambda x, *d: x.permute(*d))((x @ wq).reshape(B, Sq, Hq, Dh), 0, 2, 1, 3)
    k = (lambda x, n, axis: torch.repeat_interleave(x, n, dim=axis))(k_cache, rep, axis=1)
    v = (lambda x, n, axis: torch.repeat_interleave(x, n, dim=axis))(v_cache, rep, axis=1)
    scores = torch.einsum("bhqd,bhkd->bhqk", q, k) * (Dh ** -0.5)
    p = _softmax(scores, axis=-1)
    o = torch.einsum("bhqk,bhkd->bhqd", p, v)
    return (lambda x, *d: x.permute(*d))(o, 0, 2, 1, 3).reshape(B, Sq, Hq * Dh) @ wo
```

```asm
; @launch kernel=gqa_attn_kernel grid=(256,1,1) block=(512,1,1) lds=163840
; @launch kernel=gqa_oproj_kernel grid=(256,1,1) block=(256,1,1) lds=49152
.amdgcn_target "amdgcn-amd-amdhsa--gfx950"
.text
.globl gqa_attn_kernel
.p2align 8
.type gqa_attn_kernel,@function
gqa_attn_kernel:
    s_cmp_ge_u32 s2, 256
    s_cbranch_scc1 A_end
    s_load_dwordx16 s[32:47], s[0:1], 0
    v_lshrrev_b32 v213, 6, v0
    v_and_b32 v1, 63, v0
    s_nop 0
    v_readfirstlane_b32 s3, v213
    s_lshr_b32 s28, s2, 4
    s_and_b32 s29, s2, 7
    s_lshr_b32 s30, s2, 3
    s_and_b32 s30, s30, 1
    s_lshl_b32 s31, s29, 2
    s_lshl_b32 s4, s30, 1
    s_add_u32 s31, s31, s4
    s_mov_b32 s48, 0x3e0293ee
    s_mov_b32 s49, 0x427af233
    s_mov_b32 s55, 0xbe0293ee
    s_mov_b32 s50, 0
    s_lshl_b32 s53, s28, 3
    s_add_u32 s53, s53, s29
    s_lshl_b32 s53, s53, 18
    s_waitcnt lgkmcnt(0)
    s_mov_b32 s8, s32
    s_and_b32 s9, s33, 0xffff
    s_mov_b32 s10, 1310720
    s_mov_b32 s11, 0x20000
    s_mov_b32 s12, s34
    s_and_b32 s13, s35, 0xffff
    s_mov_b32 s14, 33554432
    s_mov_b32 s15, 0x20000
    s_mov_b32 s16, s36
    s_and_b32 s17, s37, 0xffff
    s_mov_b32 s18, 33554432
    s_mov_b32 s19, 0x20000
    s_mov_b32 s20, s38
    s_and_b32 s21, s39, 0xffff
    s_mov_b32 s22, 4194304
    s_mov_b32 s23, 0x20000
    s_mov_b32 s24, s46
    s_and_b32 s25, s47, 0xffff
    s_mov_b32 s26, 12582912
    s_mov_b32 s27, 0x20000
    v_lshrrev_b32 v213, 4, v1
    v_and_b32 v214, 15, v1
    v_lshrrev_b32 v215, 5, v1
    v_and_b32 v216, 31, v1
    s_and_b32 s4, s3, 3
    s_lshl_b32 s4, s4, 2
    v_add_u32 v217, s4, v213
    v_xor_b32 v217, v217, v214
    v_lshlrev_b32 v217, 4, v217
    v_lshl_add_u32 v221, v213, 8, v217
    v_lshlrev_b32 v217, 2, v213
    v_xor_b32 v217, v217, v214
    v_lshlrev_b32 v217, 4, v217
    v_lshl_add_u32 v222, v213, 8, v217
    s_and_b32 s56, s3, 3
    s_cmp_lt_u32 s3, 4
    s_cbranch_scc1 A_nopre
    s_mov_b32 s52, s53
    s_lshl_b32 s4, s56, 10
    s_add_u32 s5, s4, 0
    s_mov_b32 m0, s5
    s_add_u32 s5, s4, s52
    s_add_u32 s5, s5, 0
    buffer_load_dwordx4 v221, s[12:15], s5 offen lds
    s_add_u32 s6, s4, 65536
    s_mov_b32 m0, s6
    s_nop 0
    buffer_load_dwordx4 v222, s[16:19], s5 offen lds
    s_lshl_b32 s4, s56, 10
    s_add_u32 s5, s4, 4096
    s_mov_b32 m0, s5
    s_add_u32 s5, s4, s52
    s_add_u32 s5, s5, 4096
    buffer_load_dwordx4 v221, s[12:15], s5 offen lds
    s_add_u32 s6, s4, 69632
    s_mov_b32 m0, s6
    s_nop 0
    buffer_load_dwordx4 v222, s[16:19], s5 offen lds
    s_lshl_b32 s4, s56, 10
    s_add_u32 s5, s4, 8192
    s_mov_b32 m0, s5
    s_add_u32 s5, s4, s52
    s_add_u32 s5, s5, 8192
    buffer_load_dwordx4 v221, s[12:15], s5 offen lds
    s_add_u32 s6, s4, 73728
    s_mov_b32 m0, s6
    s_nop 0
    buffer_load_dwordx4 v222, s[16:19], s5 offen lds
    s_lshl_b32 s4, s56, 10
    s_add_u32 s5, s4, 12288
    s_mov_b32 m0, s5
    s_add_u32 s5, s4, s52
    s_add_u32 s5, s5, 12288
    buffer_load_dwordx4 v221, s[12:15], s5 offen lds
    s_add_u32 s6, s4, 77824
    s_mov_b32 m0, s6
    s_nop 0
    buffer_load_dwordx4 v222, s[16:19], s5 offen lds
    s_add_u32 s52, s53, 16384
    s_lshl_b32 s4, s56, 10
    s_add_u32 s5, s4, 16384
    s_mov_b32 m0, s5
    s_add_u32 s5, s4, s52
    s_add_u32 s5, s5, 0
    buffer_load_dwordx4 v221, s[12:15], s5 offen lds
    s_add_u32 s6, s4, 81920
    s_mov_b32 m0, s6
    s_nop 0
    buffer_load_dwordx4 v222, s[16:19], s5 offen lds
    s_lshl_b32 s4, s56, 10
    s_add_u32 s5, s4, 20480
    s_mov_b32 m0, s5
    s_add_u32 s5, s4, s52
    s_add_u32 s5, s5, 4096
    buffer_load_dwordx4 v221, s[12:15], s5 offen lds
    s_add_u32 s6, s4, 86016
    s_mov_b32 m0, s6
    s_nop 0
    buffer_load_dwordx4 v222, s[16:19], s5 offen lds
    s_lshl_b32 s4, s56, 10
    s_add_u32 s5, s4, 24576
    s_mov_b32 m0, s5
    s_add_u32 s5, s4, s52
    s_add_u32 s5, s5, 8192
    buffer_load_dwordx4 v221, s[12:15], s5 offen lds
    s_add_u32 s6, s4, 90112
    s_mov_b32 m0, s6
    s_nop 0
    buffer_load_dwordx4 v222, s[16:19], s5 offen lds
    s_lshl_b32 s4, s56, 10
    s_add_u32 s5, s4, 28672
    s_mov_b32 m0, s5
    s_add_u32 s5, s4, s52
    s_add_u32 s5, s5, 12288
    buffer_load_dwordx4 v221, s[12:15], s5 offen lds
    s_add_u32 s6, s4, 94208
    s_mov_b32 m0, s6
    s_nop 0
    buffer_load_dwordx4 v222, s[16:19], s5 offen lds
A_nopre:
    s_and_b32 s4, s3, 1
    s_lshl_b32 s4, s4, 1
    v_add_u32 v217, s4, v215
    v_lshlrev_b32 v217, 2, v217
    v_xor_b32 v217, v217, v216
    v_lshlrev_b32 v217, 4, v217
    v_lshl_add_u32 v229, v215, 13, v217
    s_and_b32 s4, s3, 1
    s_lshl_b32 s4, s4, 2
    v_add_u32 v217, s4, v213
    v_and_b32 v218, 7, v1
    v_xor_b32 v217, v217, v218
    v_lshlrev_b32 v217, 4, v217
    v_lshrrev_b32 v218, 3, v1
    v_lshl_add_u32 v230, v218, 10, v217
    v_lshrrev_b32 v217, 2, v214
    v_lshl_add_u32 v218, v215, 3, v217
    v_lshlrev_b32 v218, 9, v218
    v_lshlrev_b32 v217, 2, v217
    v_and_b32 v219, 1, v213
    v_lshlrev_b32 v219, 1, v219
    v_bfe_u32 v220, v1, 1, 1
    v_add_u32 v219, v219, v220
    s_lshl_b32 s4, s3, 2
    v_add_u32 v219, s4, v219
    v_xor_b32 v219, v219, v217
    v_lshl_add_u32 v218, v219, 4, v218
    v_and_b32 v219, 1, v1
    v_lshl_add_u32 v218, v219, 3, v218
    v_add_u32 v223, 32768, v218
    v_add_u32 v224, 98304, v218
    v_bfe_u32 v217, v216, 1, 3
    v_add_u32 v218, 0, v215
    v_xor_b32 v217, v217, v218
    v_lshlrev_b32 v217, 4, v217
    v_lshl_add_u32 v225, v216, 7, v217
    v_add_u32 v225, 131072, v225
    v_bfe_u32 v217, v216, 1, 3
    v_add_u32 v218, 2, v215
    v_xor_b32 v217, v217, v218
    v_lshlrev_b32 v217, 4, v217
    v_lshl_add_u32 v226, v216, 7, v217
    v_add_u32 v226, 131072, v226
    v_bfe_u32 v217, v216, 1, 3
    v_add_u32 v218, 4, v215
    v_xor_b32 v217, v217, v218
    v_lshlrev_b32 v217, 4, v217
    v_lshl_add_u32 v227, v216, 7, v217
    v_add_u32 v227, 131072, v227
    v_bfe_u32 v217, v216, 1, 3
    v_add_u32 v218, 6, v215
    v_xor_b32 v217, v217, v218
    v_lshlrev_b32 v217, 4, v217
    v_lshl_add_u32 v228, v216, 7, v217
    v_add_u32 v228, 131072, v228
    s_lshl_b32 s4, s3, 14
    s_lshl_b32 s5, s31, 8
    s_add_u32 s4, s4, s5
    s_lshl_b32 s6, s3, 10
    s_add_u32 s5, s6, 32768
    s_mov_b32 m0, s5
    s_add_u32 s5, s4, 0
    buffer_load_dwordx4 v229, s[20:23], s5 offen lds
    s_add_u32 s5, s6, 40960
    s_mov_b32 m0, s5
    s_add_u32 s5, s4, 131072
    buffer_load_dwordx4 v229, s[20:23], s5 offen lds
    s_add_u32 s5, s6, 49152
    s_mov_b32 m0, s5
    s_add_u32 s5, s4, 262144
    buffer_load_dwordx4 v229, s[20:23], s5 offen lds
    s_add_u32 s5, s6, 57344
    s_mov_b32 m0, s5
    s_add_u32 s5, s4, 393216
    buffer_load_dwordx4 v229, s[20:23], s5 offen lds
    s_mul_i32 s4, s28, 81920
    s_lshl_b32 s5, s3, 13
    s_add_u32 s4, s4, s5
    s_add_u32 s4, s4, 0
    s_add_u32 s5, s6, 131072
    s_mov_b32 m0, s5
    s_nop 0
    buffer_load_dwordx4 v230, s[8:11], s4 offen lds
    s_cmp_ge_u32 s3, 4
    s_cbranch_scc1 A_qx0
    s_add_u32 s4, s4, 65536
    s_add_u32 s5, s5, 8192
    s_mov_b32 m0, s5
    s_nop 0
    buffer_load_dwordx4 v230, s[8:11], s4 offen lds
A_qx0:
    s_lshl_b32 s4, s3, 14
    s_lshl_b32 s5, s31, 8
    s_add_u32 s4, s4, s5
    s_lshl_b32 s6, s3, 10
    s_add_u32 s5, s6, 98304
    s_mov_b32 m0, s5
    s_add_u32 s5, s4, 524288
    buffer_load_dwordx4 v229, s[20:23], s5 offen lds
    s_add_u32 s5, s6, 106496
    s_mov_b32 m0, s5
    s_add_u32 s5, s4, 655360
    buffer_load_dwordx4 v229, s[20:23], s5 offen lds
    s_add_u32 s5, s6, 114688
    s_mov_b32 m0, s5
    s_add_u32 s5, s4, 786432
    buffer_load_dwordx4 v229, s[20:23], s5 offen lds
    s_add_u32 s5, s6, 122880
    s_mov_b32 m0, s5
    s_add_u32 s5, s4, 917504
    buffer_load_dwordx4 v229, s[20:23], s5 offen lds
    s_mul_i32 s4, s28, 81920
    s_lshl_b32 s5, s3, 13
    s_add_u32 s4, s4, s5
    s_add_u32 s4, s4, 128
    s_add_u32 s5, s6, 143360
    s_mov_b32 m0, s5
    s_nop 0
    buffer_load_dwordx4 v230, s[8:11], s4 offen lds
    s_cmp_ge_u32 s3, 4
    s_cbranch_scc1 A_qx1
    s_add_u32 s4, s4, 65536
    s_add_u32 s5, s5, 8192
    s_mov_b32 m0, s5
    s_nop 0
    buffer_load_dwordx4 v230, s[8:11], s4 offen lds
A_qx1:
    s_waitcnt vmcnt(5)
    s_barrier
    ds_read_b64_tr_b16 v[164:165], v223 offset:0
    ds_read_b64_tr_b16 v[166:167], v223 offset:2048
    ds_read_b128 v[180:183], v225 offset:0
    ds_read_b128 v[184:187], v225 offset:4096
    ds_read_b128 v[188:191], v225 offset:8192
    s_waitcnt lgkmcnt(2)
    v_mfma_f32_32x32x16_bf16 v[100:115], v[164:167], v[180:183], 0
    s_waitcnt lgkmcnt(1)
    v_mfma_f32_32x32x16_bf16 v[116:131], v[164:167], v[184:187], 0
    s_waitcnt lgkmcnt(0)
    v_mfma_f32_32x32x16_bf16 v[132:147], v[164:167], v[188:191], 0
    ds_read_b64_tr_b16 v[168:169], v223 offset:8192
    ds_read_b64_tr_b16 v[170:171], v223 offset:10240
    ds_read_b128 v[180:183], v226 offset:0
    ds_read_b128 v[184:187], v226 offset:4096
    ds_read_b128 v[188:191], v226 offset:8192
    s_waitcnt lgkmcnt(2)
    v_mfma_f32_32x32x16_bf16 v[100:115], v[168:171], v[180:183], v[100:115]
    s_waitcnt lgkmcnt(1)
    v_mfma_f32_32x32x16_bf16 v[116:131], v[168:171], v[184:187], v[116:131]
    s_waitcnt lgkmcnt(0)
    v_mfma_f32_32x32x16_bf16 v[132:147], v[168:171], v[188:191], v[132:147]
    ds_read_b64_tr_b16 v[164:165], v223 offset:16384
    ds_read_b64_tr_b16 v[166:167], v223 offset:18432
    ds_read_b128 v[180:183], v227 offset:0
    ds_read_b128 v[184:187], v227 offset:4096
    ds_read_b128 v[188:191], v227 offset:8192
    s_waitcnt lgkmcnt(2)
    v_mfma_f32_32x32x16_bf16 v[100:115], v[164:167], v[180:183], v[100:115]
    s_waitcnt lgkmcnt(1)
    v_mfma_f32_32x32x16_bf16 v[116:131], v[164:167], v[184:187], v[116:131]
    s_waitcnt lgkmcnt(0)
    v_mfma_f32_32x32x16_bf16 v[132:147], v[164:167], v[188:191], v[132:147]
    ds_read_b64_tr_b16 v[168:169], v223 offset:24576
    ds_read_b64_tr_b16 v[170:171], v223 offset:26624
    ds_read_b128 v[180:183], v228 offset:0
    ds_read_b128 v[184:187], v228 offset:4096
    ds_read_b128 v[188:191], v228 offset:8192
    s_waitcnt lgkmcnt(2)
    v_mfma_f32_32x32x16_bf16 v[100:115], v[168:171], v[180:183], v[100:115]
    s_waitcnt lgkmcnt(1)
    v_mfma_f32_32x32x16_bf16 v[116:131], v[168:171], v[184:187], v[116:131]
    s_waitcnt lgkmcnt(0)
    v_mfma_f32_32x32x16_bf16 v[132:147], v[168:171], v[188:191], v[132:147]
    s_waitcnt lgkmcnt(0)
    s_barrier
    s_lshl_b32 s4, s3, 14
    s_lshl_b32 s5, s31, 8
    s_add_u32 s4, s4, s5
    s_lshl_b32 s6, s3, 10
    s_add_u32 s5, s6, 32768
    s_mov_b32 m0, s5
    s_add_u32 s5, s4, 1048576
    buffer_load_dwordx4 v229, s[20:23], s5 offen lds
    s_add_u32 s5, s6, 40960
    s_mov_b32 m0, s5
    s_add_u32 s5, s4, 1179648
    buffer_load_dwordx4 v229, s[20:23], s5 offen lds
    s_add_u32 s5, s6, 49152
    s_mov_b32 m0, s5
    s_add_u32 s5, s4, 1310720
    buffer_load_dwordx4 v229, s[20:23], s5 offen lds
    s_add_u32 s5, s6, 57344
    s_mov_b32 m0, s5
    s_add_u32 s5, s4, 1441792
    buffer_load_dwordx4 v229, s[20:23], s5 offen lds
    s_mul_i32 s4, s28, 81920
    s_lshl_b32 s5, s3, 13
    s_add_u32 s4, s4, s5
    s_add_u32 s4, s4, 256
    s_add_u32 s5, s6, 131072
    s_mov_b32 m0, s5
    s_nop 0
    buffer_load_dwordx4 v230, s[8:11], s4 offen lds
    s_cmp_ge_u32 s3, 4
    s_cbranch_scc1 A_qx2
    s_add_u32 s4, s4, 65536
    s_add_u32 s5, s5, 8192
    s_mov_b32 m0, s5
    s_nop 0
    buffer_load_dwordx4 v230, s[8:11], s4 offen lds
A_qx2:
    s_waitcnt vmcnt(5)
    s_barrier
    ds_read_b64_tr_b16 v[164:165], v224 offset:0
    ds_read_b64_tr_b16 v[166:167], v224 offset:2048
    ds_read_b128 v[180:183], v225 offset:12288
    ds_read_b128 v[184:187], v225 offset:16384
    ds_read_b128 v[188:191], v225 offset:20480
    s_waitcnt lgkmcnt(2)
    v_mfma_f32_32x32x16_bf16 v[100:115], v[164:167], v[180:183], v[100:115]
    s_waitcnt lgkmcnt(1)
    v_mfma_f32_32x32x16_bf16 v[116:131], v[164:167], v[184:187], v[116:131]
    s_waitcnt lgkmcnt(0)
    v_mfma_f32_32x32x16_bf16 v[132:147], v[164:167], v[188:191], v[132:147]
    ds_read_b64_tr_b16 v[168:169], v224 offset:8192
    ds_read_b64_tr_b16 v[170:171], v224 offset:10240
    ds_read_b128 v[180:183], v226 offset:12288
    ds_read_b128 v[184:187], v226 offset:16384
    ds_read_b128 v[188:191], v226 offset:20480
    s_waitcnt lgkmcnt(2)
    v_mfma_f32_32x32x16_bf16 v[100:115], v[168:171], v[180:183], v[100:115]
    s_waitcnt lgkmcnt(1)
    v_mfma_f32_32x32x16_bf16 v[116:131], v[168:171], v[184:187], v[116:131]
    s_waitcnt lgkmcnt(0)
    v_mfma_f32_32x32x16_bf16 v[132:147], v[168:171], v[188:191], v[132:147]
    ds_read_b64_tr_b16 v[164:165], v224 offset:16384
    ds_read_b64_tr_b16 v[166:167], v224 offset:18432
    ds_read_b128 v[180:183], v227 offset:12288
    ds_read_b128 v[184:187], v227 offset:16384
    ds_read_b128 v[188:191], v227 offset:20480
    s_waitcnt lgkmcnt(2)
    v_mfma_f32_32x32x16_bf16 v[100:115], v[164:167], v[180:183], v[100:115]
    s_waitcnt lgkmcnt(1)
    v_mfma_f32_32x32x16_bf16 v[116:131], v[164:167], v[184:187], v[116:131]
    s_waitcnt lgkmcnt(0)
    v_mfma_f32_32x32x16_bf16 v[132:147], v[164:167], v[188:191], v[132:147]
    ds_read_b64_tr_b16 v[168:169], v224 offset:24576
    ds_read_b64_tr_b16 v[170:171], v224 offset:26624
    ds_read_b128 v[180:183], v228 offset:12288
    ds_read_b128 v[184:187], v228 offset:16384
    ds_read_b128 v[188:191], v228 offset:20480
    s_waitcnt lgkmcnt(2)
    v_mfma_f32_32x32x16_bf16 v[100:115], v[168:171], v[180:183], v[100:115]
    s_waitcnt lgkmcnt(1)
    v_mfma_f32_32x32x16_bf16 v[116:131], v[168:171], v[184:187], v[116:131]
    s_waitcnt lgkmcnt(0)
    v_mfma_f32_32x32x16_bf16 v[132:147], v[168:171], v[188:191], v[132:147]
    s_waitcnt lgkmcnt(0)
    s_barrier
    s_lshl_b32 s4, s3, 14
    s_lshl_b32 s5, s31, 8
    s_add_u32 s4, s4, s5
    s_lshl_b32 s6, s3, 10
    s_add_u32 s5, s6, 98304
    s_mov_b32 m0, s5
    s_add_u32 s5, s4, 1572864
    buffer_load_dwordx4 v229, s[20:23], s5 offen lds
    s_add_u32 s5, s6, 106496
    s_mov_b32 m0, s5
    s_add_u32 s5, s4, 1703936
    buffer_load_dwordx4 v229, s[20:23], s5 offen lds
    s_add_u32 s5, s6, 114688
    s_mov_b32 m0, s5
    s_add_u32 s5, s4, 1835008
    buffer_load_dwordx4 v229, s[20:23], s5 offen lds
    s_add_u32 s5, s6, 122880
    s_mov_b32 m0, s5
    s_add_u32 s5, s4, 1966080
    buffer_load_dwordx4 v229, s[20:23], s5 offen lds
    s_mul_i32 s4, s28, 81920
    s_lshl_b32 s5, s3, 13
    s_add_u32 s4, s4, s5
    s_add_u32 s4, s4, 384
    s_add_u32 s5, s6, 143360
    s_mov_b32 m0, s5
    s_nop 0
    buffer_load_dwordx4 v230, s[8:11], s4 offen lds
    s_cmp_ge_u32 s3, 4
    s_cbranch_scc1 A_qx3
    s_add_u32 s4, s4, 65536
    s_add_u32 s5, s5, 8192
    s_mov_b32 m0, s5
    s_nop 0
    buffer_load_dwordx4 v230, s[8:11], s4 offen lds
A_qx3:
    s_waitcnt vmcnt(5)
    s_barrier
    ds_read_b64_tr_b16 v[164:165], v223 offset:0
    ds_read_b64_tr_b16 v[166:167], v223 offset:2048
    ds_read_b128 v[180:183], v225 offset:0
    ds_read_b128 v[184:187], v225 offset:4096
    ds_read_b128 v[188:191], v225 offset:8192
    s_waitcnt lgkmcnt(2)
    v_mfma_f32_32x32x16_bf16 v[100:115], v[164:167], v[180:183], v[100:115]
    s_waitcnt lgkmcnt(1)
    v_mfma_f32_32x32x16_bf16 v[116:131], v[164:167], v[184:187], v[116:131]
    s_waitcnt lgkmcnt(0)
    v_mfma_f32_32x32x16_bf16 v[132:147], v[164:167], v[188:191], v[132:147]
    ds_read_b64_tr_b16 v[168:169], v223 offset:8192
    ds_read_b64_tr_b16 v[170:171], v223 offset:10240
    ds_read_b128 v[180:183], v226 offset:0
    ds_read_b128 v[184:187], v226 offset:4096
    ds_read_b128 v[188:191], v226 offset:8192
    s_waitcnt lgkmcnt(2)
    v_mfma_f32_32x32x16_bf16 v[100:115], v[168:171], v[180:183], v[100:115]
    s_waitcnt lgkmcnt(1)
    v_mfma_f32_32x32x16_bf16 v[116:131], v[168:171], v[184:187], v[116:131]
    s_waitcnt lgkmcnt(0)
    v_mfma_f32_32x32x16_bf16 v[132:147], v[168:171], v[188:191], v[132:147]
    ds_read_b64_tr_b16 v[164:165], v223 offset:16384
    ds_read_b64_tr_b16 v[166:167], v223 offset:18432
    ds_read_b128 v[180:183], v227 offset:0
    ds_read_b128 v[184:187], v227 offset:4096
    ds_read_b128 v[188:191], v227 offset:8192
    s_waitcnt lgkmcnt(2)
    v_mfma_f32_32x32x16_bf16 v[100:115], v[164:167], v[180:183], v[100:115]
    s_waitcnt lgkmcnt(1)
    v_mfma_f32_32x32x16_bf16 v[116:131], v[164:167], v[184:187], v[116:131]
    s_waitcnt lgkmcnt(0)
    v_mfma_f32_32x32x16_bf16 v[132:147], v[164:167], v[188:191], v[132:147]
    ds_read_b64_tr_b16 v[168:169], v223 offset:24576
    ds_read_b64_tr_b16 v[170:171], v223 offset:26624
    ds_read_b128 v[180:183], v228 offset:0
    ds_read_b128 v[184:187], v228 offset:4096
    ds_read_b128 v[188:191], v228 offset:8192
    s_waitcnt lgkmcnt(2)
    v_mfma_f32_32x32x16_bf16 v[100:115], v[168:171], v[180:183], v[100:115]
    s_waitcnt lgkmcnt(1)
    v_mfma_f32_32x32x16_bf16 v[116:131], v[168:171], v[184:187], v[116:131]
    s_waitcnt lgkmcnt(0)
    v_mfma_f32_32x32x16_bf16 v[132:147], v[168:171], v[188:191], v[132:147]
    s_waitcnt lgkmcnt(0)
    s_barrier
    s_lshl_b32 s4, s3, 14
    s_lshl_b32 s5, s31, 8
    s_add_u32 s4, s4, s5
    s_lshl_b32 s6, s3, 10
    s_add_u32 s5, s6, 32768
    s_mov_b32 m0, s5
    s_add_u32 s5, s4, 2097152
    buffer_load_dwordx4 v229, s[20:23], s5 offen lds
    s_add_u32 s5, s6, 40960
    s_mov_b32 m0, s5
    s_add_u32 s5, s4, 2228224
    buffer_load_dwordx4 v229, s[20:23], s5 offen lds
    s_add_u32 s5, s6, 49152
    s_mov_b32 m0, s5
    s_add_u32 s5, s4, 2359296
    buffer_load_dwordx4 v229, s[20:23], s5 offen lds
    s_add_u32 s5, s6, 57344
    s_mov_b32 m0, s5
    s_add_u32 s5, s4, 2490368
    buffer_load_dwordx4 v229, s[20:23], s5 offen lds
    s_mul_i32 s4, s28, 81920
    s_lshl_b32 s5, s3, 13
    s_add_u32 s4, s4, s5
    s_add_u32 s4, s4, 512
    s_add_u32 s5, s6, 131072
    s_mov_b32 m0, s5
    s_nop 0
    buffer_load_dwordx4 v230, s[8:11], s4 offen lds
    s_cmp_ge_u32 s3, 4
    s_cbranch_scc1 A_qx4
    s_add_u32 s4, s4, 65536
    s_add_u32 s5, s5, 8192
    s_mov_b32 m0, s5
    s_nop 0
    buffer_load_dwordx4 v230, s[8:11], s4 offen lds
A_qx4:
    s_waitcnt vmcnt(5)
    s_barrier
    ds_read_b64_tr_b16 v[164:165], v224 offset:0
    ds_read_b64_tr_b16 v[166:167], v224 offset:2048
    ds_read_b128 v[180:183], v225 offset:12288
    ds_read_b128 v[184:187], v225 offset:16384
    ds_read_b128 v[188:191], v225 offset:20480
    s_waitcnt lgkmcnt(2)
    v_mfma_f32_32x32x16_bf16 v[100:115], v[164:167], v[180:183], v[100:115]
    s_waitcnt lgkmcnt(1)
    v_mfma_f32_32x32x16_bf16 v[116:131], v[164:167], v[184:187], v[116:131]
    s_waitcnt lgkmcnt(0)
    v_mfma_f32_32x32x16_bf16 v[132:147], v[164:167], v[188:191], v[132:147]
    ds_read_b64_tr_b16 v[168:169], v224 offset:8192
    ds_read_b64_tr_b16 v[170:171], v224 offset:10240
    ds_read_b128 v[180:183], v226 offset:12288
    ds_read_b128 v[184:187], v226 offset:16384
    ds_read_b128 v[188:191], v226 offset:20480
    s_waitcnt lgkmcnt(2)
    v_mfma_f32_32x32x16_bf16 v[100:115], v[168:171], v[180:183], v[100:115]
    s_waitcnt lgkmcnt(1)
    v_mfma_f32_32x32x16_bf16 v[116:131], v[168:171], v[184:187], v[116:131]
    s_waitcnt lgkmcnt(0)
    v_mfma_f32_32x32x16_bf16 v[132:147], v[168:171], v[188:191], v[132:147]
    ds_read_b64_tr_b16 v[164:165], v224 offset:16384
    ds_read_b64_tr_b16 v[166:167], v224 offset:18432
    ds_read_b128 v[180:183], v227 offset:12288
    ds_read_b128 v[184:187], v227 offset:16384
    ds_read_b128 v[188:191], v227 offset:20480
    s_waitcnt lgkmcnt(2)
    v_mfma_f32_32x32x16_bf16 v[100:115], v[164:167], v[180:183], v[100:115]
    s_waitcnt lgkmcnt(1)
    v_mfma_f32_32x32x16_bf16 v[116:131], v[164:167], v[184:187], v[116:131]
    s_waitcnt lgkmcnt(0)
    v_mfma_f32_32x32x16_bf16 v[132:147], v[164:167], v[188:191], v[132:147]
    ds_read_b64_tr_b16 v[168:169], v224 offset:24576
    ds_read_b64_tr_b16 v[170:171], v224 offset:26624
    ds_read_b128 v[180:183], v228 offset:12288
    ds_read_b128 v[184:187], v228 offset:16384
    ds_read_b128 v[188:191], v228 offset:20480
    s_waitcnt lgkmcnt(2)
    v_mfma_f32_32x32x16_bf16 v[100:115], v[168:171], v[180:183], v[100:115]
    s_waitcnt lgkmcnt(1)
    v_mfma_f32_32x32x16_bf16 v[116:131], v[168:171], v[184:187], v[116:131]
    s_waitcnt lgkmcnt(0)
    v_mfma_f32_32x32x16_bf16 v[132:147], v[168:171], v[188:191], v[132:147]
    s_waitcnt lgkmcnt(0)
    s_barrier
    s_lshl_b32 s4, s3, 14
    s_lshl_b32 s5, s31, 8
    s_add_u32 s4, s4, s5
    s_lshl_b32 s6, s3, 10
    s_add_u32 s5, s6, 98304
    s_mov_b32 m0, s5
    s_add_u32 s5, s4, 2621440
    buffer_load_dwordx4 v229, s[20:23], s5 offen lds
    s_add_u32 s5, s6, 106496
    s_mov_b32 m0, s5
    s_add_u32 s5, s4, 2752512
    buffer_load_dwordx4 v229, s[20:23], s5 offen lds
    s_add_u32 s5, s6, 114688
    s_mov_b32 m0, s5
    s_add_u32 s5, s4, 2883584
    buffer_load_dwordx4 v229, s[20:23], s5 offen lds
    s_add_u32 s5, s6, 122880
    s_mov_b32 m0, s5
    s_add_u32 s5, s4, 3014656
    buffer_load_dwordx4 v229, s[20:23], s5 offen lds
    s_mul_i32 s4, s28, 81920
    s_lshl_b32 s5, s3, 13
    s_add_u32 s4, s4, s5
    s_add_u32 s4, s4, 640
    s_add_u32 s5, s6, 143360
    s_mov_b32 m0, s5
    s_nop 0
    buffer_load_dwordx4 v230, s[8:11], s4 offen lds
    s_cmp_ge_u32 s3, 4
    s_cbranch_scc1 A_qx5
    s_add_u32 s4, s4, 65536
    s_add_u32 s5, s5, 8192
    s_mov_b32 m0, s5
    s_nop 0
    buffer_load_dwordx4 v230, s[8:11], s4 offen lds
A_qx5:
    s_waitcnt vmcnt(5)
    s_barrier
    ds_read_b64_tr_b16 v[164:165], v223 offset:0
    ds_read_b64_tr_b16 v[166:167], v223 offset:2048
    ds_read_b128 v[180:183], v225 offset:0
    ds_read_b128 v[184:187], v225 offset:4096
    ds_read_b128 v[188:191], v225 offset:8192
    s_waitcnt lgkmcnt(2)
    v_mfma_f32_32x32x16_bf16 v[100:115], v[164:167], v[180:183], v[100:115]
    s_waitcnt lgkmcnt(1)
    v_mfma_f32_32x32x16_bf16 v[116:131], v[164:167], v[184:187], v[116:131]
    s_waitcnt lgkmcnt(0)
    v_mfma_f32_32x32x16_bf16 v[132:147], v[164:167], v[188:191], v[132:147]
    ds_read_b64_tr_b16 v[168:169], v223 offset:8192
    ds_read_b64_tr_b16 v[170:171], v223 offset:10240
    ds_read_b128 v[180:183], v226 offset:0
    ds_read_b128 v[184:187], v226 offset:4096
    ds_read_b128 v[188:191], v226 offset:8192
    s_waitcnt lgkmcnt(2)
    v_mfma_f32_32x32x16_bf16 v[100:115], v[168:171], v[180:183], v[100:115]
    s_waitcnt lgkmcnt(1)
    v_mfma_f32_32x32x16_bf16 v[116:131], v[168:171], v[184:187], v[116:131]
    s_waitcnt lgkmcnt(0)
    v_mfma_f32_32x32x16_bf16 v[132:147], v[168:171], v[188:191], v[132:147]
    ds_read_b64_tr_b16 v[164:165], v223 offset:16384
    ds_read_b64_tr_b16 v[166:167], v223 offset:18432
    ds_read_b128 v[180:183], v227 offset:0
    ds_read_b128 v[184:187], v227 offset:4096
    ds_read_b128 v[188:191], v227 offset:8192
    s_waitcnt lgkmcnt(2)
    v_mfma_f32_32x32x16_bf16 v[100:115], v[164:167], v[180:183], v[100:115]
    s_waitcnt lgkmcnt(1)
    v_mfma_f32_32x32x16_bf16 v[116:131], v[164:167], v[184:187], v[116:131]
    s_waitcnt lgkmcnt(0)
    v_mfma_f32_32x32x16_bf16 v[132:147], v[164:167], v[188:191], v[132:147]
    ds_read_b64_tr_b16 v[168:169], v223 offset:24576
    ds_read_b64_tr_b16 v[170:171], v223 offset:26624
    ds_read_b128 v[180:183], v228 offset:0
    ds_read_b128 v[184:187], v228 offset:4096
    ds_read_b128 v[188:191], v228 offset:8192
    s_waitcnt lgkmcnt(2)
    v_mfma_f32_32x32x16_bf16 v[100:115], v[168:171], v[180:183], v[100:115]
    s_waitcnt lgkmcnt(1)
    v_mfma_f32_32x32x16_bf16 v[116:131], v[168:171], v[184:187], v[116:131]
    s_waitcnt lgkmcnt(0)
    v_mfma_f32_32x32x16_bf16 v[132:147], v[168:171], v[188:191], v[132:147]
    s_waitcnt lgkmcnt(0)
    s_barrier
    s_lshl_b32 s4, s3, 14
    s_lshl_b32 s5, s31, 8
    s_add_u32 s4, s4, s5
    s_lshl_b32 s6, s3, 10
    s_add_u32 s5, s6, 32768
    s_mov_b32 m0, s5
    s_add_u32 s5, s4, 3145728
    buffer_load_dwordx4 v229, s[20:23], s5 offen lds
    s_add_u32 s5, s6, 40960
    s_mov_b32 m0, s5
    s_add_u32 s5, s4, 3276800
    buffer_load_dwordx4 v229, s[20:23], s5 offen lds
    s_add_u32 s5, s6, 49152
    s_mov_b32 m0, s5
    s_add_u32 s5, s4, 3407872
    buffer_load_dwordx4 v229, s[20:23], s5 offen lds
    s_add_u32 s5, s6, 57344
    s_mov_b32 m0, s5
    s_add_u32 s5, s4, 3538944
    buffer_load_dwordx4 v229, s[20:23], s5 offen lds
    s_mul_i32 s4, s28, 81920
    s_lshl_b32 s5, s3, 13
    s_add_u32 s4, s4, s5
    s_add_u32 s4, s4, 768
    s_add_u32 s5, s6, 131072
    s_mov_b32 m0, s5
    s_nop 0
    buffer_load_dwordx4 v230, s[8:11], s4 offen lds
    s_cmp_ge_u32 s3, 4
    s_cbranch_scc1 A_qx6
    s_add_u32 s4, s4, 65536
    s_add_u32 s5, s5, 8192
    s_mov_b32 m0, s5
    s_nop 0
    buffer_load_dwordx4 v230, s[8:11], s4 offen lds
A_qx6:
    s_waitcnt vmcnt(5)
    s_barrier
    ds_read_b64_tr_b16 v[164:165], v224 offset:0
    ds_read_b64_tr_b16 v[166:167], v224 offset:2048
    ds_read_b128 v[180:183], v225 offset:12288
    ds_read_b128 v[184:187], v225 offset:16384
    ds_read_b128 v[188:191], v225 offset:20480
    s_waitcnt lgkmcnt(2)
    v_mfma_f32_32x32x16_bf16 v[100:115], v[164:167], v[180:183], v[100:115]
    s_waitcnt lgkmcnt(1)
    v_mfma_f32_32x32x16_bf16 v[116:131], v[164:167], v[184:187], v[116:131]
    s_waitcnt lgkmcnt(0)
    v_mfma_f32_32x32x16_bf16 v[132:147], v[164:167], v[188:191], v[132:147]
    ds_read_b64_tr_b16 v[168:169], v224 offset:8192
    ds_read_b64_tr_b16 v[170:171], v224 offset:10240
    ds_read_b128 v[180:183], v226 offset:12288
    ds_read_b128 v[184:187], v226 offset:16384
    ds_read_b128 v[188:191], v226 offset:20480
    s_waitcnt lgkmcnt(2)
    v_mfma_f32_32x32x16_bf16 v[100:115], v[168:171], v[180:183], v[100:115]
    s_waitcnt lgkmcnt(1)
    v_mfma_f32_32x32x16_bf16 v[116:131], v[168:171], v[184:187], v[116:131]
    s_waitcnt lgkmcnt(0)
    v_mfma_f32_32x32x16_bf16 v[132:147], v[168:171], v[188:191], v[132:147]
    ds_read_b64_tr_b16 v[164:165], v224 offset:16384
    ds_read_b64_tr_b16 v[166:167], v224 offset:18432
    ds_read_b128 v[180:183], v227 offset:12288
    ds_read_b128 v[184:187], v227 offset:16384
    ds_read_b128 v[188:191], v227 offset:20480
    s_waitcnt lgkmcnt(2)
    v_mfma_f32_32x32x16_bf16 v[100:115], v[164:167], v[180:183], v[100:115]
    s_waitcnt lgkmcnt(1)
    v_mfma_f32_32x32x16_bf16 v[116:131], v[164:167], v[184:187], v[116:131]
    s_waitcnt lgkmcnt(0)
    v_mfma_f32_32x32x16_bf16 v[132:147], v[164:167], v[188:191], v[132:147]
    ds_read_b64_tr_b16 v[168:169], v224 offset:24576
    ds_read_b64_tr_b16 v[170:171], v224 offset:26624
    ds_read_b128 v[180:183], v228 offset:12288
    ds_read_b128 v[184:187], v228 offset:16384
    ds_read_b128 v[188:191], v228 offset:20480
    s_waitcnt lgkmcnt(2)
    v_mfma_f32_32x32x16_bf16 v[100:115], v[168:171], v[180:183], v[100:115]
    s_waitcnt lgkmcnt(1)
    v_mfma_f32_32x32x16_bf16 v[116:131], v[168:171], v[184:187], v[116:131]
    s_waitcnt lgkmcnt(0)
    v_mfma_f32_32x32x16_bf16 v[132:147], v[168:171], v[188:191], v[132:147]
    s_waitcnt lgkmcnt(0)
    s_barrier
    s_lshl_b32 s4, s3, 14
    s_lshl_b32 s5, s31, 8
    s_add_u32 s4, s4, s5
    s_lshl_b32 s6, s3, 10
    s_add_u32 s5, s6, 98304
    s_mov_b32 m0, s5
    s_add_u32 s5, s4, 3670016
    buffer_load_dwordx4 v229, s[20:23], s5 offen lds
    s_add_u32 s5, s6, 106496
    s_mov_b32 m0, s5
    s_add_u32 s5, s4, 3801088
    buffer_load_dwordx4 v229, s[20:23], s5 offen lds
    s_add_u32 s5, s6, 114688
    s_mov_b32 m0, s5
    s_add_u32 s5, s4, 3932160
    buffer_load_dwordx4 v229, s[20:23], s5 offen lds
    s_add_u32 s5, s6, 122880
    s_mov_b32 m0, s5
    s_add_u32 s5, s4, 4063232
    buffer_load_dwordx4 v229, s[20:23], s5 offen lds
    s_mul_i32 s4, s28, 81920
    s_lshl_b32 s5, s3, 13
    s_add_u32 s4, s4, s5
    s_add_u32 s4, s4, 896
    s_add_u32 s5, s6, 143360
    s_mov_b32 m0, s5
    s_nop 0
    buffer_load_dwordx4 v230, s[8:11], s4 offen lds
    s_cmp_ge_u32 s3, 4
    s_cbranch_scc1 A_qx7
    s_add_u32 s4, s4, 65536
    s_add_u32 s5, s5, 8192
    s_mov_b32 m0, s5
    s_nop 0
    buffer_load_dwordx4 v230, s[8:11], s4 offen lds
A_qx7:
    s_waitcnt vmcnt(5)
    s_barrier
    ds_read_b64_tr_b16 v[164:165], v223 offset:0
    ds_read_b64_tr_b16 v[166:167], v223 offset:2048
    ds_read_b128 v[180:183], v225 offset:0
    ds_read_b128 v[184:187], v225 offset:4096
    ds_read_b128 v[188:191], v225 offset:8192
    s_waitcnt lgkmcnt(2)
    v_mfma_f32_32x32x16_bf16 v[100:115], v[164:167], v[180:183], v[100:115]
    s_waitcnt lgkmcnt(1)
    v_mfma_f32_32x32x16_bf16 v[116:131], v[164:167], v[184:187], v[116:131]
    s_waitcnt lgkmcnt(0)
    v_mfma_f32_32x32x16_bf16 v[132:147], v[164:167], v[188:191], v[132:147]
    ds_read_b64_tr_b16 v[168:169], v223 offset:8192
    ds_read_b64_tr_b16 v[170:171], v223 offset:10240
    ds_read_b128 v[180:183], v226 offset:0
    ds_read_b128 v[184:187], v226 offset:4096
    ds_read_b128 v[188:191], v226 offset:8192
    s_waitcnt lgkmcnt(2)
    v_mfma_f32_32x32x16_bf16 v[100:115], v[168:171], v[180:183], v[100:115]
    s_waitcnt lgkmcnt(1)
    v_mfma_f32_32x32x16_bf16 v[116:131], v[168:171], v[184:187], v[116:131]
    s_waitcnt lgkmcnt(0)
    v_mfma_f32_32x32x16_bf16 v[132:147], v[168:171], v[188:191], v[132:147]
    ds_read_b64_tr_b16 v[164:165], v223 offset:16384
    ds_read_b64_tr_b16 v[166:167], v223 offset:18432
    ds_read_b128 v[180:183], v227 offset:0
    ds_read_b128 v[184:187], v227 offset:4096
    ds_read_b128 v[188:191], v227 offset:8192
    s_waitcnt lgkmcnt(2)
    v_mfma_f32_32x32x16_bf16 v[100:115], v[164:167], v[180:183], v[100:115]
    s_waitcnt lgkmcnt(1)
    v_mfma_f32_32x32x16_bf16 v[116:131], v[164:167], v[184:187], v[116:131]
    s_waitcnt lgkmcnt(0)
    v_mfma_f32_32x32x16_bf16 v[132:147], v[164:167], v[188:191], v[132:147]
    ds_read_b64_tr_b16 v[168:169], v223 offset:24576
    ds_read_b64_tr_b16 v[170:171], v223 offset:26624
    ds_read_b128 v[180:183], v228 offset:0
    ds_read_b128 v[184:187], v228 offset:4096
    ds_read_b128 v[188:191], v228 offset:8192
    s_waitcnt lgkmcnt(2)
    v_mfma_f32_32x32x16_bf16 v[100:115], v[168:171], v[180:183], v[100:115]
    s_waitcnt lgkmcnt(1)
    v_mfma_f32_32x32x16_bf16 v[116:131], v[168:171], v[184:187], v[116:131]
    s_waitcnt lgkmcnt(0)
    v_mfma_f32_32x32x16_bf16 v[132:147], v[168:171], v[188:191], v[132:147]
    s_waitcnt lgkmcnt(0)
    s_barrier
    s_waitcnt vmcnt(0)
    s_barrier
    ds_read_b64_tr_b16 v[164:165], v224 offset:0
    ds_read_b64_tr_b16 v[166:167], v224 offset:2048
    ds_read_b128 v[180:183], v225 offset:12288
    ds_read_b128 v[184:187], v225 offset:16384
    ds_read_b128 v[188:191], v225 offset:20480
    s_waitcnt lgkmcnt(2)
    v_mfma_f32_32x32x16_bf16 v[100:115], v[164:167], v[180:183], v[100:115]
    s_waitcnt lgkmcnt(1)
    v_mfma_f32_32x32x16_bf16 v[116:131], v[164:167], v[184:187], v[116:131]
    s_waitcnt lgkmcnt(0)
    v_mfma_f32_32x32x16_bf16 v[132:147], v[164:167], v[188:191], v[132:147]
    ds_read_b64_tr_b16 v[168:169], v224 offset:8192
    ds_read_b64_tr_b16 v[170:171], v224 offset:10240
    ds_read_b128 v[180:183], v226 offset:12288
    ds_read_b128 v[184:187], v226 offset:16384
    ds_read_b128 v[188:191], v226 offset:20480
    s_waitcnt lgkmcnt(2)
    v_mfma_f32_32x32x16_bf16 v[100:115], v[168:171], v[180:183], v[100:115]
    s_waitcnt lgkmcnt(1)
    v_mfma_f32_32x32x16_bf16 v[116:131], v[168:171], v[184:187], v[116:131]
    s_waitcnt lgkmcnt(0)
    v_mfma_f32_32x32x16_bf16 v[132:147], v[168:171], v[188:191], v[132:147]
    ds_read_b64_tr_b16 v[164:165], v224 offset:16384
    ds_read_b64_tr_b16 v[166:167], v224 offset:18432
    ds_read_b128 v[180:183], v227 offset:12288
    ds_read_b128 v[184:187], v227 offset:16384
    ds_read_b128 v[188:191], v227 offset:20480
    s_waitcnt lgkmcnt(2)
    v_mfma_f32_32x32x16_bf16 v[100:115], v[164:167], v[180:183], v[100:115]
    s_waitcnt lgkmcnt(1)
    v_mfma_f32_32x32x16_bf16 v[116:131], v[164:167], v[184:187], v[116:131]
    s_waitcnt lgkmcnt(0)
    v_mfma_f32_32x32x16_bf16 v[132:147], v[164:167], v[188:191], v[132:147]
    ds_read_b64_tr_b16 v[168:169], v224 offset:24576
    ds_read_b64_tr_b16 v[170:171], v224 offset:26624
    ds_read_b128 v[180:183], v228 offset:12288
    ds_read_b128 v[184:187], v228 offset:16384
    ds_read_b128 v[188:191], v228 offset:20480
    s_waitcnt lgkmcnt(2)
    v_mfma_f32_32x32x16_bf16 v[100:115], v[168:171], v[180:183], v[100:115]
    s_waitcnt lgkmcnt(1)
    v_mfma_f32_32x32x16_bf16 v[116:131], v[168:171], v[184:187], v[116:131]
    s_waitcnt lgkmcnt(0)
    v_mfma_f32_32x32x16_bf16 v[132:147], v[168:171], v[188:191], v[132:147]
    s_waitcnt lgkmcnt(0)
    s_barrier
    s_and_b32 s4, s3, 3
    s_lshl_b32 s4, s4, 2
    s_lshr_b32 s5, s3, 2
    s_mul_i32 s5, s5, 65536
    s_add_u32 s5, s5, 32768
    v_mov_b32 v217, 0
    v_add_u32 v217, s4, v217
    v_xor_b32 v217, v217, v214
    v_lshlrev_b32 v217, 4, v217
    v_lshl_add_u32 v217, v216, 8, v217
    v_lshl_add_u32 v217, v215, 3, v217
    v_add_u32 v196, s5, v217
    v_mov_b32 v217, 1
    v_add_u32 v217, s4, v217
    v_xor_b32 v217, v217, v214
    v_lshlrev_b32 v217, 4, v217
    v_lshl_add_u32 v217, v216, 8, v217
    v_lshl_add_u32 v217, v215, 3, v217
    v_add_u32 v197, s5, v217
    v_mov_b32 v217, 2
    v_add_u32 v217, s4, v217
    v_xor_b32 v217, v217, v214
    v_lshlrev_b32 v217, 4, v217
    v_lshl_add_u32 v217, v216, 8, v217
    v_lshl_add_u32 v217, v215, 3, v217
    v_add_u32 v198, s5, v217
    v_mov_b32 v217, 3
    v_add_u32 v217, s4, v217
    v_xor_b32 v217, v217, v214
    v_lshlrev_b32 v217, 4, v217
    v_lshl_add_u32 v217, v216, 8, v217
    v_lshl_add_u32 v217, v215, 3, v217
    v_add_u32 v199, s5, v217
    v_cvt_pk_bf16_f32 v164, v100, v101
    v_cvt_pk_bf16_f32 v165, v102, v103
    ds_write_b64 v196, v[164:165] offset:0
    v_cvt_pk_bf16_f32 v166, v104, v105
    v_cvt_pk_bf16_f32 v167, v106, v107
    ds_write_b64 v197, v[166:167] offset:0
    v_cvt_pk_bf16_f32 v168, v108, v109
    v_cvt_pk_bf16_f32 v169, v110, v111
    ds_write_b64 v198, v[168:169] offset:0
    v_cvt_pk_bf16_f32 v170, v112, v113
    v_cvt_pk_bf16_f32 v171, v114, v115
    ds_write_b64 v199, v[170:171] offset:0
    v_cvt_pk_bf16_f32 v172, v116, v117
    v_cvt_pk_bf16_f32 v173, v118, v119
    ds_write_b64 v196, v[172:173] offset:8192
    v_cvt_pk_bf16_f32 v174, v120, v121
    v_cvt_pk_bf16_f32 v175, v122, v123
    ds_write_b64 v197, v[174:175] offset:8192
    v_cvt_pk_bf16_f32 v176, v124, v125
    v_cvt_pk_bf16_f32 v177, v126, v127
    ds_write_b64 v198, v[176:177] offset:8192
    v_cvt_pk_bf16_f32 v178, v128, v129
    v_cvt_pk_bf16_f32 v179, v130, v131
    ds_write_b64 v199, v[178:179] offset:8192
    v_cmp_gt_u32 vcc, 16, v216
    s_nop 0
    s_and_saveexec_b64 s[58:59], vcc
    v_cvt_pk_bf16_f32 v180, v132, v133
    v_cvt_pk_bf16_f32 v181, v134, v135
    ds_write_b64 v196, v[180:181] offset:16384
    v_cvt_pk_bf16_f32 v182, v136, v137
    v_cvt_pk_bf16_f32 v183, v138, v139
    ds_write_b64 v197, v[182:183] offset:16384
    v_cvt_pk_bf16_f32 v184, v140, v141
    v_cvt_pk_bf16_f32 v185, v142, v143
    ds_write_b64 v198, v[184:185] offset:16384
    v_cvt_pk_bf16_f32 v186, v144, v145
    v_cvt_pk_bf16_f32 v187, v146, v147
    ds_write_b64 v199, v[186:187] offset:16384
    s_mov_b64 exec, s[58:59]
    s_waitcnt lgkmcnt(0)
    s_barrier
    v_add_u32 v217, 0, v215
    v_xor_b32 v217, v217, v214
    v_lshlrev_b32 v217, 4, v217
    v_lshl_add_u32 v196, v216, 8, v217
    v_add_u32 v217, 2, v215
    v_xor_b32 v217, v217, v214
    v_lshlrev_b32 v217, 4, v217
    v_lshl_add_u32 v197, v216, 8, v217
    v_add_u32 v217, 4, v215
    v_xor_b32 v217, v217, v214
    v_lshlrev_b32 v217, 4, v217
    v_lshl_add_u32 v198, v216, 8, v217
    v_add_u32 v217, 6, v215
    v_xor_b32 v217, v217, v214
    v_lshlrev_b32 v217, 4, v217
    v_lshl_add_u32 v199, v216, 8, v217
    v_add_u32 v217, 8, v215
    v_xor_b32 v217, v217, v214
    v_lshlrev_b32 v217, 4, v217
    v_lshl_add_u32 v200, v216, 8, v217
    v_add_u32 v217, 10, v215
    v_xor_b32 v217, v217, v214
    v_lshlrev_b32 v217, 4, v217
    v_lshl_add_u32 v201, v216, 8, v217
    v_add_u32 v217, 12, v215
    v_xor_b32 v217, v217, v214
    v_lshlrev_b32 v217, 4, v217
    v_lshl_add_u32 v202, v216, 8, v217
    v_add_u32 v217, 14, v215
    v_xor_b32 v217, v217, v214
    v_lshlrev_b32 v217, 4, v217
    v_lshl_add_u32 v203, v216, 8, v217
    s_min_u32 s4, s3, 4
    s_lshl_b32 s4, s4, 5
    v_add_u32 v217, s4, v216
    v_lshlrev_b32 v218, 8, v217
    v_add_u32 v219, 32768, v218
    v_add_u32 v220, 77824, v218
    v_cmp_gt_u32 vcc, 80, v217
    s_nop 1
    v_cndmask_b32 v218, v220, v219, vcc
    v_lshrrev_b32 v217, 8, v196
    v_lshlrev_b32 v217, 8, v217
    v_sub_u32 v218, v218, v217
    v_add_u32 v219, v196, v218
    ds_read_b128 v[4:7], v219
    v_add_u32 v219, v197, v218
    ds_read_b128 v[8:11], v219
    v_add_u32 v219, v198, v218
    ds_read_b128 v[12:15], v219
    v_add_u32 v219, v199, v218
    ds_read_b128 v[16:19], v219
    v_add_u32 v219, v200, v218
    ds_read_b128 v[20:23], v219
    v_add_u32 v219, v201, v218
    ds_read_b128 v[24:27], v219
    v_add_u32 v219, v202, v218
    ds_read_b128 v[28:31], v219
    v_add_u32 v219, v203, v218
    ds_read_b128 v[32:35], v219
    v_lshrrev_b32 v217, 2, v214
    v_lshl_add_u32 v218, v215, 2, v217
    v_lshlrev_b32 v218, 8, v218
    v_xor_b32 v217, 0, v217
    v_lshlrev_b32 v217, 2, v217
    v_and_b32 v219, 1, v213
    v_lshl_add_u32 v217, v219, 1, v217
    v_bfe_u32 v219, v1, 1, 1
    v_add_u32 v217, v217, v219
    v_lshl_add_u32 v218, v217, 4, v218
    v_and_b32 v219, 1, v1
    v_lshl_add_u32 v218, v219, 3, v218
    v_add_u32 v204, 65536, v218
    v_lshrrev_b32 v217, 2, v214
    v_lshl_add_u32 v218, v215, 2, v217
    v_lshlrev_b32 v218, 8, v218
    v_xor_b32 v217, 1, v217
    v_lshlrev_b32 v217, 2, v217
    v_and_b32 v219, 1, v213
    v_lshl_add_u32 v217, v219, 1, v217
    v_bfe_u32 v219, v1, 1, 1
    v_add_u32 v217, v217, v219
    v_lshl_add_u32 v218, v217, 4, v218
    v_and_b32 v219, 1, v1
    v_lshl_add_u32 v218, v219, 3, v218
    v_add_u32 v205, 65536, v218
    v_lshrrev_b32 v217, 2, v214
    v_lshl_add_u32 v218, v215, 2, v217
    v_lshlrev_b32 v218, 8, v218
    v_xor_b32 v217, 2, v217
    v_lshlrev_b32 v217, 2, v217
    v_and_b32 v219, 1, v213
    v_lshl_add_u32 v217, v219, 1, v217
    v_bfe_u32 v219, v1, 1, 1
    v_add_u32 v217, v217, v219
    v_lshl_add_u32 v218, v217, 4, v218
    v_and_b32 v219, 1, v1
    v_lshl_add_u32 v218, v219, 3, v218
    v_add_u32 v206, 65536, v218
    v_lshrrev_b32 v217, 2, v214
    v_lshl_add_u32 v218, v215, 2, v217
    v_lshlrev_b32 v218, 8, v218
    v_xor_b32 v217, 3, v217
    v_lshlrev_b32 v217, 2, v217
    v_and_b32 v219, 1, v213
    v_lshl_add_u32 v217, v219, 1, v217
    v_bfe_u32 v219, v1, 1, 1
    v_add_u32 v217, v217, v219
    v_lshl_add_u32 v218, v217, 4, v218
    v_and_b32 v219, 1, v1
    v_lshl_add_u32 v218, v219, 3, v218
    v_add_u32 v207, 65536, v218
    s_waitcnt lgkmcnt(0)
    s_barrier
    v_mov_b32 v208, 0xf149f2ca
    v_mov_b32 v209, 0
    v_mov_b32 v210, 0
    v_mov_b32 v36, 0
    v_mov_b32 v37, 0
    v_mov_b32 v38, 0
    v_mov_b32 v39, 0
    v_mov_b32 v40, 0
    v_mov_b32 v41, 0
    v_mov_b32 v42, 0
    v_mov_b32 v43, 0
    v_mov_b32 v44, 0
    v_mov_b32 v45, 0
    v_mov_b32 v46, 0
    v_mov_b32 v47, 0
    v_mov_b32 v48, 0
    v_mov_b32 v49, 0
    v_mov_b32 v50, 0
    v_mov_b32 v51, 0
    v_mov_b32 v52, 0
    v_mov_b32 v53, 0
    v_mov_b32 v54, 0
    v_mov_b32 v55, 0
    v_mov_b32 v56, 0
    v_mov_b32 v57, 0
    v_mov_b32 v58, 0
    v_mov_b32 v59, 0
    v_mov_b32 v60, 0
    v_mov_b32 v61, 0
    v_mov_b32 v62, 0
    v_mov_b32 v63, 0
    v_mov_b32 v64, 0
    v_mov_b32 v65, 0
    v_mov_b32 v66, 0
    v_mov_b32 v67, 0
    v_mov_b32 v68, 0
    v_mov_b32 v69, 0
    v_mov_b32 v70, 0
    v_mov_b32 v71, 0
    v_mov_b32 v72, 0
    v_mov_b32 v73, 0
    v_mov_b32 v74, 0
    v_mov_b32 v75, 0
    v_mov_b32 v76, 0
    v_mov_b32 v77, 0
    v_mov_b32 v78, 0
    v_mov_b32 v79, 0
    v_mov_b32 v80, 0
    v_mov_b32 v81, 0
    v_mov_b32 v82, 0
    v_mov_b32 v83, 0
    v_mov_b32 v84, 0
    v_mov_b32 v85, 0
    v_mov_b32 v86, 0
    v_mov_b32 v87, 0
    v_mov_b32 v88, 0
    v_mov_b32 v89, 0
    v_mov_b32 v90, 0
    v_mov_b32 v91, 0
    v_mov_b32 v92, 0
    v_mov_b32 v93, 0
    v_mov_b32 v94, 0
    v_mov_b32 v95, 0
    v_mov_b32 v96, 0
    v_mov_b32 v97, 0
    v_mov_b32 v98, 0
    v_mov_b32 v99, 0
    s_cmp_ge_u32 s3, 4
    s_cbranch_scc1 A_small
    ds_read_b128 v[164:167], v196 offset:0
    s_waitcnt lgkmcnt(0)
    v_mfma_f32_32x32x16_bf16 v[100:115], v[164:167], v[4:7], 0
    ds_read_b128 v[168:171], v197 offset:0
    s_waitcnt lgkmcnt(0)
    v_mfma_f32_32x32x16_bf16 v[100:115], v[168:171], v[8:11], v[100:115]
    ds_read_b128 v[172:175], v198 offset:0
    s_waitcnt lgkmcnt(0)
    v_mfma_f32_32x32x16_bf16 v[100:115], v[172:175], v[12:15], v[100:115]
    ds_read_b128 v[176:179], v199 offset:0
    s_waitcnt lgkmcnt(0)
    v_mfma_f32_32x32x16_bf16 v[100:115], v[176:179], v[16:19], v[100:115]
    ds_read_b128 v[164:167], v200 offset:0
    s_waitcnt lgkmcnt(0)
    v_mfma_f32_32x32x16_bf16 v[100:115], v[164:167], v[20:23], v[100:115]
    ds_read_b128 v[168:171], v201 offset:0
    s_waitcnt lgkmcnt(0)
    v_mfma_f32_32x32x16_bf16 v[100:115], v[168:171], v[24:27], v[100:115]
    ds_read_b128 v[172:175], v202 offset:0
    s_waitcnt lgkmcnt(0)
    v_mfma_f32_32x32x16_bf16 v[100:115], v[172:175], v[28:31], v[100:115]
    ds_read_b128 v[176:179], v203 offset:0
    s_waitcnt lgkmcnt(0)
    v_mfma_f32_32x32x16_bf16 v[100:115], v[176:179], v[32:35], v[100:115]
    ds_read_b128 v[164:167], v196 offset:8192
    s_waitcnt lgkmcnt(0)
    v_mfma_f32_32x32x16_bf16 v[116:131], v[164:167], v[4:7], 0
    ds_read_b128 v[168:171], v197 offset:8192
    s_waitcnt lgkmcnt(0)
    v_mfma_f32_32x32x16_bf16 v[116:131], v[168:171], v[8:11], v[116:131]
    ds_read_b128 v[172:175], v198 offset:8192
    s_waitcnt lgkmcnt(0)
    v_mfma_f32_32x32x16_bf16 v[116:131], v[172:175], v[12:15], v[116:131]
    ds_read_b128 v[176:179], v199 offset:8192
    s_waitcnt lgkmcnt(0)
    v_mfma_f32_32x32x16_bf16 v[116:131], v[176:179], v[16:19], v[116:131]
    ds_read_b128 v[164:167], v200 offset:8192
    s_waitcnt lgkmcnt(0)
    v_mfma_f32_32x32x16_bf16 v[116:131], v[164:167], v[20:23], v[116:131]
    ds_read_b128 v[168:171], v201 offset:8192
    s_waitcnt lgkmcnt(0)
    v_mfma_f32_32x32x16_bf16 v[116:131], v[168:171], v[24:27], v[116:131]
    ds_read_b128 v[172:175], v202 offset:8192
    s_waitcnt lgkmcnt(0)
    v_mfma_f32_32x32x16_bf16 v[116:131], v[172:175], v[28:31], v[116:131]
    ds_read_b128 v[176:179], v203 offset:8192
    s_waitcnt lgkmcnt(0)
    v_mfma_f32_32x32x16_bf16 v[116:131], v[176:179], v[32:35], v[116:131]
    v_max3_f32 v213, v100, v101, v102
    v_max3_f32 v214, v103, v104, v105
    v_max3_f32 v215, v106, v107, v108
    v_max3_f32 v216, v109, v110, v111
    v_max3_f32 v217, v112, v113, v114
    s_nop 6
    v_max3_f32 v218, v115, v116, v117
    v_max3_f32 v219, v118, v119, v120
    v_max3_f32 v220, v121, v122, v123
    v_max3_f32 v213, v213, v124, v125
    v_max3_f32 v214, v214, v126, v127
    v_max3_f32 v215, v215, v128, v129
    v_max3_f32 v216, v216, v130, v131
    v_max3_f32 v213, v213, v214, v215
    v_max3_f32 v216, v216, v217, v218
    v_max3_f32 v213, v213, v219, v220
    v_max_f32 v213, v213, v216
    v_mov_b32 v214, v213
    s_nop 1
    v_permlane32_swap_b32 v213, v214
    v_max3_f32 v213, v213, v214, v208
    v_sub_f32 v214, v213, v208
    v_cmp_lt_f32 vcc, s49, v214
    s_nop 1
    s_cbranch_vccz A_nrp
    v_mul_f32 v214, s55, v214
    v_exp_f32 v211, v214
    s_nop 0
    v_mul_f32 v209, v209, v211
    v_mul_f32 v210, v210, v211
    v_mov_b32 v208, v213
    s_mov_b32 s50, 1
A_nrp:
    v_mul_f32 v212, s48, v208
    v_fma_f32 v100, v100, s48, -v212
    v_exp_f32 v100, v100
    s_nop 0
    v_add_f32 v209, v209, v100
    v_fma_f32 v101, v101, s48, -v212
    v_exp_f32 v101, v101
    s_nop 0
    v_add_f32 v210, v210, v101
    v_cvt_pk_bf16_f32 v100, v100, v101
    v_fma_f32 v102, v102, s48, -v212
    v_exp_f32 v102, v102
    s_nop 0
    v_add_f32 v209, v209, v102
    v_fma_f32 v103, v103, s48, -v212
    v_exp_f32 v103, v103
    s_nop 0
    v_add_f32 v210, v210, v103
    v_cvt_pk_bf16_f32 v101, v102, v103
    v_fma_f32 v104, v104, s48, -v212
    v_exp_f32 v104, v104
    s_nop 0
    v_add_f32 v209, v209, v104
    v_fma_f32 v105, v105, s48, -v212
    v_exp_f32 v105, v105
    s_nop 0
    v_add_f32 v210, v210, v105
    v_cvt_pk_bf16_f32 v102, v104, v105
    v_fma_f32 v106, v106, s48, -v212
    v_exp_f32 v106, v106
    s_nop 0
    v_add_f32 v209, v209, v106
    v_fma_f32 v107, v107, s48, -v212
    v_exp_f32 v107, v107
    s_nop 0
    v_add_f32 v210, v210, v107
    v_cvt_pk_bf16_f32 v103, v106, v107
    v_fma_f32 v108, v108, s48, -v212
    v_exp_f32 v108, v108
    s_nop 0
    v_add_f32 v209, v209, v108
    v_fma_f32 v109, v109, s48, -v212
    v_exp_f32 v109, v109
    s_nop 0
    v_add_f32 v210, v210, v109
    v_cvt_pk_bf16_f32 v104, v108, v109
    v_fma_f32 v110, v110, s48, -v212
    v_exp_f32 v110, v110
    s_nop 0
    v_add_f32 v209, v209, v110
    v_fma_f32 v111, v111, s48, -v212
    v_exp_f32 v111, v111
    s_nop 0
    v_add_f32 v210, v210, v111
    v_cvt_pk_bf16_f32 v105, v110, v111
    v_fma_f32 v112, v112, s48, -v212
    v_exp_f32 v112, v112
    s_nop 0
    v_add_f32 v209, v209, v112
    v_fma_f32 v113, v113, s48, -v212
    v_exp_f32 v113, v113
    s_nop 0
    v_add_f32 v210, v210, v113
    v_cvt_pk_bf16_f32 v106, v112, v113
    v_fma_f32 v114, v114, s48, -v212
    v_exp_f32 v114, v114
    s_nop 0
    v_add_f32 v209, v209, v114
    v_fma_f32 v115, v115, s48, -v212
    v_exp_f32 v115, v115
    s_nop 0
    v_add_f32 v210, v210, v115
    v_cvt_pk_bf16_f32 v107, v114, v115
    s_mov_b32 s51, 0
A_bloop:
    ds_read_b128 v[164:167], v196 offset:16384
    ds_read_b128 v[168:171], v197 offset:16384
    ds_read_b128 v[172:175], v198 offset:16384
    ds_read_b128 v[176:179], v199 offset:16384
    s_waitcnt lgkmcnt(3)
    v_mfma_f32_32x32x16_bf16 v[132:147], v[164:167], v[4:7], 0
    s_cmp_eq_u32 s50, 0
    s_cbranch_scc1 A_noec
    v_mul_f32 v36, v36, v211
    v_mul_f32 v37, v37, v211
    v_mul_f32 v38, v38, v211
    v_mul_f32 v39, v39, v211
    v_mul_f32 v40, v40, v211
    v_mul_f32 v41, v41, v211
    v_mul_f32 v42, v42, v211
    v_mul_f32 v43, v43, v211
    v_mul_f32 v44, v44, v211
    v_mul_f32 v45, v45, v211
    v_mul_f32 v46, v46, v211
    v_mul_f32 v47, v47, v211
    v_mul_f32 v48, v48, v211
    v_mul_f32 v49, v49, v211
    v_mul_f32 v50, v50, v211
    v_mul_f32 v51, v51, v211
    v_mul_f32 v52, v52, v211
    v_mul_f32 v53, v53, v211
    v_mul_f32 v54, v54, v211
    v_mul_f32 v55, v55, v211
    v_mul_f32 v56, v56, v211
    v_mul_f32 v57, v57, v211
    v_mul_f32 v58, v58, v211
    v_mul_f32 v59, v59, v211
    v_mul_f32 v60, v60, v211
    v_mul_f32 v61, v61, v211
    v_mul_f32 v62, v62, v211
    v_mul_f32 v63, v63, v211
    v_mul_f32 v64, v64, v211
    v_mul_f32 v65, v65, v211
    v_mul_f32 v66, v66, v211
    v_mul_f32 v67, v67, v211
    v_mul_f32 v68, v68, v211
    v_mul_f32 v69, v69, v211
    v_mul_f32 v70, v70, v211
    v_mul_f32 v71, v71, v211
    v_mul_f32 v72, v72, v211
    v_mul_f32 v73, v73, v211
    v_mul_f32 v74, v74, v211
    v_mul_f32 v75, v75, v211
    v_mul_f32 v76, v76, v211
    v_mul_f32 v77, v77, v211
    v_mul_f32 v78, v78, v211
    v_mul_f32 v79, v79, v211
    v_mul_f32 v80, v80, v211
    v_mul_f32 v81, v81, v211
    v_mul_f32 v82, v82, v211
    v_mul_f32 v83, v83, v211
    v_mul_f32 v84, v84, v211
    v_mul_f32 v85, v85, v211
    v_mul_f32 v86, v86, v211
    v_mul_f32 v87, v87, v211
    v_mul_f32 v88, v88, v211
    v_mul_f32 v89, v89, v211
    v_mul_f32 v90, v90, v211
    v_mul_f32 v91, v91, v211
    v_mul_f32 v92, v92, v211
    v_mul_f32 v93, v93, v211
    v_mul_f32 v94, v94, v211
    v_mul_f32 v95, v95, v211
    v_mul_f32 v96, v96, v211
    v_mul_f32 v97, v97, v211
    v_mul_f32 v98, v98, v211
    v_mul_f32 v99, v99, v211
    s_mov_b32 s50, 0
A_noec:
    ds_read_b128 v[164:167], v200 offset:16384
    s_waitcnt lgkmcnt(3)
    v_mfma_f32_32x32x16_bf16 v[132:147], v[168:171], v[8:11], v[132:147]
    ds_read_b128 v[168:171], v201 offset:16384
    s_waitcnt lgkmcnt(3)
    v_mfma_f32_32x32x16_bf16 v[132:147], v[172:175], v[12:15], v[132:147]
    ds_read_b128 v[172:175], v202 offset:16384
    s_waitcnt lgkmcnt(3)
    v_mfma_f32_32x32x16_bf16 v[132:147], v[176:179], v[16:19], v[132:147]
    ds_read_b128 v[176:179], v203 offset:16384
    s_waitcnt lgkmcnt(3)
    v_mfma_f32_32x32x16_bf16 v[132:147], v[164:167], v[20:23], v[132:147]
    ds_read_b128 v[164:167], v196 offset:24576
    s_waitcnt lgkmcnt(3)
    v_mfma_f32_32x32x16_bf16 v[132:147], v[168:171], v[24:27], v[132:147]
    ds_read_b128 v[168:171], v197 offset:24576
    s_waitcnt lgkmcnt(3)
    v_mfma_f32_32x32x16_bf16 v[132:147], v[172:175], v[28:31], v[132:147]
    ds_read_b128 v[172:175], v198 offset:24576
    s_waitcnt lgkmcnt(3)
    v_mfma_f32_32x32x16_bf16 v[132:147], v[176:179], v[32:35], v[132:147]
    ds_read_b128 v[176:179], v199 offset:24576
    s_waitcnt lgkmcnt(3)
    v_mfma_f32_32x32x16_bf16 v[148:163], v[164:167], v[4:7], 0
    v_fma_f32 v116, v116, s48, -v212
    v_exp_f32 v116, v116
    ds_read_b128 v[164:167], v200 offset:24576
    s_waitcnt lgkmcnt(3)
    v_mfma_f32_32x32x16_bf16 v[148:163], v[168:171], v[8:11], v[148:163]
    v_add_f32 v209, v209, v116
    v_fma_f32 v117, v117, s48, -v212
    v_exp_f32 v117, v117
    s_nop 0
    v_add_f32 v210, v210, v117
    v_cvt_pk_bf16_f32 v116, v116, v117
    v_fma_f32 v118, v118, s48, -v212
    v_exp_f32 v118, v118
    s_nop 0
    v_add_f32 v209, v209, v118
    ds_read_b128 v[168:171], v201 offset:24576
    s_waitcnt lgkmcnt(3)
    v_mfma_f32_32x32x16_bf16 v[148:163], v[172:175], v[12:15], v[148:163]
    v_fma_f32 v119, v119, s48, -v212
    v_exp_f32 v119, v119
    s_nop 0
    v_add_f32 v210, v210, v119
    v_cvt_pk_bf16_f32 v117, v118, v119
    v_fma_f32 v120, v120, s48, -v212
    v_exp_f32 v120, v120
    s_nop 0
    v_add_f32 v209, v209, v120
    v_fma_f32 v121, v121, s48, -v212
    ds_read_b128 v[172:175], v202 offset:24576
    s_waitcnt lgkmcnt(3)
    v_mfma_f32_32x32x16_bf16 v[148:163], v[176:179], v[16:19], v[148:163]
    v_exp_f32 v121, v121
    s_nop 0
    v_add_f32 v210, v210, v121
    v_cvt_pk_bf16_f32 v118, v120, v121
    v_fma_f32 v122, v122, s48, -v212
    v_exp_f32 v122, v122
    s_nop 0
    v_add_f32 v209, v209, v122
    v_fma_f32 v123, v123, s48, -v212
    ds_read_b128 v[176:179], v203 offset:24576
    s_waitcnt lgkmcnt(3)
    v_mfma_f32_32x32x16_bf16 v[148:163], v[164:167], v[20:23], v[148:163]
    v_exp_f32 v123, v123
    s_nop 0
    v_add_f32 v210, v210, v123
    v_cvt_pk_bf16_f32 v119, v122, v123
    v_fma_f32 v124, v124, s48, -v212
    v_exp_f32 v124, v124
    s_nop 0
    v_add_f32 v209, v209, v124
    v_fma_f32 v125, v125, s48, -v212
    v_exp_f32 v125, v125
    ds_read_b64_tr_b16 v[180:181], v204 offset:0
    ds_read_b64_tr_b16 v[182:183], v204 offset:2048
    s_waitcnt lgkmcnt(4)
    v_mfma_f32_32x32x16_bf16 v[148:163], v[168:171], v[24:27], v[148:163]
    v_add_f32 v210, v210, v125
    v_cvt_pk_bf16_f32 v120, v124, v125
    v_fma_f32 v126, v126, s48, -v212
    v_exp_f32 v126, v126
    s_nop 0
    v_add_f32 v209, v209, v126
    v_fma_f32 v127, v127, s48, -v212
    v_exp_f32 v127, v127
    s_nop 0
    v_add_f32 v210, v210, v127
    ds_read_b64_tr_b16 v[184:185], v205 offset:0
    ds_read_b64_tr_b16 v[186:187], v205 offset:2048
    s_waitcnt lgkmcnt(5)
    v_mfma_f32_32x32x16_bf16 v[148:163], v[172:175], v[28:31], v[148:163]
    v_cvt_pk_bf16_f32 v121, v126, v127
    v_fma_f32 v128, v128, s48, -v212
    v_exp_f32 v128, v128
    s_nop 0
    v_add_f32 v209, v209, v128
    v_fma_f32 v129, v129, s48, -v212
    v_exp_f32 v129, v129
    s_nop 0
    v_add_f32 v210, v210, v129
    v_cvt_pk_bf16_f32 v122, v128, v129
    ds_read_b64_tr_b16 v[188:189], v206 offset:0
    ds_read_b64_tr_b16 v[190:191], v206 offset:2048
    s_waitcnt lgkmcnt(6)
    v_mfma_f32_32x32x16_bf16 v[148:163], v[176:179], v[32:35], v[148:163]
    v_fma_f32 v130, v130, s48, -v212
    v_exp_f32 v130, v130
    s_nop 0
    v_add_f32 v209, v209, v130
    v_fma_f32 v131, v131, s48, -v212
    v_exp_f32 v131, v131
    s_nop 0
    v_add_f32 v210, v210, v131
    v_cvt_pk_bf16_f32 v123, v130, v131
    ds_read_b64_tr_b16 v[192:193], v207 offset:0
    ds_read_b64_tr_b16 v[194:195], v207 offset:2048
    s_waitcnt lgkmcnt(6)
    v_mfma_f32_32x32x16_bf16 v[36:51], v[180:183], v[100:103], v[36:51]
    v_max3_f32 v213, v132, v133, v134
    v_max3_f32 v214, v135, v136, v137
    v_max3_f32 v215, v138, v139, v140
    v_max3_f32 v216, v141, v142, v143
    v_max3_f32 v217, v144, v145, v146
    v_max3_f32 v218, v147, v148, v149
    ds_read_b64_tr_b16 v[180:181], v204 offset:4096
    ds_read_b64_tr_b16 v[182:183], v204 offset:6144
    s_waitcnt lgkmcnt(6)
    v_mfma_f32_32x32x16_bf16 v[52:67], v[184:187], v[100:103], v[52:67]
    v_max3_f32 v219, v150, v151, v152
    v_max3_f32 v220, v153, v154, v155
    v_max3_f32 v213, v213, v156, v157
    v_max3_f32 v214, v214, v158, v159
    v_max3_f32 v215, v215, v160, v161
    ds_read_b64_tr_b16 v[184:185], v205 offset:4096
    ds_read_b64_tr_b16 v[186:187], v205 offset:6144
    s_waitcnt lgkmcnt(6)
    v_mfma_f32_32x32x16_bf16 v[68:83], v[188:191], v[100:103], v[68:83]
    v_max3_f32 v216, v216, v162, v163
    v_max3_f32 v213, v213, v214, v215
    v_max3_f32 v216, v216, v217, v218
    v_max3_f32 v213, v213, v219, v220
    v_max_f32 v213, v213, v216
    v_mov_b32 v214, v213
    ds_read_b64_tr_b16 v[188:189], v206 offset:4096
    ds_read_b64_tr_b16 v[190:191], v206 offset:6144
    s_waitcnt lgkmcnt(6)
    v_mfma_f32_32x32x16_bf16 v[84:99], v[192:195], v[100:103], v[84:99]
    v_permlane32_swap_b32 v213, v214
    v_max3_f32 v213, v213, v214, v208
    v_sub_f32 v214, v213, v208
    v_cmp_lt_f32 vcc, s49, v214
    s_nop 1
    s_cbranch_vccz A_nren
    v_mul_f32 v214, s55, v214
    v_exp_f32 v211, v214
    s_nop 0
    v_mul_f32 v209, v209, v211
    v_mul_f32 v210, v210, v211
    v_mov_b32 v208, v213
    s_mov_b32 s50, 1
A_nren:
    ds_read_b64_tr_b16 v[192:193], v207 offset:4096
    ds_read_b64_tr_b16 v[194:195], v207 offset:6144
    s_waitcnt lgkmcnt(6)
    v_mfma_f32_32x32x16_bf16 v[36:51], v[180:183], v[104:107], v[36:51]
    ds_read_b64_tr_b16 v[180:181], v204 offset:8192
    ds_read_b64_tr_b16 v[182:183], v204 offset:10240
    s_waitcnt lgkmcnt(6)
    v_mfma_f32_32x32x16_bf16 v[52:67], v[184:187], v[104:107], v[52:67]
    v_mul_f32 v212, s48, v208
    v_fma_f32 v132, v132, s48, -v212
    v_exp_f32 v132, v132
    ds_read_b64_tr_b16 v[184:185], v205 offset:8192
    ds_read_b64_tr_b16 v[186:187], v205 offset:10240
    s_waitcnt lgkmcnt(6)
    v_mfma_f32_32x32x16_bf16 v[68:83], v[188:191], v[104:107], v[68:83]
    v_add_f32 v209, v209, v132
    v_fma_f32 v133, v133, s48, -v212
    v_exp_f32 v133, v133
    s_nop 0
    v_add_f32 v210, v210, v133
    v_cvt_pk_bf16_f32 v132, v132, v133
    v_fma_f32 v134, v134, s48, -v212
    ds_read_b64_tr_b16 v[188:189], v206 offset:8192
    ds_read_b64_tr_b16 v[190:191], v206 offset:10240
    s_waitcnt lgkmcnt(6)
    v_mfma_f32_32x32x16_bf16 v[84:99], v[192:195], v[104:107], v[84:99]
    v_exp_f32 v134, v134
    s_nop 0
    v_add_f32 v209, v209, v134
    v_fma_f32 v135, v135, s48, -v212
    v_exp_f32 v135, v135
    s_nop 0
    v_add_f32 v210, v210, v135
    ds_read_b64_tr_b16 v[192:193], v207 offset:8192
    ds_read_b64_tr_b16 v[194:195], v207 offset:10240
    s_waitcnt lgkmcnt(6)
    v_mfma_f32_32x32x16_bf16 v[36:51], v[180:183], v[116:119], v[36:51]
    v_cvt_pk_bf16_f32 v133, v134, v135
    v_fma_f32 v136, v136, s48, -v212
    v_exp_f32 v136, v136
    s_nop 0
    v_add_f32 v209, v209, v136
    v_fma_f32 v137, v137, s48, -v212
    ds_read_b64_tr_b16 v[180:181], v204 offset:12288
    ds_read_b64_tr_b16 v[182:183], v204 offset:14336
    s_waitcnt lgkmcnt(6)
    v_mfma_f32_32x32x16_bf16 v[52:67], v[184:187], v[116:119], v[52:67]
    v_exp_f32 v137, v137
    s_nop 0
    v_add_f32 v210, v210, v137
    v_cvt_pk_bf16_f32 v134, v136, v137
    v_fma_f32 v138, v138, s48, -v212
    v_exp_f32 v138, v138
    s_nop 0
    v_add_f32 v209, v209, v138
    ds_read_b64_tr_b16 v[184:185], v205 offset:12288
    ds_read_b64_tr_b16 v[186:187], v205 offset:14336
    s_waitcnt lgkmcnt(6)
    v_mfma_f32_32x32x16_bf16 v[68:83], v[188:191], v[116:119], v[68:83]
    v_fma_f32 v139, v139, s48, -v212
    v_exp_f32 v139, v139
    s_nop 0
    v_add_f32 v210, v210, v139
    v_cvt_pk_bf16_f32 v135, v138, v139
    v_fma_f32 v140, v140, s48, -v212
    ds_read_b64_tr_b16 v[188:189], v206 offset:12288
    ds_read_b64_tr_b16 v[190:191], v206 offset:14336
    s_waitcnt lgkmcnt(6)
    v_mfma_f32_32x32x16_bf16 v[84:99], v[192:195], v[116:119], v[84:99]
    v_exp_f32 v140, v140
    s_nop 0
    v_add_f32 v209, v209, v140
    v_fma_f32 v141, v141, s48, -v212
    v_exp_f32 v141, v141
    s_nop 0
    v_add_f32 v210, v210, v141
    v_cvt_pk_bf16_f32 v136, v140, v141
    ds_read_b64_tr_b16 v[192:193], v207 offset:12288
    ds_read_b64_tr_b16 v[194:195], v207 offset:14336
    s_waitcnt lgkmcnt(6)
    v_mfma_f32_32x32x16_bf16 v[36:51], v[180:183], v[120:123], v[36:51]
    v_fma_f32 v142, v142, s48, -v212
    v_exp_f32 v142, v142
    s_nop 0
    v_add_f32 v209, v209, v142
    v_fma_f32 v143, v143, s48, -v212
    v_exp_f32 v143, v143
    s_waitcnt lgkmcnt(4)
    v_mfma_f32_32x32x16_bf16 v[52:67], v[184:187], v[120:123], v[52:67]
    v_add_f32 v210, v210, v143
    v_cvt_pk_bf16_f32 v137, v142, v143
    v_fma_f32 v144, v144, s48, -v212
    v_exp_f32 v144, v144
    s_nop 0
    v_add_f32 v209, v209, v144
    v_fma_f32 v145, v145, s48, -v212
    s_waitcnt lgkmcnt(2)
    v_mfma_f32_32x32x16_bf16 v[68:83], v[188:191], v[120:123], v[68:83]
    v_exp_f32 v145, v145
    s_nop 0
    v_add_f32 v210, v210, v145
    v_cvt_pk_bf16_f32 v138, v144, v145
    v_fma_f32 v146, v146, s48, -v212
    v_exp_f32 v146, v146
    s_waitcnt lgkmcnt(0)
    v_mfma_f32_32x32x16_bf16 v[84:99], v[192:195], v[120:123], v[84:99]
    v_add_f32 v209, v209, v146
    v_fma_f32 v147, v147, s48, -v212
    v_exp_f32 v147, v147
    s_nop 0
    v_add_f32 v210, v210, v147
    v_cvt_pk_bf16_f32 v139, v146, v147
    s_waitcnt lgkmcnt(0)
    s_barrier
    v_xor_b32 v196, 0x8000, v196
    v_xor_b32 v197, 0x8000, v197
    v_xor_b32 v198, 0x8000, v198
    v_xor_b32 v199, 0x8000, v199
    v_xor_b32 v200, 0x8000, v200
    v_xor_b32 v201, 0x8000, v201
    v_xor_b32 v202, 0x8000, v202
    v_xor_b32 v203, 0x8000, v203
    ds_read_b128 v[164:167], v196 offset:0
    ds_read_b128 v[168:171], v197 offset:0
    ds_read_b128 v[172:175], v198 offset:0
    ds_read_b128 v[176:179], v199 offset:0
    s_waitcnt lgkmcnt(3)
    v_mfma_f32_32x32x16_bf16 v[100:115], v[164:167], v[4:7], 0
    s_cmp_eq_u32 s50, 0
    s_cbranch_scc1 A_nooc
    v_mul_f32 v36, v36, v211
    v_mul_f32 v37, v37, v211
    v_mul_f32 v38, v38, v211
    v_mul_f32 v39, v39, v211
    v_mul_f32 v40, v40, v211
    v_mul_f32 v41, v41, v211
    v_mul_f32 v42, v42, v211
    v_mul_f32 v43, v43, v211
    v_mul_f32 v44, v44, v211
    v_mul_f32 v45, v45, v211
    v_mul_f32 v46, v46, v211
    v_mul_f32 v47, v47, v211
    v_mul_f32 v48, v48, v211
    v_mul_f32 v49, v49, v211
    v_mul_f32 v50, v50, v211
    v_mul_f32 v51, v51, v211
    v_mul_f32 v52, v52, v211
    v_mul_f32 v53, v53, v211
    v_mul_f32 v54, v54, v211
    v_mul_f32 v55, v55, v211
    v_mul_f32 v56, v56, v211
    v_mul_f32 v57, v57, v211
    v_mul_f32 v58, v58, v211
    v_mul_f32 v59, v59, v211
    v_mul_f32 v60, v60, v211
    v_mul_f32 v61, v61, v211
    v_mul_f32 v62, v62, v211
    v_mul_f32 v63, v63, v211
    v_mul_f32 v64, v64, v211
    v_mul_f32 v65, v65, v211
    v_mul_f32 v66, v66, v211
    v_mul_f32 v67, v67, v211
    v_mul_f32 v68, v68, v211
    v_mul_f32 v69, v69, v211
    v_mul_f32 v70, v70, v211
    v_mul_f32 v71, v71, v211
    v_mul_f32 v72, v72, v211
    v_mul_f32 v73, v73, v211
    v_mul_f32 v74, v74, v211
    v_mul_f32 v75, v75, v211
    v_mul_f32 v76, v76, v211
    v_mul_f32 v77, v77, v211
    v_mul_f32 v78, v78, v211
    v_mul_f32 v79, v79, v211
    v_mul_f32 v80, v80, v211
    v_mul_f32 v81, v81, v211
    v_mul_f32 v82, v82, v211
    v_mul_f32 v83, v83, v211
    v_mul_f32 v84, v84, v211
    v_mul_f32 v85, v85, v211
    v_mul_f32 v86, v86, v211
    v_mul_f32 v87, v87, v211
    v_mul_f32 v88, v88, v211
    v_mul_f32 v89, v89, v211
    v_mul_f32 v90, v90, v211
    v_mul_f32 v91, v91, v211
    v_mul_f32 v92, v92, v211
    v_mul_f32 v93, v93, v211
    v_mul_f32 v94, v94, v211
    v_mul_f32 v95, v95, v211
    v_mul_f32 v96, v96, v211
    v_mul_f32 v97, v97, v211
    v_mul_f32 v98, v98, v211
    v_mul_f32 v99, v99, v211
    s_mov_b32 s50, 0
A_nooc:
    ds_read_b128 v[164:167], v200 offset:0
    s_waitcnt lgkmcnt(3)
    v_mfma_f32_32x32x16_bf16 v[100:115], v[168:171], v[8:11], v[100:115]
    ds_read_b128 v[168:171], v201 offset:0
    s_waitcnt lgkmcnt(3)
    v_mfma_f32_32x32x16_bf16 v[100:115], v[172:175], v[12:15], v[100:115]
    ds_read_b128 v[172:175], v202 offset:0
    s_waitcnt lgkmcnt(3)
    v_mfma_f32_32x32x16_bf16 v[100:115], v[176:179], v[16:19], v[100:115]
    ds_read_b128 v[176:179], v203 offset:0
    s_waitcnt lgkmcnt(3)
    v_mfma_f32_32x32x16_bf16 v[100:115], v[164:167], v[20:23], v[100:115]
    ds_read_b128 v[164:167], v196 offset:8192
    s_waitcnt lgkmcnt(3)
    v_mfma_f32_32x32x16_bf16 v[100:115], v[168:171], v[24:27], v[100:115]
    ds_read_b128 v[168:171], v197 offset:8192
    s_waitcnt lgkmcnt(3)
    v_mfma_f32_32x32x16_bf16 v[100:115], v[172:175], v[28:31], v[100:115]
    ds_read_b128 v[172:175], v198 offset:8192
    s_waitcnt lgkmcnt(3)
    v_mfma_f32_32x32x16_bf16 v[100:115], v[176:179], v[32:35], v[100:115]
    ds_read_b128 v[176:179], v199 offset:8192
    s_waitcnt lgkmcnt(3)
    v_mfma_f32_32x32x16_bf16 v[116:131], v[164:167], v[4:7], 0
    v_fma_f32 v148, v148, s48, -v212
    v_exp_f32 v148, v148
    ds_read_b128 v[164:167], v200 offset:8192
    s_waitcnt lgkmcnt(3)
    v_mfma_f32_32x32x16_bf16 v[116:131], v[168:171], v[8:11], v[116:131]
    v_add_f32 v209, v209, v148
    v_fma_f32 v149, v149, s48, -v212
    v_exp_f32 v149, v149
    s_nop 0
    v_add_f32 v210, v210, v149
    v_cvt_pk_bf16_f32 v148, v148, v149
    v_fma_f32 v150, v150, s48, -v212
    v_exp_f32 v150, v150
    s_nop 0
    v_add_f32 v209, v209, v150
    ds_read_b128 v[168:171], v201 offset:8192
    s_waitcnt lgkmcnt(3)
    v_mfma_f32_32x32x16_bf16 v[116:131], v[172:175], v[12:15], v[116:131]
    v_fma_f32 v151, v151, s48, -v212
    v_exp_f32 v151, v151
    s_nop 0
    v_add_f32 v210, v210, v151
    v_cvt_pk_bf16_f32 v149, v150, v151
    v_fma_f32 v152, v152, s48, -v212
    v_exp_f32 v152, v152
    s_nop 0
    v_add_f32 v209, v209, v152
    v_fma_f32 v153, v153, s48, -v212
    ds_read_b128 v[172:175], v202 offset:8192
    s_waitcnt lgkmcnt(3)
    v_mfma_f32_32x32x16_bf16 v[116:131], v[176:179], v[16:19], v[116:131]
    v_exp_f32 v153, v153
    s_nop 0
    v_add_f32 v210, v210, v153
    v_cvt_pk_bf16_f32 v150, v152, v153
    v_fma_f32 v154, v154, s48, -v212
    v_exp_f32 v154, v154
    s_nop 0
    v_add_f32 v209, v209, v154
    v_fma_f32 v155, v155, s48, -v212
    ds_read_b128 v[176:179], v203 offset:8192
    s_waitcnt lgkmcnt(3)
    v_mfma_f32_32x32x16_bf16 v[116:131], v[164:167], v[20:23], v[116:131]
    v_exp_f32 v155, v155
    s_nop 0
    v_add_f32 v210, v210, v155
    v_cvt_pk_bf16_f32 v151, v154, v155
    v_fma_f32 v156, v156, s48, -v212
    v_exp_f32 v156, v156
    s_nop 0
    v_add_f32 v209, v209, v156
    v_fma_f32 v157, v157, s48, -v212
    v_exp_f32 v157, v157
    ds_read_b64_tr_b16 v[180:181], v204 offset:16384
    ds_read_b64_tr_b16 v[182:183], v204 offset:18432
    s_waitcnt lgkmcnt(4)
    v_mfma_f32_32x32x16_bf16 v[116:131], v[168:171], v[24:27], v[116:131]
    v_add_f32 v210, v210, v157
    v_cvt_pk_bf16_f32 v152, v156, v157
    v_fma_f32 v158, v158, s48, -v212
    v_exp_f32 v158, v158
    s_nop 0
    v_add_f32 v209, v209, v158
    v_fma_f32 v159, v159, s48, -v212
    v_exp_f32 v159, v159
    s_nop 0
    v_add_f32 v210, v210, v159
    ds_read_b64_tr_b16 v[184:185], v205 offset:16384
    ds_read_b64_tr_b16 v[186:187], v205 offset:18432
    s_waitcnt lgkmcnt(5)
    v_mfma_f32_32x32x16_bf16 v[116:131], v[172:175], v[28:31], v[116:131]
    v_cvt_pk_bf16_f32 v153, v158, v159
    v_fma_f32 v160, v160, s48, -v212
    v_exp_f32 v160, v160
    s_nop 0
    v_add_f32 v209, v209, v160
    v_fma_f32 v161, v161, s48, -v212
    v_exp_f32 v161, v161
    s_nop 0
    v_add_f32 v210, v210, v161
    v_cvt_pk_bf16_f32 v154, v160, v161
    ds_read_b64_tr_b16 v[188:189], v206 offset:16384
    ds_read_b64_tr_b16 v[190:191], v206 offset:18432
    s_waitcnt lgkmcnt(6)
    v_mfma_f32_32x32x16_bf16 v[116:131], v[176:179], v[32:35], v[116:131]
    v_fma_f32 v162, v162, s48, -v212
    v_exp_f32 v162, v162
    s_nop 0
    v_add_f32 v209, v209, v162
    v_fma_f32 v163, v163, s48, -v212
    v_exp_f32 v163, v163
    s_nop 0
    v_add_f32 v210, v210, v163
    v_cvt_pk_bf16_f32 v155, v162, v163
    ds_read_b64_tr_b16 v[192:193], v207 offset:16384
    ds_read_b64_tr_b16 v[194:195], v207 offset:18432
    s_waitcnt lgkmcnt(6)
    v_mfma_f32_32x32x16_bf16 v[36:51], v[180:183], v[132:135], v[36:51]
    v_max3_f32 v213, v100, v101, v102
    v_max3_f32 v214, v103, v104, v105
    v_max3_f32 v215, v106, v107, v108
    v_max3_f32 v216, v109, v110, v111
    v_max3_f32 v217, v112, v113, v114
    v_max3_f32 v218, v115, v116, v117
    ds_read_b64_tr_b16 v[180:181], v204 offset:20480
    ds_read_b64_tr_b16 v[182:183], v204 offset:22528
    s_waitcnt lgkmcnt(6)
    v_mfma_f32_32x32x16_bf16 v[52:67], v[184:187], v[132:135], v[52:67]
    v_max3_f32 v219, v118, v119, v120
    v_max3_f32 v220, v121, v122, v123
    v_max3_f32 v213, v213, v124, v125
    v_max3_f32 v214, v214, v126, v127
    v_max3_f32 v215, v215, v128, v129
    ds_read_b64_tr_b16 v[184:185], v205 offset:20480
    ds_read_b64_tr_b16 v[186:187], v205 offset:22528
    s_waitcnt lgkmcnt(6)
    v_mfma_f32_32x32x16_bf16 v[68:83], v[188:191], v[132:135], v[68:83]
    v_max3_f32 v216, v216, v130, v131
    v_max3_f32 v213, v213, v214, v215
    v_max3_f32 v216, v216, v217, v218
    v_max3_f32 v213, v213, v219, v220
    v_max_f32 v213, v213, v216
    v_mov_b32 v214, v213
    ds_read_b64_tr_b16 v[188:189], v206 offset:20480
    ds_read_b64_tr_b16 v[190:191], v206 offset:22528
    s_waitcnt lgkmcnt(6)
    v_mfma_f32_32x32x16_bf16 v[84:99], v[192:195], v[132:135], v[84:99]
    v_permlane32_swap_b32 v213, v214
    v_max3_f32 v213, v213, v214, v208
    v_sub_f32 v214, v213, v208
    v_cmp_lt_f32 vcc, s49, v214
    s_nop 1
    s_cbranch_vccz A_nron
    v_mul_f32 v214, s55, v214
    v_exp_f32 v211, v214
    s_nop 0
    v_mul_f32 v209, v209, v211
    v_mul_f32 v210, v210, v211
    v_mov_b32 v208, v213
    s_mov_b32 s50, 1
A_nron:
    ds_read_b64_tr_b16 v[192:193], v207 offset:20480
    ds_read_b64_tr_b16 v[194:195], v207 offset:22528
    s_waitcnt lgkmcnt(6)
    v_mfma_f32_32x32x16_bf16 v[36:51], v[180:183], v[136:139], v[36:51]
    ds_read_b64_tr_b16 v[180:181], v204 offset:24576
    ds_read_b64_tr_b16 v[182:183], v204 offset:26624
    s_waitcnt lgkmcnt(6)
    v_mfma_f32_32x32x16_bf16 v[52:67], v[184:187], v[136:139], v[52:67]
    v_mul_f32 v212, s48, v208
    v_fma_f32 v100, v100, s48, -v212
    v_exp_f32 v100, v100
    ds_read_b64_tr_b16 v[184:185], v205 offset:24576
    ds_read_b64_tr_b16 v[186:187], v205 offset:26624
    s_waitcnt lgkmcnt(6)
    v_mfma_f32_32x32x16_bf16 v[68:83], v[188:191], v[136:139], v[68:83]
    v_add_f32 v209, v209, v100
    v_fma_f32 v101, v101, s48, -v212
    v_exp_f32 v101, v101
    s_nop 0
    v_add_f32 v210, v210, v101
    v_cvt_pk_bf16_f32 v100, v100, v101
    v_fma_f32 v102, v102, s48, -v212
    ds_read_b64_tr_b16 v[188:189], v206 offset:24576
    ds_read_b64_tr_b16 v[190:191], v206 offset:26624
    s_waitcnt lgkmcnt(6)
    v_mfma_f32_32x32x16_bf16 v[84:99], v[192:195], v[136:139], v[84:99]
    v_exp_f32 v102, v102
    s_nop 0
    v_add_f32 v209, v209, v102
    v_fma_f32 v103, v103, s48, -v212
    v_exp_f32 v103, v103
    s_nop 0
    v_add_f32 v210, v210, v103
    ds_read_b64_tr_b16 v[192:193], v207 offset:24576
    ds_read_b64_tr_b16 v[194:195], v207 offset:26624
    s_waitcnt lgkmcnt(6)
    v_mfma_f32_32x32x16_bf16 v[36:51], v[180:183], v[148:151], v[36:51]
    v_cvt_pk_bf16_f32 v101, v102, v103
    v_fma_f32 v104, v104, s48, -v212
    v_exp_f32 v104, v104
    s_nop 0
    v_add_f32 v209, v209, v104
    v_fma_f32 v105, v105, s48, -v212
    ds_read_b64_tr_b16 v[180:181], v204 offset:28672
    ds_read_b64_tr_b16 v[182:183], v204 offset:30720
    s_waitcnt lgkmcnt(6)
    v_mfma_f32_32x32x16_bf16 v[52:67], v[184:187], v[148:151], v[52:67]
    v_exp_f32 v105, v105
    s_nop 0
    v_add_f32 v210, v210, v105
    v_cvt_pk_bf16_f32 v102, v104, v105
    v_fma_f32 v106, v106, s48, -v212
    v_exp_f32 v106, v106
    s_nop 0
    v_add_f32 v209, v209, v106
    ds_read_b64_tr_b16 v[184:185], v205 offset:28672
    ds_read_b64_tr_b16 v[186:187], v205 offset:30720
    s_waitcnt lgkmcnt(6)
    v_mfma_f32_32x32x16_bf16 v[68:83], v[188:191], v[148:151], v[68:83]
    v_fma_f32 v107, v107, s48, -v212
    v_exp_f32 v107, v107
    s_nop 0
    v_add_f32 v210, v210, v107
    v_cvt_pk_bf16_f32 v103, v106, v107
    v_fma_f32 v108, v108, s48, -v212
    ds_read_b64_tr_b16 v[188:189], v206 offset:28672
    ds_read_b64_tr_b16 v[190:191], v206 offset:30720
    s_waitcnt lgkmcnt(6)
    v_mfma_f32_32x32x16_bf16 v[84:99], v[192:195], v[148:151], v[84:99]
    v_exp_f32 v108, v108
    s_nop 0
    v_add_f32 v209, v209, v108
    v_fma_f32 v109, v109, s48, -v212
    v_exp_f32 v109, v109
    s_nop 0
    v_add_f32 v210, v210, v109
    v_cvt_pk_bf16_f32 v104, v108, v109
    ds_read_b64_tr_b16 v[192:193], v207 offset:28672
    ds_read_b64_tr_b16 v[194:195], v207 offset:30720
    s_waitcnt lgkmcnt(6)
    v_mfma_f32_32x32x16_bf16 v[36:51], v[180:183], v[152:155], v[36:51]
    v_fma_f32 v110, v110, s48, -v212
    v_exp_f32 v110, v110
    s_nop 0
    v_add_f32 v209, v209, v110
    v_fma_f32 v111, v111, s48, -v212
    v_exp_f32 v111, v111
    s_waitcnt lgkmcnt(4)
    v_mfma_f32_32x32x16_bf16 v[52:67], v[184:187], v[152:155], v[52:67]
    v_add_f32 v210, v210, v111
    v_cvt_pk_bf16_f32 v105, v110, v111
    v_fma_f32 v112, v112, s48, -v212
    v_exp_f32 v112, v112
    s_nop 0
    v_add_f32 v209, v209, v112
    v_fma_f32 v113, v113, s48, -v212
    s_waitcnt lgkmcnt(2)
    v_mfma_f32_32x32x16_bf16 v[68:83], v[188:191], v[152:155], v[68:83]
    v_exp_f32 v113, v113
    s_nop 0
    v_add_f32 v210, v210, v113
    v_cvt_pk_bf16_f32 v106, v112, v113
    v_fma_f32 v114, v114, s48, -v212
    v_exp_f32 v114, v114
    s_waitcnt lgkmcnt(0)
    v_mfma_f32_32x32x16_bf16 v[84:99], v[192:195], v[152:155], v[84:99]
    v_add_f32 v209, v209, v114
    v_fma_f32 v115, v115, s48, -v212
    v_exp_f32 v115, v115
    s_nop 0
    v_add_f32 v210, v210, v115
    v_cvt_pk_bf16_f32 v107, v114, v115
    s_waitcnt lgkmcnt(0)
    s_barrier
    v_xor_b32 v204, 0x8000, v204
    v_xor_b32 v205, 0x8000, v205
    v_xor_b32 v206, 0x8000, v206
    v_xor_b32 v207, 0x8000, v207
    s_add_u32 s51, s51, 1
    s_cmp_lt_u32 s51, 7
    s_cbranch_scc1 A_bloop
    ds_read_b128 v[164:167], v196 offset:16384
    ds_read_b128 v[168:171], v197 offset:16384
    ds_read_b128 v[172:175], v198 offset:16384
    ds_read_b128 v[176:179], v199 offset:16384
    s_waitcnt lgkmcnt(3)
    v_mfma_f32_32x32x16_bf16 v[132:147], v[164:167], v[4:7], 0
    s_cmp_eq_u32 s50, 0
    s_cbranch_scc1 A_noe2c
    v_mul_f32 v36, v36, v211
    v_mul_f32 v37, v37, v211
    v_mul_f32 v38, v38, v211
    v_mul_f32 v39, v39, v211
    v_mul_f32 v40, v40, v211
    v_mul_f32 v41, v41, v211
    v_mul_f32 v42, v42, v211
    v_mul_f32 v43, v43, v211
    v_mul_f32 v44, v44, v211
    v_mul_f32 v45, v45, v211
    v_mul_f32 v46, v46, v211
    v_mul_f32 v47, v47, v211
    v_mul_f32 v48, v48, v211
    v_mul_f32 v49, v49, v211
    v_mul_f32 v50, v50, v211
    v_mul_f32 v51, v51, v211
    v_mul_f32 v52, v52, v211
    v_mul_f32 v53, v53, v211
    v_mul_f32 v54, v54, v211
    v_mul_f32 v55, v55, v211
    v_mul_f32 v56, v56, v211
    v_mul_f32 v57, v57, v211
    v_mul_f32 v58, v58, v211
    v_mul_f32 v59, v59, v211
    v_mul_f32 v60, v60, v211
    v_mul_f32 v61, v61, v211
    v_mul_f32 v62, v62, v211
    v_mul_f32 v63, v63, v211
    v_mul_f32 v64, v64, v211
    v_mul_f32 v65, v65, v211
    v_mul_f32 v66, v66, v211
    v_mul_f32 v67, v67, v211
    v_mul_f32 v68, v68, v211
    v_mul_f32 v69, v69, v211
    v_mul_f32 v70, v70, v211
    v_mul_f32 v71, v71, v211
    v_mul_f32 v72, v72, v211
    v_mul_f32 v73, v73, v211
    v_mul_f32 v74, v74, v211
    v_mul_f32 v75, v75, v211
    v_mul_f32 v76, v76, v211
    v_mul_f32 v77, v77, v211
    v_mul_f32 v78, v78, v211
    v_mul_f32 v79, v79, v211
    v_mul_f32 v80, v80, v211
    v_mul_f32 v81, v81, v211
    v_mul_f32 v82, v82, v211
    v_mul_f32 v83, v83, v211
    v_mul_f32 v84, v84, v211
    v_mul_f32 v85, v85, v211
    v_mul_f32 v86, v86, v211
    v_mul_f32 v87, v87, v211
    v_mul_f32 v88, v88, v211
    v_mul_f32 v89, v89, v211
    v_mul_f32 v90, v90, v211
    v_mul_f32 v91, v91, v211
    v_mul_f32 v92, v92, v211
    v_mul_f32 v93, v93, v211
    v_mul_f32 v94, v94, v211
    v_mul_f32 v95, v95, v211
    v_mul_f32 v96, v96, v211
    v_mul_f32 v97, v97, v211
    v_mul_f32 v98, v98, v211
    v_mul_f32 v99, v99, v211
    s_mov_b32 s50, 0
A_noe2c:
    ds_read_b128 v[164:167], v200 offset:16384
    s_waitcnt lgkmcnt(3)
    v_mfma_f32_32x32x16_bf16 v[132:147], v[168:171], v[8:11], v[132:147]
    ds_read_b128 v[168:171], v201 offset:16384
    s_waitcnt lgkmcnt(3)
    v_mfma_f32_32x32x16_bf16 v[132:147], v[172:175], v[12:15], v[132:147]
    ds_read_b128 v[172:175], v202 offset:16384
    s_waitcnt lgkmcnt(3)
    v_mfma_f32_32x32x16_bf16 v[132:147], v[176:179], v[16:19], v[132:147]
    ds_read_b128 v[176:179], v203 offset:16384
    s_waitcnt lgkmcnt(3)
    v_mfma_f32_32x32x16_bf16 v[132:147], v[164:167], v[20:23], v[132:147]
    ds_read_b128 v[164:167], v196 offset:24576
    s_waitcnt lgkmcnt(3)
    v_mfma_f32_32x32x16_bf16 v[132:147], v[168:171], v[24:27], v[132:147]
    ds_read_b128 v[168:171], v197 offset:24576
    s_waitcnt lgkmcnt(3)
    v_mfma_f32_32x32x16_bf16 v[132:147], v[172:175], v[28:31], v[132:147]
    ds_read_b128 v[172:175], v198 offset:24576
    s_waitcnt lgkmcnt(3)
    v_mfma_f32_32x32x16_bf16 v[132:147], v[176:179], v[32:35], v[132:147]
    ds_read_b128 v[176:179], v199 offset:24576
    s_waitcnt lgkmcnt(3)
    v_mfma_f32_32x32x16_bf16 v[148:163], v[164:167], v[4:7], 0
    v_fma_f32 v116, v116, s48, -v212
    v_exp_f32 v116, v116
    ds_read_b128 v[164:167], v200 offset:24576
    s_waitcnt lgkmcnt(3)
    v_mfma_f32_32x32x16_bf16 v[148:163], v[168:171], v[8:11], v[148:163]
    v_add_f32 v209, v209, v116
    v_fma_f32 v117, v117, s48, -v212
    v_exp_f32 v117, v117
    s_nop 0
    v_add_f32 v210, v210, v117
    v_cvt_pk_bf16_f32 v116, v116, v117
    v_fma_f32 v118, v118, s48, -v212
    v_exp_f32 v118, v118
    s_nop 0
    v_add_f32 v209, v209, v118
    ds_read_b128 v[168:171], v201 offset:24576
    s_waitcnt lgkmcnt(3)
    v_mfma_f32_32x32x16_bf16 v[148:163], v[172:175], v[12:15], v[148:163]
    v_fma_f32 v119, v119, s48, -v212
    v_exp_f32 v119, v119
    s_nop 0
    v_add_f32 v210, v210, v119
    v_cvt_pk_bf16_f32 v117, v118, v119
    v_fma_f32 v120, v120, s48, -v212
    v_exp_f32 v120, v120
    s_nop 0
    v_add_f32 v209, v209, v120
    v_fma_f32 v121, v121, s48, -v212
    ds_read_b128 v[172:175], v202 offset:24576
    s_waitcnt lgkmcnt(3)
    v_mfma_f32_32x32x16_bf16 v[148:163], v[176:179], v[16:19], v[148:163]
    v_exp_f32 v121, v121
    s_nop 0
    v_add_f32 v210, v210, v121
    v_cvt_pk_bf16_f32 v118, v120, v121
    v_fma_f32 v122, v122, s48, -v212
    v_exp_f32 v122, v122
    s_nop 0
    v_add_f32 v209, v209, v122
    v_fma_f32 v123, v123, s48, -v212
    ds_read_b128 v[176:179], v203 offset:24576
    s_waitcnt lgkmcnt(3)
    v_mfma_f32_32x32x16_bf16 v[148:163], v[164:167], v[20:23], v[148:163]
    v_exp_f32 v123, v123
    s_nop 0
    v_add_f32 v210, v210, v123
    v_cvt_pk_bf16_f32 v119, v122, v123
    v_fma_f32 v124, v124, s48, -v212
    v_exp_f32 v124, v124
    s_nop 0
    v_add_f32 v209, v209, v124
    v_fma_f32 v125, v125, s48, -v212
    v_exp_f32 v125, v125
    ds_read_b64_tr_b16 v[180:181], v204 offset:0
    ds_read_b64_tr_b16 v[182:183], v204 offset:2048
    s_waitcnt lgkmcnt(4)
    v_mfma_f32_32x32x16_bf16 v[148:163], v[168:171], v[24:27], v[148:163]
    v_add_f32 v210, v210, v125
    v_cvt_pk_bf16_f32 v120, v124, v125
    v_fma_f32 v126, v126, s48, -v212
    v_exp_f32 v126, v126
    s_nop 0
    v_add_f32 v209, v209, v126
    v_fma_f32 v127, v127, s48, -v212
    v_exp_f32 v127, v127
    s_nop 0
    v_add_f32 v210, v210, v127
    ds_read_b64_tr_b16 v[184:185], v205 offset:0
    ds_read_b64_tr_b16 v[186:187], v205 offset:2048
    s_waitcnt lgkmcnt(5)
    v_mfma_f32_32x32x16_bf16 v[148:163], v[172:175], v[28:31], v[148:163]
    v_cvt_pk_bf16_f32 v121, v126, v127
    v_fma_f32 v128, v128, s48, -v212
    v_exp_f32 v128, v128
    s_nop 0
    v_add_f32 v209, v209, v128
    v_fma_f32 v129, v129, s48, -v212
    v_exp_f32 v129, v129
    s_nop 0
    v_add_f32 v210, v210, v129
    v_cvt_pk_bf16_f32 v122, v128, v129
    ds_read_b64_tr_b16 v[188:189], v206 offset:0
    ds_read_b64_tr_b16 v[190:191], v206 offset:2048
    s_waitcnt lgkmcnt(6)
    v_mfma_f32_32x32x16_bf16 v[148:163], v[176:179], v[32:35], v[148:163]
    v_fma_f32 v130, v130, s48, -v212
    v_exp_f32 v130, v130
    s_nop 0
    v_add_f32 v209, v209, v130
    v_fma_f32 v131, v131, s48, -v212
    v_exp_f32 v131, v131
    s_nop 0
    v_add_f32 v210, v210, v131
    v_cvt_pk_bf16_f32 v123, v130, v131
    ds_read_b64_tr_b16 v[192:193], v207 offset:0
    ds_read_b64_tr_b16 v[194:195], v207 offset:2048
    s_waitcnt lgkmcnt(6)
    v_mfma_f32_32x32x16_bf16 v[36:51], v[180:183], v[100:103], v[36:51]
    v_max3_f32 v213, v132, v133, v134
    v_max3_f32 v214, v135, v136, v137
    v_max3_f32 v215, v138, v139, v140
    v_max3_f32 v216, v141, v142, v143
    v_max3_f32 v217, v144, v145, v146
    v_max3_f32 v218, v147, v148, v149
    ds_read_b64_tr_b16 v[180:181], v204 offset:4096
    ds_read_b64_tr_b16 v[182:183], v204 offset:6144
    s_waitcnt lgkmcnt(6)
    v_mfma_f32_32x32x16_bf16 v[52:67], v[184:187], v[100:103], v[52:67]
    v_max3_f32 v219, v150, v151, v152
    v_max3_f32 v220, v153, v154, v155
    v_max3_f32 v213, v213, v156, v157
    v_max3_f32 v214, v214, v158, v159
    v_max3_f32 v215, v215, v160, v161
    ds_read_b64_tr_b16 v[184:185], v205 offset:4096
    ds_read_b64_tr_b16 v[186:187], v205 offset:6144
    s_waitcnt lgkmcnt(6)
    v_mfma_f32_32x32x16_bf16 v[68:83], v[188:191], v[100:103], v[68:83]
    v_max3_f32 v216, v216, v162, v163
    v_max3_f32 v213, v213, v214, v215
    v_max3_f32 v216, v216, v217, v218
    v_max3_f32 v213, v213, v219, v220
    v_max_f32 v213, v213, v216
    v_mov_b32 v214, v213
    ds_read_b64_tr_b16 v[188:189], v206 offset:4096
    ds_read_b64_tr_b16 v[190:191], v206 offset:6144
    s_waitcnt lgkmcnt(6)
    v_mfma_f32_32x32x16_bf16 v[84:99], v[192:195], v[100:103], v[84:99]
    v_permlane32_swap_b32 v213, v214
    v_max3_f32 v213, v213, v214, v208
    v_sub_f32 v214, v213, v208
    v_cmp_lt_f32 vcc, s49, v214
    s_nop 1
    s_cbranch_vccz A_nre2n
    v_mul_f32 v214, s55, v214
    v_exp_f32 v211, v214
    s_nop 0
    v_mul_f32 v209, v209, v211
    v_mul_f32 v210, v210, v211
    v_mov_b32 v208, v213
    s_mov_b32 s50, 1
A_nre2n:
    ds_read_b64_tr_b16 v[192:193], v207 offset:4096
    ds_read_b64_tr_b16 v[194:195], v207 offset:6144
    s_waitcnt lgkmcnt(6)
    v_mfma_f32_32x32x16_bf16 v[36:51], v[180:183], v[104:107], v[36:51]
    ds_read_b64_tr_b16 v[180:181], v204 offset:8192
    ds_read_b64_tr_b16 v[182:183], v204 offset:10240
    s_waitcnt lgkmcnt(6)
    v_mfma_f32_32x32x16_bf16 v[52:67], v[184:187], v[104:107], v[52:67]
    v_mul_f32 v212, s48, v208
    v_fma_f32 v132, v132, s48, -v212
    v_exp_f32 v132, v132
    ds_read_b64_tr_b16 v[184:185], v205 offset:8192
    ds_read_b64_tr_b16 v[186:187], v205 offset:10240
    s_waitcnt lgkmcnt(6)
    v_mfma_f32_32x32x16_bf16 v[68:83], v[188:191], v[104:107], v[68:83]
    v_add_f32 v209, v209, v132
    v_fma_f32 v133, v133, s48, -v212
    v_exp_f32 v133, v133
    s_nop 0
    v_add_f32 v210, v210, v133
    v_cvt_pk_bf16_f32 v132, v132, v133
    v_fma_f32 v134, v134, s48, -v212
    ds_read_b64_tr_b16 v[188:189], v206 offset:8192
    ds_read_b64_tr_b16 v[190:191], v206 offset:10240
    s_waitcnt lgkmcnt(6)
    v_mfma_f32_32x32x16_bf16 v[84:99], v[192:195], v[104:107], v[84:99]
    v_exp_f32 v134, v134
    s_nop 0
    v_add_f32 v209, v209, v134
    v_fma_f32 v135, v135, s48, -v212
    v_exp_f32 v135, v135
    s_nop 0
    v_add_f32 v210, v210, v135
    ds_read_b64_tr_b16 v[192:193], v207 offset:8192
    ds_read_b64_tr_b16 v[194:195], v207 offset:10240
    s_waitcnt lgkmcnt(6)
    v_mfma_f32_32x32x16_bf16 v[36:51], v[180:183], v[116:119], v[36:51]
    v_cvt_pk_bf16_f32 v133, v134, v135
    v_fma_f32 v136, v136, s48, -v212
    v_exp_f32 v136, v136
    s_nop 0
    v_add_f32 v209, v209, v136
    v_fma_f32 v137, v137, s48, -v212
    ds_read_b64_tr_b16 v[180:181], v204 offset:12288
    ds_read_b64_tr_b16 v[182:183], v204 offset:14336
    s_waitcnt lgkmcnt(6)
    v_mfma_f32_32x32x16_bf16 v[52:67], v[184:187], v[116:119], v[52:67]
    v_exp_f32 v137, v137
    s_nop 0
    v_add_f32 v210, v210, v137
    v_cvt_pk_bf16_f32 v134, v136, v137
    v_fma_f32 v138, v138, s48, -v212
    v_exp_f32 v138, v138
    s_nop 0
    v_add_f32 v209, v209, v138
    ds_read_b64_tr_b16 v[184:185], v205 offset:12288
    ds_read_b64_tr_b16 v[186:187], v205 offset:14336
    s_waitcnt lgkmcnt(6)
    v_mfma_f32_32x32x16_bf16 v[68:83], v[188:191], v[116:119], v[68:83]
    v_fma_f32 v139, v139, s48, -v212
    v_exp_f32 v139, v139
    s_nop 0
    v_add_f32 v210, v210, v139
    v_cvt_pk_bf16_f32 v135, v138, v139
    v_fma_f32 v140, v140, s48, -v212
    ds_read_b64_tr_b16 v[188:189], v206 offset:12288
    ds_read_b64_tr_b16 v[190:191], v206 offset:14336
    s_waitcnt lgkmcnt(6)
    v_mfma_f32_32x32x16_bf16 v[84:99], v[192:195], v[116:119], v[84:99]
    v_exp_f32 v140, v140
    s_nop 0
    v_add_f32 v209, v209, v140
    v_fma_f32 v141, v141, s48, -v212
    v_exp_f32 v141, v141
    s_nop 0
    v_add_f32 v210, v210, v141
    v_cvt_pk_bf16_f32 v136, v140, v141
    ds_read_b64_tr_b16 v[192:193], v207 offset:12288
    ds_read_b64_tr_b16 v[194:195], v207 offset:14336
    s_waitcnt lgkmcnt(6)
    v_mfma_f32_32x32x16_bf16 v[36:51], v[180:183], v[120:123], v[36:51]
    v_fma_f32 v142, v142, s48, -v212
    v_exp_f32 v142, v142
    s_nop 0
    v_add_f32 v209, v209, v142
    v_fma_f32 v143, v143, s48, -v212
    v_exp_f32 v143, v143
    s_waitcnt lgkmcnt(4)
    v_mfma_f32_32x32x16_bf16 v[52:67], v[184:187], v[120:123], v[52:67]
    v_add_f32 v210, v210, v143
    v_cvt_pk_bf16_f32 v137, v142, v143
    v_fma_f32 v144, v144, s48, -v212
    v_exp_f32 v144, v144
    s_nop 0
    v_add_f32 v209, v209, v144
    v_fma_f32 v145, v145, s48, -v212
    s_waitcnt lgkmcnt(2)
    v_mfma_f32_32x32x16_bf16 v[68:83], v[188:191], v[120:123], v[68:83]
    v_exp_f32 v145, v145
    s_nop 0
    v_add_f32 v210, v210, v145
    v_cvt_pk_bf16_f32 v138, v144, v145
    v_fma_f32 v146, v146, s48, -v212
    v_exp_f32 v146, v146
    s_waitcnt lgkmcnt(0)
    v_mfma_f32_32x32x16_bf16 v[84:99], v[192:195], v[120:123], v[84:99]
    v_add_f32 v209, v209, v146
    v_fma_f32 v147, v147, s48, -v212
    v_exp_f32 v147, v147
    s_nop 0
    v_add_f32 v210, v210, v147
    v_cvt_pk_bf16_f32 v139, v146, v147
    s_waitcnt lgkmcnt(0)
    s_barrier
    v_xor_b32 v196, 0x8000, v196
    v_xor_b32 v197, 0x8000, v197
    v_xor_b32 v198, 0x8000, v198
    v_xor_b32 v199, 0x8000, v199
    v_xor_b32 v200, 0x8000, v200
    v_xor_b32 v201, 0x8000, v201
    v_xor_b32 v202, 0x8000, v202
    v_xor_b32 v203, 0x8000, v203
    s_cmp_eq_u32 s50, 0
    s_cbranch_scc1 A_noo2c
    v_mul_f32 v36, v36, v211
    v_mul_f32 v37, v37, v211
    v_mul_f32 v38, v38, v211
    v_mul_f32 v39, v39, v211
    v_mul_f32 v40, v40, v211
    v_mul_f32 v41, v41, v211
    v_mul_f32 v42, v42, v211
    v_mul_f32 v43, v43, v211
    v_mul_f32 v44, v44, v211
    v_mul_f32 v45, v45, v211
    v_mul_f32 v46, v46, v211
    v_mul_f32 v47, v47, v211
    v_mul_f32 v48, v48, v211
    v_mul_f32 v49, v49, v211
    v_mul_f32 v50, v50, v211
    v_mul_f32 v51, v51, v211
    v_mul_f32 v52, v52, v211
    v_mul_f32 v53, v53, v211
    v_mul_f32 v54, v54, v211
    v_mul_f32 v55, v55, v211
    v_mul_f32 v56, v56, v211
    v_mul_f32 v57, v57, v211
    v_mul_f32 v58, v58, v211
    v_mul_f32 v59, v59, v211
    v_mul_f32 v60, v60, v211
    v_mul_f32 v61, v61, v211
    v_mul_f32 v62, v62, v211
    v_mul_f32 v63, v63, v211
    v_mul_f32 v64, v64, v211
    v_mul_f32 v65, v65, v211
    v_mul_f32 v66, v66, v211
    v_mul_f32 v67, v67, v211
    v_mul_f32 v68, v68, v211
    v_mul_f32 v69, v69, v211
    v_mul_f32 v70, v70, v211
    v_mul_f32 v71, v71, v211
    v_mul_f32 v72, v72, v211
    v_mul_f32 v73, v73, v211
    v_mul_f32 v74, v74, v211
    v_mul_f32 v75, v75, v211
    v_mul_f32 v76, v76, v211
    v_mul_f32 v77, v77, v211
    v_mul_f32 v78, v78, v211
    v_mul_f32 v79, v79, v211
    v_mul_f32 v80, v80, v211
    v_mul_f32 v81, v81, v211
    v_mul_f32 v82, v82, v211
    v_mul_f32 v83, v83, v211
    v_mul_f32 v84, v84, v211
    v_mul_f32 v85, v85, v211
    v_mul_f32 v86, v86, v211
    v_mul_f32 v87, v87, v211
    v_mul_f32 v88, v88, v211
    v_mul_f32 v89, v89, v211
    v_mul_f32 v90, v90, v211
    v_mul_f32 v91, v91, v211
    v_mul_f32 v92, v92, v211
    v_mul_f32 v93, v93, v211
    v_mul_f32 v94, v94, v211
    v_mul_f32 v95, v95, v211
    v_mul_f32 v96, v96, v211
    v_mul_f32 v97, v97, v211
    v_mul_f32 v98, v98, v211
    v_mul_f32 v99, v99, v211
    s_mov_b32 s50, 0
A_noo2c:
    v_fma_f32 v148, v148, s48, -v212
    v_exp_f32 v148, v148
    s_nop 0
    v_add_f32 v209, v209, v148
    v_fma_f32 v149, v149, s48, -v212
    v_exp_f32 v149, v149
    s_nop 0
    v_add_f32 v210, v210, v149
    v_cvt_pk_bf16_f32 v148, v148, v149
    v_fma_f32 v150, v150, s48, -v212
    v_exp_f32 v150, v150
    s_nop 0
    v_add_f32 v209, v209, v150
    v_fma_f32 v151, v151, s48, -v212
    v_exp_f32 v151, v151
    s_nop 0
    v_add_f32 v210, v210, v151
    v_cvt_pk_bf16_f32 v149, v150, v151
    v_fma_f32 v152, v152, s48, -v212
    v_exp_f32 v152, v152
    s_nop 0
    v_add_f32 v209, v209, v152
    v_fma_f32 v153, v153, s48, -v212
    v_exp_f32 v153, v153
    s_nop 0
    v_add_f32 v210, v210, v153
    v_cvt_pk_bf16_f32 v150, v152, v153
    v_fma_f32 v154, v154, s48, -v212
    v_exp_f32 v154, v154
    s_nop 0
    v_add_f32 v209, v209, v154
    v_fma_f32 v155, v155, s48, -v212
    v_exp_f32 v155, v155
    s_nop 0
    v_add_f32 v210, v210, v155
    v_cvt_pk_bf16_f32 v151, v154, v155
    v_fma_f32 v156, v156, s48, -v212
    v_exp_f32 v156, v156
    s_nop 0
    v_add_f32 v209, v209, v156
    v_fma_f32 v157, v157, s48, -v212
    v_exp_f32 v157, v157
    s_nop 0
    v_add_f32 v210, v210, v157
    v_cvt_pk_bf16_f32 v152, v156, v157
    v_fma_f32 v158, v158, s48, -v212
    v_exp_f32 v158, v158
    s_nop 0
    v_add_f32 v209, v209, v158
    v_fma_f32 v159, v159, s48, -v212
    v_exp_f32 v159, v159
    s_nop 0
    v_add_f32 v210, v210, v159
    v_cvt_pk_bf16_f32 v153, v158, v159
    v_fma_f32 v160, v160, s48, -v212
    v_exp_f32 v160, v160
    s_nop 0
    v_add_f32 v209, v209, v160
    v_fma_f32 v161, v161, s48, -v212
    v_exp_f32 v161, v161
    s_nop 0
    v_add_f32 v210, v210, v161
    v_cvt_pk_bf16_f32 v154, v160, v161
    v_fma_f32 v162, v162, s48, -v212
    v_exp_f32 v162, v162
    s_nop 0
    v_add_f32 v209, v209, v162
    v_fma_f32 v163, v163, s48, -v212
    v_exp_f32 v163, v163
    s_nop 0
    v_add_f32 v210, v210, v163
    v_cvt_pk_bf16_f32 v155, v162, v163
    ds_read_b64_tr_b16 v[180:181], v204 offset:16384
    ds_read_b64_tr_b16 v[182:183], v204 offset:18432
    ds_read_b64_tr_b16 v[184:185], v205 offset:16384
    ds_read_b64_tr_b16 v[186:187], v205 offset:18432
    ds_read_b64_tr_b16 v[188:189], v206 offset:16384
    ds_read_b64_tr_b16 v[190:191], v206 offset:18432
    ds_read_b64_tr_b16 v[192:193], v207 offset:16384
    ds_read_b64_tr_b16 v[194:195], v207 offset:18432
    s_waitcnt lgkmcnt(6)
    v_mfma_f32_32x32x16_bf16 v[36:51], v[180:183], v[132:135], v[36:51]
    ds_read_b64_tr_b16 v[180:181], v204 offset:20480
    ds_read_b64_tr_b16 v[182:183], v204 offset:22528
    s_waitcnt lgkmcnt(6)
    v_mfma_f32_32x32x16_bf16 v[52:67], v[184:187], v[132:135], v[52:67]
    ds_read_b64_tr_b16 v[184:185], v205 offset:20480
    ds_read_b64_tr_b16 v[186:187], v205 offset:22528
    s_waitcnt lgkmcnt(6)
    v_mfma_f32_32x32x16_bf16 v[68:83], v[188:191], v[132:135], v[68:83]
    ds_read_b64_tr_b16 v[188:189], v206 offset:20480
    ds_read_b64_tr_b16 v[190:191], v206 offset:22528
    s_waitcnt lgkmcnt(6)
    v_mfma_f32_32x32x16_bf16 v[84:99], v[192:195], v[132:135], v[84:99]
    ds_read_b64_tr_b16 v[192:193], v207 offset:20480
    ds_read_b64_tr_b16 v[194:195], v207 offset:22528
    s_waitcnt lgkmcnt(6)
    v_mfma_f32_32x32x16_bf16 v[36:51], v[180:183], v[136:139], v[36:51]
    ds_read_b64_tr_b16 v[180:181], v204 offset:24576
    ds_read_b64_tr_b16 v[182:183], v204 offset:26624
    s_waitcnt lgkmcnt(6)
    v_mfma_f32_32x32x16_bf16 v[52:67], v[184:187], v[136:139], v[52:67]
    ds_read_b64_tr_b16 v[184:185], v205 offset:24576
    ds_read_b64_tr_b16 v[186:187], v205 offset:26624
    s_waitcnt lgkmcnt(6)
    v_mfma_f32_32x32x16_bf16 v[68:83], v[188:191], v[136:139], v[68:83]
    ds_read_b64_tr_b16 v[188:189], v206 offset:24576
    ds_read_b64_tr_b16 v[190:191], v206 offset:26624
    s_waitcnt lgkmcnt(6)
    v_mfma_f32_32x32x16_bf16 v[84:99], v[192:195], v[136:139], v[84:99]
    ds_read_b64_tr_b16 v[192:193], v207 offset:24576
    ds_read_b64_tr_b16 v[194:195], v207 offset:26624
    s_waitcnt lgkmcnt(6)
    v_mfma_f32_32x32x16_bf16 v[36:51], v[180:183], v[148:151], v[36:51]
    ds_read_b64_tr_b16 v[180:181], v204 offset:28672
    ds_read_b64_tr_b16 v[182:183], v204 offset:30720
    s_waitcnt lgkmcnt(6)
    v_mfma_f32_32x32x16_bf16 v[52:67], v[184:187], v[148:151], v[52:67]
    ds_read_b64_tr_b16 v[184:185], v205 offset:28672
    ds_read_b64_tr_b16 v[186:187], v205 offset:30720
    s_waitcnt lgkmcnt(6)
    v_mfma_f32_32x32x16_bf16 v[68:83], v[188:191], v[148:151], v[68:83]
    ds_read_b64_tr_b16 v[188:189], v206 offset:28672
    ds_read_b64_tr_b16 v[190:191], v206 offset:30720
    s_waitcnt lgkmcnt(6)
    v_mfma_f32_32x32x16_bf16 v[84:99], v[192:195], v[148:151], v[84:99]
    ds_read_b64_tr_b16 v[192:193], v207 offset:28672
    ds_read_b64_tr_b16 v[194:195], v207 offset:30720
    s_waitcnt lgkmcnt(6)
    v_mfma_f32_32x32x16_bf16 v[36:51], v[180:183], v[152:155], v[36:51]
    s_waitcnt lgkmcnt(4)
    v_mfma_f32_32x32x16_bf16 v[52:67], v[184:187], v[152:155], v[52:67]
    s_waitcnt lgkmcnt(2)
    v_mfma_f32_32x32x16_bf16 v[68:83], v[188:191], v[152:155], v[68:83]
    s_waitcnt lgkmcnt(0)
    v_mfma_f32_32x32x16_bf16 v[84:99], v[192:195], v[152:155], v[84:99]
    s_waitcnt lgkmcnt(0)
    s_barrier
    v_add_f32 v209, v209, v210
    v_mov_b32 v210, v209
    s_nop 1
    v_permlane32_swap_b32 v209, v210
    v_add_f32 v209, v209, v210
    v_rcp_f32 v209, v209
    v_lshrrev_b32 v215, 5, v1
    v_and_b32 v216, 31, v1
    s_lshl_b32 s4, s3, 5
    v_add_u32 v217, s4, v216
    v_cmp_gt_u32 vcc, 80, v217
    v_subrev_u32 v218, 80, v217
    s_nop 0
    v_cndmask_b32 v218, v218, v217, vcc
    v_mov_b32 v219, 8192
    v_cndmask_b32 v219, v219, 0, vcc
    v_lshrrev_b32 v217, 5, v218
    v_and_b32 v218, 31, v218
    v_lshlrev_b32 v218, 4, v218
    v_lshl_add_u32 v218, v217, 18, v218
    v_add_u32 v218, v218, v219
    s_mul_i32 s4, s28, 786432
    s_lshl_b32 s5, s31, 13
    s_add_u32 s4, s4, s5
    v_add_u32 v218, s4, v218
    v_lshl_add_u32 v218, v215, 3, v218
    s_mov_b32 s60, 0
    s_mov_b32 s61, 2048
    s_mov_b32 s62, 4096
    s_mov_b32 s63, 6144
    v_mul_f32 v36, v36, v209
    v_mul_f32 v37, v37, v209
    v_mul_f32 v38, v38, v209
    v_mul_f32 v39, v39, v209
    v_cvt_pk_bf16_f32 v36, v36, v37
    v_cvt_pk_bf16_f32 v37, v38, v39
    buffer_store_dwordx2 v[36:37], v218, s[24:27], s60 offen offset:0
    v_mul_f32 v40, v40, v209
    v_mul_f32 v41, v41, v209
    v_mul_f32 v42, v42, v209
    v_mul_f32 v43, v43, v209
    v_cvt_pk_bf16_f32 v40, v40, v41
    v_cvt_pk_bf16_f32 v41, v42, v43
    buffer_store_dwordx2 v[40:41], v218, s[24:27], s60 offen offset:512
    v_mul_f32 v44, v44, v209
    v_mul_f32 v45, v45, v209
    v_mul_f32 v46, v46, v209
    v_mul_f32 v47, v47, v209
    v_cvt_pk_bf16_f32 v44, v44, v45
    v_cvt_pk_bf16_f32 v45, v46, v47
    buffer_store_dwordx2 v[44:45], v218, s[24:27], s60 offen offset:1024
    v_mul_f32 v48, v48, v209
    v_mul_f32 v49, v49, v209
    v_mul_f32 v50, v50, v209
    v_mul_f32 v51, v51, v209
    v_cvt_pk_bf16_f32 v48, v48, v49
    v_cvt_pk_bf16_f32 v49, v50, v51
    buffer_store_dwordx2 v[48:49], v218, s[24:27], s60 offen offset:1536
    v_mul_f32 v52, v52, v209
    v_mul_f32 v53, v53, v209
    v_mul_f32 v54, v54, v209
    v_mul_f32 v55, v55, v209
    v_cvt_pk_bf16_f32 v52, v52, v53
    v_cvt_pk_bf16_f32 v53, v54, v55
    buffer_store_dwordx2 v[52:53], v218, s[24:27], s61 offen offset:0
    v_mul_f32 v56, v56, v209
    v_mul_f32 v57, v57, v209
    v_mul_f32 v58, v58, v209
    v_mul_f32 v59, v59, v209
    v_cvt_pk_bf16_f32 v56, v56, v57
    v_cvt_pk_bf16_f32 v57, v58, v59
    buffer_store_dwordx2 v[56:57], v218, s[24:27], s61 offen offset:512
    v_mul_f32 v60, v60, v209
    v_mul_f32 v61, v61, v209
    v_mul_f32 v62, v62, v209
    v_mul_f32 v63, v63, v209
    v_cvt_pk_bf16_f32 v60, v60, v61
    v_cvt_pk_bf16_f32 v61, v62, v63
    buffer_store_dwordx2 v[60:61], v218, s[24:27], s61 offen offset:1024
    v_mul_f32 v64, v64, v209
    v_mul_f32 v65, v65, v209
    v_mul_f32 v66, v66, v209
    v_mul_f32 v67, v67, v209
    v_cvt_pk_bf16_f32 v64, v64, v65
    v_cvt_pk_bf16_f32 v65, v66, v67
    buffer_store_dwordx2 v[64:65], v218, s[24:27], s61 offen offset:1536
    v_mul_f32 v68, v68, v209
    v_mul_f32 v69, v69, v209
    v_mul_f32 v70, v70, v209
    v_mul_f32 v71, v71, v209
    v_cvt_pk_bf16_f32 v68, v68, v69
    v_cvt_pk_bf16_f32 v69, v70, v71
    buffer_store_dwordx2 v[68:69], v218, s[24:27], s62 offen offset:0
    v_mul_f32 v72, v72, v209
    v_mul_f32 v73, v73, v209
    v_mul_f32 v74, v74, v209
    v_mul_f32 v75, v75, v209
    v_cvt_pk_bf16_f32 v72, v72, v73
    v_cvt_pk_bf16_f32 v73, v74, v75
    buffer_store_dwordx2 v[72:73], v218, s[24:27], s62 offen offset:512
    v_mul_f32 v76, v76, v209
    v_mul_f32 v77, v77, v209
    v_mul_f32 v78, v78, v209
    v_mul_f32 v79, v79, v209
    v_cvt_pk_bf16_f32 v76, v76, v77
    v_cvt_pk_bf16_f32 v77, v78, v79
    buffer_store_dwordx2 v[76:77], v218, s[24:27], s62 offen offset:1024
    v_mul_f32 v80, v80, v209
    v_mul_f32 v81, v81, v209
    v_mul_f32 v82, v82, v209
    v_mul_f32 v83, v83, v209
    v_cvt_pk_bf16_f32 v80, v80, v81
    v_cvt_pk_bf16_f32 v81, v82, v83
    buffer_store_dwordx2 v[80:81], v218, s[24:27], s62 offen offset:1536
    v_mul_f32 v84, v84, v209
    v_mul_f32 v85, v85, v209
    v_mul_f32 v86, v86, v209
    v_mul_f32 v87, v87, v209
    v_cvt_pk_bf16_f32 v84, v84, v85
    v_cvt_pk_bf16_f32 v85, v86, v87
    buffer_store_dwordx2 v[84:85], v218, s[24:27], s63 offen offset:0
    v_mul_f32 v88, v88, v209
    v_mul_f32 v89, v89, v209
    v_mul_f32 v90, v90, v209
    v_mul_f32 v91, v91, v209
    v_cvt_pk_bf16_f32 v88, v88, v89
    v_cvt_pk_bf16_f32 v89, v90, v91
    buffer_store_dwordx2 v[88:89], v218, s[24:27], s63 offen offset:512
    v_mul_f32 v92, v92, v209
    v_mul_f32 v93, v93, v209
    v_mul_f32 v94, v94, v209
    v_mul_f32 v95, v95, v209
    v_cvt_pk_bf16_f32 v92, v92, v93
    v_cvt_pk_bf16_f32 v93, v94, v95
    buffer_store_dwordx2 v[92:93], v218, s[24:27], s63 offen offset:1024
    v_mul_f32 v96, v96, v209
    v_mul_f32 v97, v97, v209
    v_mul_f32 v98, v98, v209
    v_mul_f32 v99, v99, v209
    v_cvt_pk_bf16_f32 v96, v96, v97
    v_cvt_pk_bf16_f32 v97, v98, v99
    buffer_store_dwordx2 v[96:97], v218, s[24:27], s63 offen offset:1536
    s_barrier
    s_branch A_end
A_small:
    s_and_b32 s4, s56, 1
    s_lshl_b32 s4, s4, 13
    s_lshr_b32 s57, s56, 1
    v_add_u32 v196, s4, v196
    v_add_u32 v197, s4, v197
    v_add_u32 v198, s4, v198
    v_add_u32 v199, s4, v199
    v_add_u32 v200, s4, v200
    v_add_u32 v201, s4, v201
    v_add_u32 v202, s4, v202
    v_add_u32 v203, s4, v203
    v_add_u32 v204, s4, v204
    v_add_u32 v205, s4, v205
    v_add_u32 v206, s4, v206
    v_add_u32 v207, s4, v207
    s_add_u32 s52, s53, 32768
    s_lshl_b32 s4, s56, 10
    s_add_u32 s5, s4, 32768
    s_mov_b32 m0, s5
    s_add_u32 s5, s4, s52
    s_add_u32 s5, s5, 0
    buffer_load_dwordx4 v221, s[12:15], s5 offen lds
    s_add_u32 s6, s4, 98304
    s_mov_b32 m0, s6
    s_nop 0
    buffer_load_dwordx4 v222, s[16:19], s5 offen lds
    s_lshl_b32 s4, s56, 10
    s_add_u32 s5, s4, 36864
    s_mov_b32 m0, s5
    s_add_u32 s5, s4, s52
    s_add_u32 s5, s5, 4096
    buffer_load_dwordx4 v221, s[12:15], s5 offen lds
    s_add_u32 s6, s4, 102400
    s_mov_b32 m0, s6
    s_nop 0
    buffer_load_dwordx4 v222, s[16:19], s5 offen lds
    s_lshl_b32 s4, s56, 10
    s_add_u32 s5, s4, 40960
    s_mov_b32 m0, s5
    s_add_u32 s5, s4, s52
    s_add_u32 s5, s5, 8192
    buffer_load_dwordx4 v221, s[12:15], s5 offen lds
    s_add_u32 s6, s4, 106496
    s_mov_b32 m0, s6
    s_nop 0
    buffer_load_dwordx4 v222, s[16:19], s5 offen lds
    s_lshl_b32 s4, s56, 10
    s_add_u32 s5, s4, 45056
    s_mov_b32 m0, s5
    s_add_u32 s5, s4, s52
    s_add_u32 s5, s5, 12288
    buffer_load_dwordx4 v221, s[12:15], s5 offen lds
    s_add_u32 s6, s4, 110592
    s_mov_b32 m0, s6
    s_nop 0
    buffer_load_dwordx4 v222, s[16:19], s5 offen lds
    s_mov_b32 s51, 0
    s_add_u32 s52, s52, 16384
    s_lshl_b32 s4, s56, 10
    s_add_u32 s5, s4, 49152
    s_mov_b32 m0, s5
    s_add_u32 s5, s4, s52
    s_add_u32 s5, s5, 0
    buffer_load_dwordx4 v221, s[12:15], s5 offen lds
    s_add_u32 s6, s4, 114688
    s_mov_b32 m0, s6
    s_nop 0
    buffer_load_dwordx4 v222, s[16:19], s5 offen lds
    s_lshl_b32 s4, s56, 10
    s_add_u32 s5, s4, 53248
    s_mov_b32 m0, s5
    s_add_u32 s5, s4, s52
    s_add_u32 s5, s5, 4096
    buffer_load_dwordx4 v221, s[12:15], s5 offen lds
    s_add_u32 s6, s4, 118784
    s_mov_b32 m0, s6
    s_nop 0
    buffer_load_dwordx4 v222, s[16:19], s5 offen lds
    s_lshl_b32 s4, s56, 10
    s_add_u32 s5, s4, 57344
    s_mov_b32 m0, s5
    s_add_u32 s5, s4, s52
    s_add_u32 s5, s5, 8192
    buffer_load_dwordx4 v221, s[12:15], s5 offen lds
    s_add_u32 s6, s4, 122880
    s_mov_b32 m0, s6
    s_nop 0
    buffer_load_dwordx4 v222, s[16:19], s5 offen lds
    s_lshl_b32 s4, s56, 10
    s_add_u32 s5, s4, 61440
    s_mov_b32 m0, s5
    s_add_u32 s5, s4, s52
    s_add_u32 s5, s5, 12288
    buffer_load_dwordx4 v221, s[12:15], s5 offen lds
    s_add_u32 s6, s4, 126976
    s_mov_b32 m0, s6
    s_nop 0
    buffer_load_dwordx4 v222, s[16:19], s5 offen lds
    s_cmp_lg_u32 s57, 0
    s_cbranch_scc1 A_sskips0
    ds_read_b128 v[164:167], v196 offset:0
    s_waitcnt lgkmcnt(0)
    v_mfma_f32_32x32x16_bf16 v[100:115], v[164:167], v[4:7], 0
    ds_read_b128 v[168:171], v197 offset:0
    s_waitcnt lgkmcnt(0)
    v_mfma_f32_32x32x16_bf16 v[100:115], v[168:171], v[8:11], v[100:115]
    ds_read_b128 v[172:175], v198 offset:0
    s_waitcnt lgkmcnt(0)
    v_mfma_f32_32x32x16_bf16 v[100:115], v[172:175], v[12:15], v[100:115]
    ds_read_b128 v[176:179], v199 offset:0
    s_waitcnt lgkmcnt(0)
    v_mfma_f32_32x32x16_bf16 v[100:115], v[176:179], v[16:19], v[100:115]
    ds_read_b128 v[164:167], v200 offset:0
    s_waitcnt lgkmcnt(0)
    v_mfma_f32_32x32x16_bf16 v[100:115], v[164:167], v[20:23], v[100:115]
    ds_read_b128 v[168:171], v201 offset:0
    s_waitcnt lgkmcnt(0)
    v_mfma_f32_32x32x16_bf16 v[100:115], v[168:171], v[24:27], v[100:115]
    ds_read_b128 v[172:175], v202 offset:0
    s_waitcnt lgkmcnt(0)
    v_mfma_f32_32x32x16_bf16 v[100:115], v[172:175], v[28:31], v[100:115]
    ds_read_b128 v[176:179], v203 offset:0
    s_waitcnt lgkmcnt(0)
    v_mfma_f32_32x32x16_bf16 v[100:115], v[176:179], v[32:35], v[100:115]
    s_nop 11
    v_max3_f32 v213, v100, v101, v102
    v_max3_f32 v214, v103, v104, v105
    v_max3_f32 v215, v106, v107, v108
    v_max3_f32 v216, v109, v110, v111
    v_max3_f32 v217, v112, v113, v114
    v_max3_f32 v213, v213, v214, v115
    v_max3_f32 v215, v215, v216, v217
    v_max_f32 v213, v213, v215
    v_mov_b32 v214, v213
    s_nop 1
    v_permlane32_swap_b32 v213, v214
    v_max3_f32 v213, v213, v214, v208
    v_sub_f32 v214, v213, v208
    v_cmp_lt_f32 vcc, s49, v214
    s_nop 1
    s_cbranch_vccz A_snrs0
    v_mul_f32 v214, s55, v214
    v_exp_f32 v211, v214
    s_nop 0
    v_mul_f32 v209, v209, v211
    v_mov_b32 v208, v213
    v_mul_f32 v36, v36, v211
    v_mul_f32 v37, v37, v211
    v_mul_f32 v38, v38, v211
    v_mul_f32 v39, v39, v211
    v_mul_f32 v40, v40, v211
    v_mul_f32 v41, v41, v211
    v_mul_f32 v42, v42, v211
    v_mul_f32 v43, v43, v211
    v_mul_f32 v44, v44, v211
    v_mul_f32 v45, v45, v211
    v_mul_f32 v46, v46, v211
    v_mul_f32 v47, v47, v211
    v_mul_f32 v48, v48, v211
    v_mul_f32 v49, v49, v211
    v_mul_f32 v50, v50, v211
    v_mul_f32 v51, v51, v211
    v_mul_f32 v52, v52, v211
    v_mul_f32 v53, v53, v211
    v_mul_f32 v54, v54, v211
    v_mul_f32 v55, v55, v211
    v_mul_f32 v56, v56, v211
    v_mul_f32 v57, v57, v211
    v_mul_f32 v58, v58, v211
    v_mul_f32 v59, v59, v211
    v_mul_f32 v60, v60, v211
    v_mul_f32 v61, v61, v211
    v_mul_f32 v62, v62, v211
    v_mul_f32 v63, v63, v211
    v_mul_f32 v64, v64, v211
    v_mul_f32 v65, v65, v211
    v_mul_f32 v66, v66, v211
    v_mul_f32 v67, v67, v211
    v_mul_f32 v68, v68, v211
    v_mul_f32 v69, v69, v211
    v_mul_f32 v70, v70, v211
    v_mul_f32 v71, v71, v211
    v_mul_f32 v72, v72, v211
    v_mul_f32 v73, v73, v211
    v_mul_f32 v74, v74, v211
    v_mul_f32 v75, v75, v211
    v_mul_f32 v76, v76, v211
    v_mul_f32 v77, v77, v211
    v_mul_f32 v78, v78, v211
    v_mul_f32 v79, v79, v211
    v_mul_f32 v80, v80, v211
    v_mul_f32 v81, v81, v211
    v_mul_f32 v82, v82, v211
    v_mul_f32 v83, v83, v211
    v_mul_f32 v84, v84, v211
    v_mul_f32 v85, v85, v211
    v_mul_f32 v86, v86, v211
    v_mul_f32 v87, v87, v211
    v_mul_f32 v88, v88, v211
    v_mul_f32 v89, v89, v211
    v_mul_f32 v90, v90, v211
    v_mul_f32 v91, v91, v211
    v_mul_f32 v92, v92, v211
    v_mul_f32 v93, v93, v211
    v_mul_f32 v94, v94, v211
    v_mul_f32 v95, v95, v211
    v_mul_f32 v96, v96, v211
    v_mul_f32 v97, v97, v211
    v_mul_f32 v98, v98, v211
    v_mul_f32 v99, v99, v211
A_snrs0:
    v_mul_f32 v212, s48, v208
    v_fma_f32 v100, v100, s48, -v212
    v_exp_f32 v100, v100
    s_nop 0
    v_add_f32 v209, v209, v100
    v_fma_f32 v101, v101, s48, -v212
    v_exp_f32 v101, v101
    s_nop 0
    v_add_f32 v209, v209, v101
    v_cvt_pk_bf16_f32 v100, v100, v101
    v_fma_f32 v102, v102, s48, -v212
    v_exp_f32 v102, v102
    s_nop 0
    v_add_f32 v209, v209, v102
    v_fma_f32 v103, v103, s48, -v212
    v_exp_f32 v103, v103
    s_nop 0
    v_add_f32 v209, v209, v103
    v_cvt_pk_bf16_f32 v101, v102, v103
    v_fma_f32 v104, v104, s48, -v212
    v_exp_f32 v104, v104
    s_nop 0
    v_add_f32 v209, v209, v104
    v_fma_f32 v105, v105, s48, -v212
    v_exp_f32 v105, v105
    s_nop 0
    v_add_f32 v209, v209, v105
    v_cvt_pk_bf16_f32 v102, v104, v105
    v_fma_f32 v106, v106, s48, -v212
    v_exp_f32 v106, v106
    s_nop 0
    v_add_f32 v209, v209, v106
    v_fma_f32 v107, v107, s48, -v212
    v_exp_f32 v107, v107
    s_nop 0
    v_add_f32 v209, v209, v107
    v_cvt_pk_bf16_f32 v103, v106, v107
    v_fma_f32 v108, v108, s48, -v212
    v_exp_f32 v108, v108
    s_nop 0
    v_add_f32 v209, v209, v108
    v_fma_f32 v109, v109, s48, -v212
    v_exp_f32 v109, v109
    s_nop 0
    v_add_f32 v209, v209, v109
    v_cvt_pk_bf16_f32 v104, v108, v109
    v_fma_f32 v110, v110, s48, -v212
    v_exp_f32 v110, v110
    s_nop 0
    v_add_f32 v209, v209, v110
    v_fma_f32 v111, v111, s48, -v212
    v_exp_f32 v111, v111
    s_nop 0
    v_add_f32 v209, v209, v111
    v_cvt_pk_bf16_f32 v105, v110, v111
    v_fma_f32 v112, v112, s48, -v212
    v_exp_f32 v112, v112
    s_nop 0
    v_add_f32 v209, v209, v112
    v_fma_f32 v113, v113, s48, -v212
    v_exp_f32 v113, v113
    s_nop 0
    v_add_f32 v209, v209, v113
    v_cvt_pk_bf16_f32 v106, v112, v113
    v_fma_f32 v114, v114, s48, -v212
    v_exp_f32 v114, v114
    s_nop 0
    v_add_f32 v209, v209, v114
    v_fma_f32 v115, v115, s48, -v212
    v_exp_f32 v115, v115
    s_nop 0
    v_add_f32 v209, v209, v115
    v_cvt_pk_bf16_f32 v107, v114, v115
    ds_read_b64_tr_b16 v[180:181], v204 offset:0
    ds_read_b64_tr_b16 v[182:183], v204 offset:2048
    s_waitcnt lgkmcnt(0)
    v_mfma_f32_32x32x16_bf16 v[36:51], v[180:183], v[100:103], v[36:51]
    ds_read_b64_tr_b16 v[184:185], v205 offset:0
    ds_read_b64_tr_b16 v[186:187], v205 offset:2048
    s_waitcnt lgkmcnt(0)
    v_mfma_f32_32x32x16_bf16 v[52:67], v[184:187], v[100:103], v[52:67]
    ds_read_b64_tr_b16 v[188:189], v206 offset:0
    ds_read_b64_tr_b16 v[190:191], v206 offset:2048
    s_waitcnt lgkmcnt(0)
    v_mfma_f32_32x32x16_bf16 v[68:83], v[188:191], v[100:103], v[68:83]
    ds_read_b64_tr_b16 v[192:193], v207 offset:0
    ds_read_b64_tr_b16 v[194:195], v207 offset:2048
    s_waitcnt lgkmcnt(0)
    v_mfma_f32_32x32x16_bf16 v[84:99], v[192:195], v[100:103], v[84:99]
    ds_read_b64_tr_b16 v[180:181], v204 offset:4096
    ds_read_b64_tr_b16 v[182:183], v204 offset:6144
    s_waitcnt lgkmcnt(0)
    v_mfma_f32_32x32x16_bf16 v[36:51], v[180:183], v[104:107], v[36:51]
    ds_read_b64_tr_b16 v[184:185], v205 offset:4096
    ds_read_b64_tr_b16 v[186:187], v205 offset:6144
    s_waitcnt lgkmcnt(0)
    v_mfma_f32_32x32x16_bf16 v[52:67], v[184:187], v[104:107], v[52:67]
    ds_read_b64_tr_b16 v[188:189], v206 offset:4096
    ds_read_b64_tr_b16 v[190:191], v206 offset:6144
    s_waitcnt lgkmcnt(0)
    v_mfma_f32_32x32x16_bf16 v[68:83], v[188:191], v[104:107], v[68:83]
    ds_read_b64_tr_b16 v[192:193], v207 offset:4096
    ds_read_b64_tr_b16 v[194:195], v207 offset:6144
    s_waitcnt lgkmcnt(0)
    v_mfma_f32_32x32x16_bf16 v[84:99], v[192:195], v[104:107], v[84:99]
    s_waitcnt lgkmcnt(0)
A_sskips0:
    s_waitcnt vmcnt(8)
    s_barrier
    s_add_u32 s52, s52, 16384
    s_lshl_b32 s4, s56, 10
    s_add_u32 s5, s4, 0
    s_mov_b32 m0, s5
    s_add_u32 s5, s4, s52
    s_add_u32 s5, s5, 0
    buffer_load_dwordx4 v221, s[12:15], s5 offen lds
    s_add_u32 s6, s4, 65536
    s_mov_b32 m0, s6
    s_nop 0
    buffer_load_dwordx4 v222, s[16:19], s5 offen lds
    s_lshl_b32 s4, s56, 10
    s_add_u32 s5, s4, 4096
    s_mov_b32 m0, s5
    s_add_u32 s5, s4, s52
    s_add_u32 s5, s5, 4096
    buffer_load_dwordx4 v221, s[12:15], s5 offen lds
    s_add_u32 s6, s4, 69632
    s_mov_b32 m0, s6
    s_nop 0
    buffer_load_dwordx4 v222, s[16:19], s5 offen lds
    s_lshl_b32 s4, s56, 10
    s_add_u32 s5, s4, 8192
    s_mov_b32 m0, s5
    s_add_u32 s5, s4, s52
    s_add_u32 s5, s5, 8192
    buffer_load_dwordx4 v221, s[12:15], s5 offen lds
    s_add_u32 s6, s4, 73728
    s_mov_b32 m0, s6
    s_nop 0
    buffer_load_dwordx4 v222, s[16:19], s5 offen lds
    s_lshl_b32 s4, s56, 10
    s_add_u32 s5, s4, 12288
    s_mov_b32 m0, s5
    s_add_u32 s5, s4, s52
    s_add_u32 s5, s5, 12288
    buffer_load_dwordx4 v221, s[12:15], s5 offen lds
    s_add_u32 s6, s4, 77824
    s_mov_b32 m0, s6
    s_nop 0
    buffer_load_dwordx4 v222, s[16:19], s5 offen lds
    s_cmp_lg_u32 s57, 1
    s_cbranch_scc1 A_sskips1
    ds_read_b128 v[164:167], v196 offset:16384
    s_waitcnt lgkmcnt(0)
    v_mfma_f32_32x32x16_bf16 v[100:115], v[164:167], v[4:7], 0
    ds_read_b128 v[168:171], v197 offset:16384
    s_waitcnt lgkmcnt(0)
    v_mfma_f32_32x32x16_bf16 v[100:115], v[168:171], v[8:11], v[100:115]
    ds_read_b128 v[172:175], v198 offset:16384
    s_waitcnt lgkmcnt(0)
    v_mfma_f32_32x32x16_bf16 v[100:115], v[172:175], v[12:15], v[100:115]
    ds_read_b128 v[176:179], v199 offset:16384
    s_waitcnt lgkmcnt(0)
    v_mfma_f32_32x32x16_bf16 v[100:115], v[176:179], v[16:19], v[100:115]
    ds_read_b128 v[164:167], v200 offset:16384
    s_waitcnt lgkmcnt(0)
    v_mfma_f32_32x32x16_bf16 v[100:115], v[164:167], v[20:23], v[100:115]
    ds_read_b128 v[168:171], v201 offset:16384
    s_waitcnt lgkmcnt(0)
    v_mfma_f32_32x32x16_bf16 v[100:115], v[168:171], v[24:27], v[100:115]
    ds_read_b128 v[172:175], v202 offset:16384
    s_waitcnt lgkmcnt(0)
    v_mfma_f32_32x32x16_bf16 v[100:115], v[172:175], v[28:31], v[100:115]
    ds_read_b128 v[176:179], v203 offset:16384
    s_waitcnt lgkmcnt(0)
    v_mfma_f32_32x32x16_bf16 v[100:115], v[176:179], v[32:35], v[100:115]
    s_nop 11
    v_max3_f32 v213, v100, v101, v102
    v_max3_f32 v214, v103, v104, v105
    v_max3_f32 v215, v106, v107, v108
    v_max3_f32 v216, v109, v110, v111
    v_max3_f32 v217, v112, v113, v114
    v_max3_f32 v213, v213, v214, v115
    v_max3_f32 v215, v215, v216, v217
    v_max_f32 v213, v213, v215
    v_mov_b32 v214, v213
    s_nop 1
    v_permlane32_swap_b32 v213, v214
    v_max3_f32 v213, v213, v214, v208
    v_sub_f32 v214, v213, v208
    v_cmp_lt_f32 vcc, s49, v214
    s_nop 1
    s_cbranch_vccz A_snrs1
    v_mul_f32 v214, s55, v214
    v_exp_f32 v211, v214
    s_nop 0
    v_mul_f32 v209, v209, v211
    v_mov_b32 v208, v213
    v_mul_f32 v36, v36, v211
    v_mul_f32 v37, v37, v211
    v_mul_f32 v38, v38, v211
    v_mul_f32 v39, v39, v211
    v_mul_f32 v40, v40, v211
    v_mul_f32 v41, v41, v211
    v_mul_f32 v42, v42, v211
    v_mul_f32 v43, v43, v211
    v_mul_f32 v44, v44, v211
    v_mul_f32 v45, v45, v211
    v_mul_f32 v46, v46, v211
    v_mul_f32 v47, v47, v211
    v_mul_f32 v48, v48, v211
    v_mul_f32 v49, v49, v211
    v_mul_f32 v50, v50, v211
    v_mul_f32 v51, v51, v211
    v_mul_f32 v52, v52, v211
    v_mul_f32 v53, v53, v211
    v_mul_f32 v54, v54, v211
    v_mul_f32 v55, v55, v211
    v_mul_f32 v56, v56, v211
    v_mul_f32 v57, v57, v211
    v_mul_f32 v58, v58, v211
    v_mul_f32 v59, v59, v211
    v_mul_f32 v60, v60, v211
    v_mul_f32 v61, v61, v211
    v_mul_f32 v62, v62, v211
    v_mul_f32 v63, v63, v211
    v_mul_f32 v64, v64, v211
    v_mul_f32 v65, v65, v211
    v_mul_f32 v66, v66, v211
    v_mul_f32 v67, v67, v211
    v_mul_f32 v68, v68, v211
    v_mul_f32 v69, v69, v211
    v_mul_f32 v70, v70, v211
    v_mul_f32 v71, v71, v211
    v_mul_f32 v72, v72, v211
    v_mul_f32 v73, v73, v211
    v_mul_f32 v74, v74, v211
    v_mul_f32 v75, v75, v211
    v_mul_f32 v76, v76, v211
    v_mul_f32 v77, v77, v211
    v_mul_f32 v78, v78, v211
    v_mul_f32 v79, v79, v211
    v_mul_f32 v80, v80, v211
    v_mul_f32 v81, v81, v211
    v_mul_f32 v82, v82, v211
    v_mul_f32 v83, v83, v211
    v_mul_f32 v84, v84, v211
    v_mul_f32 v85, v85, v211
    v_mul_f32 v86, v86, v211
    v_mul_f32 v87, v87, v211
    v_mul_f32 v88, v88, v211
    v_mul_f32 v89, v89, v211
    v_mul_f32 v90, v90, v211
    v_mul_f32 v91, v91, v211
    v_mul_f32 v92, v92, v211
    v_mul_f32 v93, v93, v211
    v_mul_f32 v94, v94, v211
    v_mul_f32 v95, v95, v211
    v_mul_f32 v96, v96, v211
    v_mul_f32 v97, v97, v211
    v_mul_f32 v98, v98, v211
    v_mul_f32 v99, v99, v211
A_snrs1:
    v_mul_f32 v212, s48, v208
    v_fma_f32 v100, v100, s48, -v212
    v_exp_f32 v100, v100
    s_nop 0
    v_add_f32 v209, v209, v100
    v_fma_f32 v101, v101, s48, -v212
    v_exp_f32 v101, v101
    s_nop 0
    v_add_f32 v209, v209, v101
    v_cvt_pk_bf16_f32 v100, v100, v101
    v_fma_f32 v102, v102, s48, -v212
    v_exp_f32 v102, v102
    s_nop 0
    v_add_f32 v209, v209, v102
    v_fma_f32 v103, v103, s48, -v212
    v_exp_f32 v103, v103
    s_nop 0
    v_add_f32 v209, v209, v103
    v_cvt_pk_bf16_f32 v101, v102, v103
    v_fma_f32 v104, v104, s48, -v212
    v_exp_f32 v104, v104
    s_nop 0
    v_add_f32 v209, v209, v104
    v_fma_f32 v105, v105, s48, -v212
    v_exp_f32 v105, v105
    s_nop 0
    v_add_f32 v209, v209, v105
    v_cvt_pk_bf16_f32 v102, v104, v105
    v_fma_f32 v106, v106, s48, -v212
    v_exp_f32 v106, v106
    s_nop 0
    v_add_f32 v209, v209, v106
    v_fma_f32 v107, v107, s48, -v212
    v_exp_f32 v107, v107
    s_nop 0
    v_add_f32 v209, v209, v107
    v_cvt_pk_bf16_f32 v103, v106, v107
    v_fma_f32 v108, v108, s48, -v212
    v_exp_f32 v108, v108
    s_nop 0
    v_add_f32 v209, v209, v108
    v_fma_f32 v109, v109, s48, -v212
    v_exp_f32 v109, v109
    s_nop 0
    v_add_f32 v209, v209, v109
    v_cvt_pk_bf16_f32 v104, v108, v109
    v_fma_f32 v110, v110, s48, -v212
    v_exp_f32 v110, v110
    s_nop 0
    v_add_f32 v209, v209, v110
    v_fma_f32 v111, v111, s48, -v212
    v_exp_f32 v111, v111
    s_nop 0
    v_add_f32 v209, v209, v111
    v_cvt_pk_bf16_f32 v105, v110, v111
    v_fma_f32 v112, v112, s48, -v212
    v_exp_f32 v112, v112
    s_nop 0
    v_add_f32 v209, v209, v112
    v_fma_f32 v113, v113, s48, -v212
    v_exp_f32 v113, v113
    s_nop 0
    v_add_f32 v209, v209, v113
    v_cvt_pk_bf16_f32 v106, v112, v113
    v_fma_f32 v114, v114, s48, -v212
    v_exp_f32 v114, v114
    s_nop 0
    v_add_f32 v209, v209, v114
    v_fma_f32 v115, v115, s48, -v212
    v_exp_f32 v115, v115
    s_nop 0
    v_add_f32 v209, v209, v115
    v_cvt_pk_bf16_f32 v107, v114, v115
    ds_read_b64_tr_b16 v[180:181], v204 offset:16384
    ds_read_b64_tr_b16 v[182:183], v204 offset:18432
    s_waitcnt lgkmcnt(0)
    v_mfma_f32_32x32x16_bf16 v[36:51], v[180:183], v[100:103], v[36:51]
    ds_read_b64_tr_b16 v[184:185], v205 offset:16384
    ds_read_b64_tr_b16 v[186:187], v205 offset:18432
    s_waitcnt lgkmcnt(0)
    v_mfma_f32_32x32x16_bf16 v[52:67], v[184:187], v[100:103], v[52:67]
    ds_read_b64_tr_b16 v[188:189], v206 offset:16384
    ds_read_b64_tr_b16 v[190:191], v206 offset:18432
    s_waitcnt lgkmcnt(0)
    v_mfma_f32_32x32x16_bf16 v[68:83], v[188:191], v[100:103], v[68:83]
    ds_read_b64_tr_b16 v[192:193], v207 offset:16384
    ds_read_b64_tr_b16 v[194:195], v207 offset:18432
    s_waitcnt lgkmcnt(0)
    v_mfma_f32_32x32x16_bf16 v[84:99], v[192:195], v[100:103], v[84:99]
    ds_read_b64_tr_b16 v[180:181], v204 offset:20480
    ds_read_b64_tr_b16 v[182:183], v204 offset:22528
    s_waitcnt lgkmcnt(0)
    v_mfma_f32_32x32x16_bf16 v[36:51], v[180:183], v[104:107], v[36:51]
    ds_read_b64_tr_b16 v[184:185], v205 offset:20480
    ds_read_b64_tr_b16 v[186:187], v205 offset:22528
    s_waitcnt lgkmcnt(0)
    v_mfma_f32_32x32x16_bf16 v[52:67], v[184:187], v[104:107], v[52:67]
    ds_read_b64_tr_b16 v[188:189], v206 offset:20480
    ds_read_b64_tr_b16 v[190:191], v206 offset:22528
    s_waitcnt lgkmcnt(0)
    v_mfma_f32_32x32x16_bf16 v[68:83], v[188:191], v[104:107], v[68:83]
    ds_read_b64_tr_b16 v[192:193], v207 offset:20480
    ds_read_b64_tr_b16 v[194:195], v207 offset:22528
    s_waitcnt lgkmcnt(0)
    v_mfma_f32_32x32x16_bf16 v[84:99], v[192:195], v[104:107], v[84:99]
    s_waitcnt lgkmcnt(0)
A_sskips1:
    s_waitcnt vmcnt(8)
    s_barrier
    v_xor_b32 v196, 0x8000, v196
    v_xor_b32 v197, 0x8000, v197
    v_xor_b32 v198, 0x8000, v198
    v_xor_b32 v199, 0x8000, v199
    v_xor_b32 v200, 0x8000, v200
    v_xor_b32 v201, 0x8000, v201
    v_xor_b32 v202, 0x8000, v202
    v_xor_b32 v203, 0x8000, v203
    v_xor_b32 v204, 0x8000, v204
    v_xor_b32 v205, 0x8000, v205
    v_xor_b32 v206, 0x8000, v206
    v_xor_b32 v207, 0x8000, v207
    s_add_u32 s52, s52, 16384
    s_lshl_b32 s4, s56, 10
    s_add_u32 s5, s4, 16384
    s_mov_b32 m0, s5
    s_add_u32 s5, s4, s52
    s_add_u32 s5, s5, 0
    buffer_load_dwordx4 v221, s[12:15], s5 offen lds
    s_add_u32 s6, s4, 81920
    s_mov_b32 m0, s6
    s_nop 0
    buffer_load_dwordx4 v222, s[16:19], s5 offen lds
    s_lshl_b32 s4, s56, 10
    s_add_u32 s5, s4, 20480
    s_mov_b32 m0, s5
    s_add_u32 s5, s4, s52
    s_add_u32 s5, s5, 4096
    buffer_load_dwordx4 v221, s[12:15], s5 offen lds
    s_add_u32 s6, s4, 86016
    s_mov_b32 m0, s6
    s_nop 0
    buffer_load_dwordx4 v222, s[16:19], s5 offen lds
    s_lshl_b32 s4, s56, 10
    s_add_u32 s5, s4, 24576
    s_mov_b32 m0, s5
    s_add_u32 s5, s4, s52
    s_add_u32 s5, s5, 8192
    buffer_load_dwordx4 v221, s[12:15], s5 offen lds
    s_add_u32 s6, s4, 90112
    s_mov_b32 m0, s6
    s_nop 0
    buffer_load_dwordx4 v222, s[16:19], s5 offen lds
    s_lshl_b32 s4, s56, 10
    s_add_u32 s5, s4, 28672
    s_mov_b32 m0, s5
    s_add_u32 s5, s4, s52
    s_add_u32 s5, s5, 12288
    buffer_load_dwordx4 v221, s[12:15], s5 offen lds
    s_add_u32 s6, s4, 94208
    s_mov_b32 m0, s6
    s_nop 0
    buffer_load_dwordx4 v222, s[16:19], s5 offen lds
    s_cmp_lg_u32 s57, 0
    s_cbranch_scc1 A_sskips2
    ds_read_b128 v[164:167], v196 offset:0
    s_waitcnt lgkmcnt(0)
    v_mfma_f32_32x32x16_bf16 v[100:115], v[164:167], v[4:7], 0
    ds_read_b128 v[168:171], v197 offset:0
    s_waitcnt lgkmcnt(0)
    v_mfma_f32_32x32x16_bf16 v[100:115], v[168:171], v[8:11], v[100:115]
    ds_read_b128 v[172:175], v198 offset:0
    s_waitcnt lgkmcnt(0)
    v_mfma_f32_32x32x16_bf16 v[100:115], v[172:175], v[12:15], v[100:115]
    ds_read_b128 v[176:179], v199 offset:0
    s_waitcnt lgkmcnt(0)
    v_mfma_f32_32x32x16_bf16 v[100:115], v[176:179], v[16:19], v[100:115]
    ds_read_b128 v[164:167], v200 offset:0
    s_waitcnt lgkmcnt(0)
    v_mfma_f32_32x32x16_bf16 v[100:115], v[164:167], v[20:23], v[100:115]
    ds_read_b128 v[168:171], v201 offset:0
    s_waitcnt lgkmcnt(0)
    v_mfma_f32_32x32x16_bf16 v[100:115], v[168:171], v[24:27], v[100:115]
    ds_read_b128 v[172:175], v202 offset:0
    s_waitcnt lgkmcnt(0)
    v_mfma_f32_32x32x16_bf16 v[100:115], v[172:175], v[28:31], v[100:115]
    ds_read_b128 v[176:179], v203 offset:0
    s_waitcnt lgkmcnt(0)
    v_mfma_f32_32x32x16_bf16 v[100:115], v[176:179], v[32:35], v[100:115]
    s_nop 11
    v_max3_f32 v213, v100, v101, v102
    v_max3_f32 v214, v103, v104, v105
    v_max3_f32 v215, v106, v107, v108
    v_max3_f32 v216, v109, v110, v111
    v_max3_f32 v217, v112, v113, v114
    v_max3_f32 v213, v213, v214, v115
    v_max3_f32 v215, v215, v216, v217
    v_max_f32 v213, v213, v215
    v_mov_b32 v214, v213
    s_nop 1
    v_permlane32_swap_b32 v213, v214
    v_max3_f32 v213, v213, v214, v208
    v_sub_f32 v214, v213, v208
    v_cmp_lt_f32 vcc, s49, v214
    s_nop 1
    s_cbranch_vccz A_snrs2
    v_mul_f32 v214, s55, v214
    v_exp_f32 v211, v214
    s_nop 0
    v_mul_f32 v209, v209, v211
    v_mov_b32 v208, v213
    v_mul_f32 v36, v36, v211
    v_mul_f32 v37, v37, v211
    v_mul_f32 v38, v38, v211
    v_mul_f32 v39, v39, v211
    v_mul_f32 v40, v40, v211
    v_mul_f32 v41, v41, v211
    v_mul_f32 v42, v42, v211
    v_mul_f32 v43, v43, v211
    v_mul_f32 v44, v44, v211
    v_mul_f32 v45, v45, v211
    v_mul_f32 v46, v46, v211
    v_mul_f32 v47, v47, v211
    v_mul_f32 v48, v48, v211
    v_mul_f32 v49, v49, v211
    v_mul_f32 v50, v50, v211
    v_mul_f32 v51, v51, v211
    v_mul_f32 v52, v52, v211
    v_mul_f32 v53, v53, v211
    v_mul_f32 v54, v54, v211
    v_mul_f32 v55, v55, v211
    v_mul_f32 v56, v56, v211
    v_mul_f32 v57, v57, v211
    v_mul_f32 v58, v58, v211
    v_mul_f32 v59, v59, v211
    v_mul_f32 v60, v60, v211
    v_mul_f32 v61, v61, v211
    v_mul_f32 v62, v62, v211
    v_mul_f32 v63, v63, v211
    v_mul_f32 v64, v64, v211
    v_mul_f32 v65, v65, v211
    v_mul_f32 v66, v66, v211
    v_mul_f32 v67, v67, v211
    v_mul_f32 v68, v68, v211
    v_mul_f32 v69, v69, v211
    v_mul_f32 v70, v70, v211
    v_mul_f32 v71, v71, v211
    v_mul_f32 v72, v72, v211
    v_mul_f32 v73, v73, v211
    v_mul_f32 v74, v74, v211
    v_mul_f32 v75, v75, v211
    v_mul_f32 v76, v76, v211
    v_mul_f32 v77, v77, v211
    v_mul_f32 v78, v78, v211
    v_mul_f32 v79, v79, v211
    v_mul_f32 v80, v80, v211
    v_mul_f32 v81, v81, v211
    v_mul_f32 v82, v82, v211
    v_mul_f32 v83, v83, v211
    v_mul_f32 v84, v84, v211
    v_mul_f32 v85, v85, v211
    v_mul_f32 v86, v86, v211
    v_mul_f32 v87, v87, v211
    v_mul_f32 v88, v88, v211
    v_mul_f32 v89, v89, v211
    v_mul_f32 v90, v90, v211
    v_mul_f32 v91, v91, v211
    v_mul_f32 v92, v92, v211
    v_mul_f32 v93, v93, v211
    v_mul_f32 v94, v94, v211
    v_mul_f32 v95, v95, v211
    v_mul_f32 v96, v96, v211
    v_mul_f32 v97, v97, v211
    v_mul_f32 v98, v98, v211
    v_mul_f32 v99, v99, v211
A_snrs2:
    v_mul_f32 v212, s48, v208
    v_fma_f32 v100, v100, s48, -v212
    v_exp_f32 v100, v100
    s_nop 0
    v_add_f32 v209, v209, v100
    v_fma_f32 v101, v101, s48, -v212
    v_exp_f32 v101, v101
    s_nop 0
    v_add_f32 v209, v209, v101
    v_cvt_pk_bf16_f32 v100, v100, v101
    v_fma_f32 v102, v102, s48, -v212
    v_exp_f32 v102, v102
    s_nop 0
    v_add_f32 v209, v209, v102
    v_fma_f32 v103, v103, s48, -v212
    v_exp_f32 v103, v103
    s_nop 0
    v_add_f32 v209, v209, v103
    v_cvt_pk_bf16_f32 v101, v102, v103
    v_fma_f32 v104, v104, s48, -v212
    v_exp_f32 v104, v104
    s_nop 0
    v_add_f32 v209, v209, v104
    v_fma_f32 v105, v105, s48, -v212
    v_exp_f32 v105, v105
    s_nop 0
    v_add_f32 v209, v209, v105
    v_cvt_pk_bf16_f32 v102, v104, v105
    v_fma_f32 v106, v106, s48, -v212
    v_exp_f32 v106, v106
    s_nop 0
    v_add_f32 v209, v209, v106
    v_fma_f32 v107, v107, s48, -v212
    v_exp_f32 v107, v107
    s_nop 0
    v_add_f32 v209, v209, v107
    v_cvt_pk_bf16_f32 v103, v106, v107
    v_fma_f32 v108, v108, s48, -v212
    v_exp_f32 v108, v108
    s_nop 0
    v_add_f32 v209, v209, v108
    v_fma_f32 v109, v109, s48, -v212
    v_exp_f32 v109, v109
    s_nop 0
    v_add_f32 v209, v209, v109
    v_cvt_pk_bf16_f32 v104, v108, v109
    v_fma_f32 v110, v110, s48, -v212
    v_exp_f32 v110, v110
    s_nop 0
    v_add_f32 v209, v209, v110
    v_fma_f32 v111, v111, s48, -v212
    v_exp_f32 v111, v111
    s_nop 0
    v_add_f32 v209, v209, v111
    v_cvt_pk_bf16_f32 v105, v110, v111
    v_fma_f32 v112, v112, s48, -v212
    v_exp_f32 v112, v112
    s_nop 0
    v_add_f32 v209, v209, v112
    v_fma_f32 v113, v113, s48, -v212
    v_exp_f32 v113, v113
    s_nop 0
    v_add_f32 v209, v209, v113
    v_cvt_pk_bf16_f32 v106, v112, v113
    v_fma_f32 v114, v114, s48, -v212
    v_exp_f32 v114, v114
    s_nop 0
    v_add_f32 v209, v209, v114
    v_fma_f32 v115, v115, s48, -v212
    v_exp_f32 v115, v115
    s_nop 0
    v_add_f32 v209, v209, v115
    v_cvt_pk_bf16_f32 v107, v114, v115
    ds_read_b64_tr_b16 v[180:181], v204 offset:0
    ds_read_b64_tr_b16 v[182:183], v204 offset:2048
    s_waitcnt lgkmcnt(0)
    v_mfma_f32_32x32x16_bf16 v[36:51], v[180:183], v[100:103], v[36:51]
    ds_read_b64_tr_b16 v[184:185], v205 offset:0
    ds_read_b64_tr_b16 v[186:187], v205 offset:2048
    s_waitcnt lgkmcnt(0)
    v_mfma_f32_32x32x16_bf16 v[52:67], v[184:187], v[100:103], v[52:67]
    ds_read_b64_tr_b16 v[188:189], v206 offset:0
    ds_read_b64_tr_b16 v[190:191], v206 offset:2048
    s_waitcnt lgkmcnt(0)
    v_mfma_f32_32x32x16_bf16 v[68:83], v[188:191], v[100:103], v[68:83]
    ds_read_b64_tr_b16 v[192:193], v207 offset:0
    ds_read_b64_tr_b16 v[194:195], v207 offset:2048
    s_waitcnt lgkmcnt(0)
    v_mfma_f32_32x32x16_bf16 v[84:99], v[192:195], v[100:103], v[84:99]
    ds_read_b64_tr_b16 v[180:181], v204 offset:4096
    ds_read_b64_tr_b16 v[182:183], v204 offset:6144
    s_waitcnt lgkmcnt(0)
    v_mfma_f32_32x32x16_bf16 v[36:51], v[180:183], v[104:107], v[36:51]
    ds_read_b64_tr_b16 v[184:185], v205 offset:4096
    ds_read_b64_tr_b16 v[186:187], v205 offset:6144
    s_waitcnt lgkmcnt(0)
    v_mfma_f32_32x32x16_bf16 v[52:67], v[184:187], v[104:107], v[52:67]
    ds_read_b64_tr_b16 v[188:189], v206 offset:4096
    ds_read_b64_tr_b16 v[190:191], v206 offset:6144
    s_waitcnt lgkmcnt(0)
    v_mfma_f32_32x32x16_bf16 v[68:83], v[188:191], v[104:107], v[68:83]
    ds_read_b64_tr_b16 v[192:193], v207 offset:4096
    ds_read_b64_tr_b16 v[194:195], v207 offset:6144
    s_waitcnt lgkmcnt(0)
    v_mfma_f32_32x32x16_bf16 v[84:99], v[192:195], v[104:107], v[84:99]
    s_waitcnt lgkmcnt(0)
A_sskips2:
    s_waitcnt vmcnt(8)
    s_barrier
    s_add_u32 s52, s52, 16384
    s_lshl_b32 s4, s56, 10
    s_add_u32 s5, s4, 32768
    s_mov_b32 m0, s5
    s_add_u32 s5, s4, s52
    s_add_u32 s5, s5, 0
    buffer_load_dwordx4 v221, s[12:15], s5 offen lds
    s_add_u32 s6, s4, 98304
    s_mov_b32 m0, s6
    s_nop 0
    buffer_load_dwordx4 v222, s[16:19], s5 offen lds
    s_lshl_b32 s4, s56, 10
    s_add_u32 s5, s4, 36864
    s_mov_b32 m0, s5
    s_add_u32 s5, s4, s52
    s_add_u32 s5, s5, 4096
    buffer_load_dwordx4 v221, s[12:15], s5 offen lds
    s_add_u32 s6, s4, 102400
    s_mov_b32 m0, s6
    s_nop 0
    buffer_load_dwordx4 v222, s[16:19], s5 offen lds
    s_lshl_b32 s4, s56, 10
    s_add_u32 s5, s4, 40960
    s_mov_b32 m0, s5
    s_add_u32 s5, s4, s52
    s_add_u32 s5, s5, 8192
    buffer_load_dwordx4 v221, s[12:15], s5 offen lds
    s_add_u32 s6, s4, 106496
    s_mov_b32 m0, s6
    s_nop 0
    buffer_load_dwordx4 v222, s[16:19], s5 offen lds
    s_lshl_b32 s4, s56, 10
    s_add_u32 s5, s4, 45056
    s_mov_b32 m0, s5
    s_add_u32 s5, s4, s52
    s_add_u32 s5, s5, 12288
    buffer_load_dwordx4 v221, s[12:15], s5 offen lds
    s_add_u32 s6, s4, 110592
    s_mov_b32 m0, s6
    s_nop 0
    buffer_load_dwordx4 v222, s[16:19], s5 offen lds
    s_cmp_lg_u32 s57, 1
    s_cbranch_scc1 A_sskips3
    ds_read_b128 v[164:167], v196 offset:16384
    s_waitcnt lgkmcnt(0)
    v_mfma_f32_32x32x16_bf16 v[100:115], v[164:167], v[4:7], 0
    ds_read_b128 v[168:171], v197 offset:16384
    s_waitcnt lgkmcnt(0)
    v_mfma_f32_32x32x16_bf16 v[100:115], v[168:171], v[8:11], v[100:115]
    ds_read_b128 v[172:175], v198 offset:16384
    s_waitcnt lgkmcnt(0)
    v_mfma_f32_32x32x16_bf16 v[100:115], v[172:175], v[12:15], v[100:115]
    ds_read_b128 v[176:179], v199 offset:16384
    s_waitcnt lgkmcnt(0)
    v_mfma_f32_32x32x16_bf16 v[100:115], v[176:179], v[16:19], v[100:115]
    ds_read_b128 v[164:167], v200 offset:16384
    s_waitcnt lgkmcnt(0)
    v_mfma_f32_32x32x16_bf16 v[100:115], v[164:167], v[20:23], v[100:115]
    ds_read_b128 v[168:171], v201 offset:16384
    s_waitcnt lgkmcnt(0)
    v_mfma_f32_32x32x16_bf16 v[100:115], v[168:171], v[24:27], v[100:115]
    ds_read_b128 v[172:175], v202 offset:16384
    s_waitcnt lgkmcnt(0)
    v_mfma_f32_32x32x16_bf16 v[100:115], v[172:175], v[28:31], v[100:115]
    ds_read_b128 v[176:179], v203 offset:16384
    s_waitcnt lgkmcnt(0)
    v_mfma_f32_32x32x16_bf16 v[100:115], v[176:179], v[32:35], v[100:115]
    s_nop 11
    v_max3_f32 v213, v100, v101, v102
    v_max3_f32 v214, v103, v104, v105
    v_max3_f32 v215, v106, v107, v108
    v_max3_f32 v216, v109, v110, v111
    v_max3_f32 v217, v112, v113, v114
    v_max3_f32 v213, v213, v214, v115
    v_max3_f32 v215, v215, v216, v217
    v_max_f32 v213, v213, v215
    v_mov_b32 v214, v213
    s_nop 1
    v_permlane32_swap_b32 v213, v214
    v_max3_f32 v213, v213, v214, v208
    v_sub_f32 v214, v213, v208
    v_cmp_lt_f32 vcc, s49, v214
    s_nop 1
    s_cbranch_vccz A_snrs3
    v_mul_f32 v214, s55, v214
    v_exp_f32 v211, v214
    s_nop 0
    v_mul_f32 v209, v209, v211
    v_mov_b32 v208, v213
    v_mul_f32 v36, v36, v211
    v_mul_f32 v37, v37, v211
    v_mul_f32 v38, v38, v211
    v_mul_f32 v39, v39, v211
    v_mul_f32 v40, v40, v211
    v_mul_f32 v41, v41, v211
    v_mul_f32 v42, v42, v211
    v_mul_f32 v43, v43, v211
    v_mul_f32 v44, v44, v211
    v_mul_f32 v45, v45, v211
    v_mul_f32 v46, v46, v211
    v_mul_f32 v47, v47, v211
    v_mul_f32 v48, v48, v211
    v_mul_f32 v49, v49, v211
    v_mul_f32 v50, v50, v211
    v_mul_f32 v51, v51, v211
    v_mul_f32 v52, v52, v211
    v_mul_f32 v53, v53, v211
    v_mul_f32 v54, v54, v211
    v_mul_f32 v55, v55, v211
    v_mul_f32 v56, v56, v211
    v_mul_f32 v57, v57, v211
    v_mul_f32 v58, v58, v211
    v_mul_f32 v59, v59, v211
    v_mul_f32 v60, v60, v211
    v_mul_f32 v61, v61, v211
    v_mul_f32 v62, v62, v211
    v_mul_f32 v63, v63, v211
    v_mul_f32 v64, v64, v211
    v_mul_f32 v65, v65, v211
    v_mul_f32 v66, v66, v211
    v_mul_f32 v67, v67, v211
    v_mul_f32 v68, v68, v211
    v_mul_f32 v69, v69, v211
    v_mul_f32 v70, v70, v211
    v_mul_f32 v71, v71, v211
    v_mul_f32 v72, v72, v211
    v_mul_f32 v73, v73, v211
    v_mul_f32 v74, v74, v211
    v_mul_f32 v75, v75, v211
    v_mul_f32 v76, v76, v211
    v_mul_f32 v77, v77, v211
    v_mul_f32 v78, v78, v211
    v_mul_f32 v79, v79, v211
    v_mul_f32 v80, v80, v211
    v_mul_f32 v81, v81, v211
    v_mul_f32 v82, v82, v211
    v_mul_f32 v83, v83, v211
    v_mul_f32 v84, v84, v211
    v_mul_f32 v85, v85, v211
    v_mul_f32 v86, v86, v211
    v_mul_f32 v87, v87, v211
    v_mul_f32 v88, v88, v211
    v_mul_f32 v89, v89, v211
    v_mul_f32 v90, v90, v211
    v_mul_f32 v91, v91, v211
    v_mul_f32 v92, v92, v211
    v_mul_f32 v93, v93, v211
    v_mul_f32 v94, v94, v211
    v_mul_f32 v95, v95, v211
    v_mul_f32 v96, v96, v211
    v_mul_f32 v97, v97, v211
    v_mul_f32 v98, v98, v211
    v_mul_f32 v99, v99, v211
A_snrs3:
    v_mul_f32 v212, s48, v208
    v_fma_f32 v100, v100, s48, -v212
    v_exp_f32 v100, v100
    s_nop 0
    v_add_f32 v209, v209, v100
    v_fma_f32 v101, v101, s48, -v212
    v_exp_f32 v101, v101
    s_nop 0
    v_add_f32 v209, v209, v101
    v_cvt_pk_bf16_f32 v100, v100, v101
    v_fma_f32 v102, v102, s48, -v212
    v_exp_f32 v102, v102
    s_nop 0
    v_add_f32 v209, v209, v102
    v_fma_f32 v103, v103, s48, -v212
    v_exp_f32 v103, v103
    s_nop 0
    v_add_f32 v209, v209, v103
    v_cvt_pk_bf16_f32 v101, v102, v103
    v_fma_f32 v104, v104, s48, -v212
    v_exp_f32 v104, v104
    s_nop 0
    v_add_f32 v209, v209, v104
    v_fma_f32 v105, v105, s48, -v212
    v_exp_f32 v105, v105
    s_nop 0
    v_add_f32 v209, v209, v105
    v_cvt_pk_bf16_f32 v102, v104, v105
    v_fma_f32 v106, v106, s48, -v212
    v_exp_f32 v106, v106
    s_nop 0
    v_add_f32 v209, v209, v106
    v_fma_f32 v107, v107, s48, -v212
    v_exp_f32 v107, v107
    s_nop 0
    v_add_f32 v209, v209, v107
    v_cvt_pk_bf16_f32 v103, v106, v107
    v_fma_f32 v108, v108, s48, -v212
    v_exp_f32 v108, v108
    s_nop 0
    v_add_f32 v209, v209, v108
    v_fma_f32 v109, v109, s48, -v212
    v_exp_f32 v109, v109
    s_nop 0
    v_add_f32 v209, v209, v109
    v_cvt_pk_bf16_f32 v104, v108, v109
    v_fma_f32 v110, v110, s48, -v212
    v_exp_f32 v110, v110
    s_nop 0
    v_add_f32 v209, v209, v110
    v_fma_f32 v111, v111, s48, -v212
    v_exp_f32 v111, v111
    s_nop 0
    v_add_f32 v209, v209, v111
    v_cvt_pk_bf16_f32 v105, v110, v111
    v_fma_f32 v112, v112, s48, -v212
    v_exp_f32 v112, v112
    s_nop 0
    v_add_f32 v209, v209, v112
    v_fma_f32 v113, v113, s48, -v212
    v_exp_f32 v113, v113
    s_nop 0
    v_add_f32 v209, v209, v113
    v_cvt_pk_bf16_f32 v106, v112, v113
    v_fma_f32 v114, v114, s48, -v212
    v_exp_f32 v114, v114
    s_nop 0
    v_add_f32 v209, v209, v114
    v_fma_f32 v115, v115, s48, -v212
    v_exp_f32 v115, v115
    s_nop 0
    v_add_f32 v209, v209, v115
    v_cvt_pk_bf16_f32 v107, v114, v115
    ds_read_b64_tr_b16 v[180:181], v204 offset:16384
    ds_read_b64_tr_b16 v[182:183], v204 offset:18432
    s_waitcnt lgkmcnt(0)
    v_mfma_f32_32x32x16_bf16 v[36:51], v[180:183], v[100:103], v[36:51]
    ds_read_b64_tr_b16 v[184:185], v205 offset:16384
    ds_read_b64_tr_b16 v[186:187], v205 offset:18432
    s_waitcnt lgkmcnt(0)
    v_mfma_f32_32x32x16_bf16 v[52:67], v[184:187], v[100:103], v[52:67]
    ds_read_b64_tr_b16 v[188:189], v206 offset:16384
    ds_read_b64_tr_b16 v[190:191], v206 offset:18432
    s_waitcnt lgkmcnt(0)
    v_mfma_f32_32x32x16_bf16 v[68:83], v[188:191], v[100:103], v[68:83]
    ds_read_b64_tr_b16 v[192:193], v207 offset:16384
    ds_read_b64_tr_b16 v[194:195], v207 offset:18432
    s_waitcnt lgkmcnt(0)
    v_mfma_f32_32x32x16_bf16 v[84:99], v[192:195], v[100:103], v[84:99]
    ds_read_b64_tr_b16 v[180:181], v204 offset:20480
    ds_read_b64_tr_b16 v[182:183], v204 offset:22528
    s_waitcnt lgkmcnt(0)
    v_mfma_f32_32x32x16_bf16 v[36:51], v[180:183], v[104:107], v[36:51]
    ds_read_b64_tr_b16 v[184:185], v205 offset:20480
    ds_read_b64_tr_b16 v[186:187], v205 offset:22528
    s_waitcnt lgkmcnt(0)
    v_mfma_f32_32x32x16_bf16 v[52:67], v[184:187], v[104:107], v[52:67]
    ds_read_b64_tr_b16 v[188:189], v206 offset:20480
    ds_read_b64_tr_b16 v[190:191], v206 offset:22528
    s_waitcnt lgkmcnt(0)
    v_mfma_f32_32x32x16_bf16 v[68:83], v[188:191], v[104:107], v[68:83]
    ds_read_b64_tr_b16 v[192:193], v207 offset:20480
    ds_read_b64_tr_b16 v[194:195], v207 offset:22528
    s_waitcnt lgkmcnt(0)
    v_mfma_f32_32x32x16_bf16 v[84:99], v[192:195], v[104:107], v[84:99]
    s_waitcnt lgkmcnt(0)
A_sskips3:
    s_waitcnt vmcnt(8)
    s_barrier
    v_xor_b32 v196, 0x8000, v196
    v_xor_b32 v197, 0x8000, v197
    v_xor_b32 v198, 0x8000, v198
    v_xor_b32 v199, 0x8000, v199
    v_xor_b32 v200, 0x8000, v200
    v_xor_b32 v201, 0x8000, v201
    v_xor_b32 v202, 0x8000, v202
    v_xor_b32 v203, 0x8000, v203
    v_xor_b32 v204, 0x8000, v204
    v_xor_b32 v205, 0x8000, v205
    v_xor_b32 v206, 0x8000, v206
    v_xor_b32 v207, 0x8000, v207
    s_add_u32 s52, s52, 16384
    s_lshl_b32 s4, s56, 10
    s_add_u32 s5, s4, 49152
    s_mov_b32 m0, s5
    s_add_u32 s5, s4, s52
    s_add_u32 s5, s5, 0
    buffer_load_dwordx4 v221, s[12:15], s5 offen lds
    s_add_u32 s6, s4, 114688
    s_mov_b32 m0, s6
    s_nop 0
    buffer_load_dwordx4 v222, s[16:19], s5 offen lds
    s_lshl_b32 s4, s56, 10
    s_add_u32 s5, s4, 53248
    s_mov_b32 m0, s5
    s_add_u32 s5, s4, s52
    s_add_u32 s5, s5, 4096
    buffer_load_dwordx4 v221, s[12:15], s5 offen lds
    s_add_u32 s6, s4, 118784
    s_mov_b32 m0, s6
    s_nop 0
    buffer_load_dwordx4 v222, s[16:19], s5 offen lds
    s_lshl_b32 s4, s56, 10
    s_add_u32 s5, s4, 57344
    s_mov_b32 m0, s5
    s_add_u32 s5, s4, s52
    s_add_u32 s5, s5, 8192
    buffer_load_dwordx4 v221, s[12:15], s5 offen lds
    s_add_u32 s6, s4, 122880
    s_mov_b32 m0, s6
    s_nop 0
    buffer_load_dwordx4 v222, s[16:19], s5 offen lds
    s_lshl_b32 s4, s56, 10
    s_add_u32 s5, s4, 61440
    s_mov_b32 m0, s5
    s_add_u32 s5, s4, s52
    s_add_u32 s5, s5, 12288
    buffer_load_dwordx4 v221, s[12:15], s5 offen lds
    s_add_u32 s6, s4, 126976
    s_mov_b32 m0, s6
    s_nop 0
    buffer_load_dwordx4 v222, s[16:19], s5 offen lds
    s_cmp_lg_u32 s57, 0
    s_cbranch_scc1 A_sskips4
    ds_read_b128 v[164:167], v196 offset:0
    s_waitcnt lgkmcnt(0)
    v_mfma_f32_32x32x16_bf16 v[100:115], v[164:167], v[4:7], 0
    ds_read_b128 v[168:171], v197 offset:0
    s_waitcnt lgkmcnt(0)
    v_mfma_f32_32x32x16_bf16 v[100:115], v[168:171], v[8:11], v[100:115]
    ds_read_b128 v[172:175], v198 offset:0
    s_waitcnt lgkmcnt(0)
    v_mfma_f32_32x32x16_bf16 v[100:115], v[172:175], v[12:15], v[100:115]
    ds_read_b128 v[176:179], v199 offset:0
    s_waitcnt lgkmcnt(0)
    v_mfma_f32_32x32x16_bf16 v[100:115], v[176:179], v[16:19], v[100:115]
    ds_read_b128 v[164:167], v200 offset:0
    s_waitcnt lgkmcnt(0)
    v_mfma_f32_32x32x16_bf16 v[100:115], v[164:167], v[20:23], v[100:115]
    ds_read_b128 v[168:171], v201 offset:0
    s_waitcnt lgkmcnt(0)
    v_mfma_f32_32x32x16_bf16 v[100:115], v[168:171], v[24:27], v[100:115]
    ds_read_b128 v[172:175], v202 offset:0
    s_waitcnt lgkmcnt(0)
    v_mfma_f32_32x32x16_bf16 v[100:115], v[172:175], v[28:31], v[100:115]
    ds_read_b128 v[176:179], v203 offset:0
    s_waitcnt lgkmcnt(0)
    v_mfma_f32_32x32x16_bf16 v[100:115], v[176:179], v[32:35], v[100:115]
    s_nop 11
    v_max3_f32 v213, v100, v101, v102
    v_max3_f32 v214, v103, v104, v105
    v_max3_f32 v215, v106, v107, v108
    v_max3_f32 v216, v109, v110, v111
    v_max3_f32 v217, v112, v113, v114
    v_max3_f32 v213, v213, v214, v115
    v_max3_f32 v215, v215, v216, v217
    v_max_f32 v213, v213, v215
    v_mov_b32 v214, v213
    s_nop 1
    v_permlane32_swap_b32 v213, v214
    v_max3_f32 v213, v213, v214, v208
    v_sub_f32 v214, v213, v208
    v_cmp_lt_f32 vcc, s49, v214
    s_nop 1
    s_cbranch_vccz A_snrs4
    v_mul_f32 v214, s55, v214
    v_exp_f32 v211, v214
    s_nop 0
    v_mul_f32 v209, v209, v211
    v_mov_b32 v208, v213
    v_mul_f32 v36, v36, v211
    v_mul_f32 v37, v37, v211
    v_mul_f32 v38, v38, v211
    v_mul_f32 v39, v39, v211
    v_mul_f32 v40, v40, v211
    v_mul_f32 v41, v41, v211
    v_mul_f32 v42, v42, v211
    v_mul_f32 v43, v43, v211
    v_mul_f32 v44, v44, v211
    v_mul_f32 v45, v45, v211
    v_mul_f32 v46, v46, v211
    v_mul_f32 v47, v47, v211
    v_mul_f32 v48, v48, v211
    v_mul_f32 v49, v49, v211
    v_mul_f32 v50, v50, v211
    v_mul_f32 v51, v51, v211
    v_mul_f32 v52, v52, v211
    v_mul_f32 v53, v53, v211
    v_mul_f32 v54, v54, v211
    v_mul_f32 v55, v55, v211
    v_mul_f32 v56, v56, v211
    v_mul_f32 v57, v57, v211
    v_mul_f32 v58, v58, v211
    v_mul_f32 v59, v59, v211
    v_mul_f32 v60, v60, v211
    v_mul_f32 v61, v61, v211
    v_mul_f32 v62, v62, v211
    v_mul_f32 v63, v63, v211
    v_mul_f32 v64, v64, v211
    v_mul_f32 v65, v65, v211
    v_mul_f32 v66, v66, v211
    v_mul_f32 v67, v67, v211
    v_mul_f32 v68, v68, v211
    v_mul_f32 v69, v69, v211
    v_mul_f32 v70, v70, v211
    v_mul_f32 v71, v71, v211
    v_mul_f32 v72, v72, v211
    v_mul_f32 v73, v73, v211
    v_mul_f32 v74, v74, v211
    v_mul_f32 v75, v75, v211
    v_mul_f32 v76, v76, v211
    v_mul_f32 v77, v77, v211
    v_mul_f32 v78, v78, v211
    v_mul_f32 v79, v79, v211
    v_mul_f32 v80, v80, v211
    v_mul_f32 v81, v81, v211
    v_mul_f32 v82, v82, v211
    v_mul_f32 v83, v83, v211
    v_mul_f32 v84, v84, v211
    v_mul_f32 v85, v85, v211
    v_mul_f32 v86, v86, v211
    v_mul_f32 v87, v87, v211
    v_mul_f32 v88, v88, v211
    v_mul_f32 v89, v89, v211
    v_mul_f32 v90, v90, v211
    v_mul_f32 v91, v91, v211
    v_mul_f32 v92, v92, v211
    v_mul_f32 v93, v93, v211
    v_mul_f32 v94, v94, v211
    v_mul_f32 v95, v95, v211
    v_mul_f32 v96, v96, v211
    v_mul_f32 v97, v97, v211
    v_mul_f32 v98, v98, v211
    v_mul_f32 v99, v99, v211
A_snrs4:
    v_mul_f32 v212, s48, v208
    v_fma_f32 v100, v100, s48, -v212
    v_exp_f32 v100, v100
    s_nop 0
    v_add_f32 v209, v209, v100
    v_fma_f32 v101, v101, s48, -v212
    v_exp_f32 v101, v101
    s_nop 0
    v_add_f32 v209, v209, v101
    v_cvt_pk_bf16_f32 v100, v100, v101
    v_fma_f32 v102, v102, s48, -v212
    v_exp_f32 v102, v102
    s_nop 0
    v_add_f32 v209, v209, v102
    v_fma_f32 v103, v103, s48, -v212
    v_exp_f32 v103, v103
    s_nop 0
    v_add_f32 v209, v209, v103
    v_cvt_pk_bf16_f32 v101, v102, v103
    v_fma_f32 v104, v104, s48, -v212
    v_exp_f32 v104, v104
    s_nop 0
    v_add_f32 v209, v209, v104
    v_fma_f32 v105, v105, s48, -v212
    v_exp_f32 v105, v105
    s_nop 0
    v_add_f32 v209, v209, v105
    v_cvt_pk_bf16_f32 v102, v104, v105
    v_fma_f32 v106, v106, s48, -v212
    v_exp_f32 v106, v106
    s_nop 0
    v_add_f32 v209, v209, v106
    v_fma_f32 v107, v107, s48, -v212
    v_exp_f32 v107, v107
    s_nop 0
    v_add_f32 v209, v209, v107
    v_cvt_pk_bf16_f32 v103, v106, v107
    v_fma_f32 v108, v108, s48, -v212
    v_exp_f32 v108, v108
    s_nop 0
    v_add_f32 v209, v209, v108
    v_fma_f32 v109, v109, s48, -v212
    v_exp_f32 v109, v109
    s_nop 0
    v_add_f32 v209, v209, v109
    v_cvt_pk_bf16_f32 v104, v108, v109
    v_fma_f32 v110, v110, s48, -v212
    v_exp_f32 v110, v110
    s_nop 0
    v_add_f32 v209, v209, v110
    v_fma_f32 v111, v111, s48, -v212
    v_exp_f32 v111, v111
    s_nop 0
    v_add_f32 v209, v209, v111
    v_cvt_pk_bf16_f32 v105, v110, v111
    v_fma_f32 v112, v112, s48, -v212
    v_exp_f32 v112, v112
    s_nop 0
    v_add_f32 v209, v209, v112
    v_fma_f32 v113, v113, s48, -v212
    v_exp_f32 v113, v113
    s_nop 0
    v_add_f32 v209, v209, v113
    v_cvt_pk_bf16_f32 v106, v112, v113
    v_fma_f32 v114, v114, s48, -v212
    v_exp_f32 v114, v114
    s_nop 0
    v_add_f32 v209, v209, v114
    v_fma_f32 v115, v115, s48, -v212
    v_exp_f32 v115, v115
    s_nop 0
    v_add_f32 v209, v209, v115
    v_cvt_pk_bf16_f32 v107, v114, v115
    ds_read_b64_tr_b16 v[180:181], v204 offset:0
    ds_read_b64_tr_b16 v[182:183], v204 offset:2048
    s_waitcnt lgkmcnt(0)
    v_mfma_f32_32x32x16_bf16 v[36:51], v[180:183], v[100:103], v[36:51]
    ds_read_b64_tr_b16 v[184:185], v205 offset:0
    ds_read_b64_tr_b16 v[186:187], v205 offset:2048
    s_waitcnt lgkmcnt(0)
    v_mfma_f32_32x32x16_bf16 v[52:67], v[184:187], v[100:103], v[52:67]
    ds_read_b64_tr_b16 v[188:189], v206 offset:0
    ds_read_b64_tr_b16 v[190:191], v206 offset:2048
    s_waitcnt lgkmcnt(0)
    v_mfma_f32_32x32x16_bf16 v[68:83], v[188:191], v[100:103], v[68:83]
    ds_read_b64_tr_b16 v[192:193], v207 offset:0
    ds_read_b64_tr_b16 v[194:195], v207 offset:2048
    s_waitcnt lgkmcnt(0)
    v_mfma_f32_32x32x16_bf16 v[84:99], v[192:195], v[100:103], v[84:99]
    ds_read_b64_tr_b16 v[180:181], v204 offset:4096
    ds_read_b64_tr_b16 v[182:183], v204 offset:6144
    s_waitcnt lgkmcnt(0)
    v_mfma_f32_32x32x16_bf16 v[36:51], v[180:183], v[104:107], v[36:51]
    ds_read_b64_tr_b16 v[184:185], v205 offset:4096
    ds_read_b64_tr_b16 v[186:187], v205 offset:6144
    s_waitcnt lgkmcnt(0)
    v_mfma_f32_32x32x16_bf16 v[52:67], v[184:187], v[104:107], v[52:67]
    ds_read_b64_tr_b16 v[188:189], v206 offset:4096
    ds_read_b64_tr_b16 v[190:191], v206 offset:6144
    s_waitcnt lgkmcnt(0)
    v_mfma_f32_32x32x16_bf16 v[68:83], v[188:191], v[104:107], v[68:83]
    ds_read_b64_tr_b16 v[192:193], v207 offset:4096
    ds_read_b64_tr_b16 v[194:195], v207 offset:6144
    s_waitcnt lgkmcnt(0)
    v_mfma_f32_32x32x16_bf16 v[84:99], v[192:195], v[104:107], v[84:99]
    s_waitcnt lgkmcnt(0)
A_sskips4:
    s_waitcnt vmcnt(8)
    s_barrier
    s_add_u32 s52, s52, 16384
    s_lshl_b32 s4, s56, 10
    s_add_u32 s5, s4, 0
    s_mov_b32 m0, s5
    s_add_u32 s5, s4, s52
    s_add_u32 s5, s5, 0
    buffer_load_dwordx4 v221, s[12:15], s5 offen lds
    s_add_u32 s6, s4, 65536
    s_mov_b32 m0, s6
    s_nop 0
    buffer_load_dwordx4 v222, s[16:19], s5 offen lds
    s_lshl_b32 s4, s56, 10
    s_add_u32 s5, s4, 4096
    s_mov_b32 m0, s5
    s_add_u32 s5, s4, s52
    s_add_u32 s5, s5, 4096
    buffer_load_dwordx4 v221, s[12:15], s5 offen lds
    s_add_u32 s6, s4, 69632
    s_mov_b32 m0, s6
    s_nop 0
    buffer_load_dwordx4 v222, s[16:19], s5 offen lds
    s_lshl_b32 s4, s56, 10
    s_add_u32 s5, s4, 8192
    s_mov_b32 m0, s5
    s_add_u32 s5, s4, s52
    s_add_u32 s5, s5, 8192
    buffer_load_dwordx4 v221, s[12:15], s5 offen lds
    s_add_u32 s6, s4, 73728
    s_mov_b32 m0, s6
    s_nop 0
    buffer_load_dwordx4 v222, s[16:19], s5 offen lds
    s_lshl_b32 s4, s56, 10
    s_add_u32 s5, s4, 12288
    s_mov_b32 m0, s5
    s_add_u32 s5, s4, s52
    s_add_u32 s5, s5, 12288
    buffer_load_dwordx4 v221, s[12:15], s5 offen lds
    s_add_u32 s6, s4, 77824
    s_mov_b32 m0, s6
    s_nop 0
    buffer_load_dwordx4 v222, s[16:19], s5 offen lds
    s_cmp_lg_u32 s57, 1
    s_cbranch_scc1 A_sskips5
    ds_read_b128 v[164:167], v196 offset:16384
    s_waitcnt lgkmcnt(0)
    v_mfma_f32_32x32x16_bf16 v[100:115], v[164:167], v[4:7], 0
    ds_read_b128 v[168:171], v197 offset:16384
    s_waitcnt lgkmcnt(0)
    v_mfma_f32_32x32x16_bf16 v[100:115], v[168:171], v[8:11], v[100:115]
    ds_read_b128 v[172:175], v198 offset:16384
    s_waitcnt lgkmcnt(0)
    v_mfma_f32_32x32x16_bf16 v[100:115], v[172:175], v[12:15], v[100:115]
    ds_read_b128 v[176:179], v199 offset:16384
    s_waitcnt lgkmcnt(0)
    v_mfma_f32_32x32x16_bf16 v[100:115], v[176:179], v[16:19], v[100:115]
    ds_read_b128 v[164:167], v200 offset:16384
    s_waitcnt lgkmcnt(0)
    v_mfma_f32_32x32x16_bf16 v[100:115], v[164:167], v[20:23], v[100:115]
    ds_read_b128 v[168:171], v201 offset:16384
    s_waitcnt lgkmcnt(0)
    v_mfma_f32_32x32x16_bf16 v[100:115], v[168:171], v[24:27], v[100:115]
    ds_read_b128 v[172:175], v202 offset:16384
    s_waitcnt lgkmcnt(0)
    v_mfma_f32_32x32x16_bf16 v[100:115], v[172:175], v[28:31], v[100:115]
    ds_read_b128 v[176:179], v203 offset:16384
    s_waitcnt lgkmcnt(0)
    v_mfma_f32_32x32x16_bf16 v[100:115], v[176:179], v[32:35], v[100:115]
    s_nop 11
    v_max3_f32 v213, v100, v101, v102
    v_max3_f32 v214, v103, v104, v105
    v_max3_f32 v215, v106, v107, v108
    v_max3_f32 v216, v109, v110, v111
    v_max3_f32 v217, v112, v113, v114
    v_max3_f32 v213, v213, v214, v115
    v_max3_f32 v215, v215, v216, v217
    v_max_f32 v213, v213, v215
    v_mov_b32 v214, v213
    s_nop 1
    v_permlane32_swap_b32 v213, v214
    v_max3_f32 v213, v213, v214, v208
    v_sub_f32 v214, v213, v208
    v_cmp_lt_f32 vcc, s49, v214
    s_nop 1
    s_cbranch_vccz A_snrs5
    v_mul_f32 v214, s55, v214
    v_exp_f32 v211, v214
    s_nop 0
    v_mul_f32 v209, v209, v211
    v_mov_b32 v208, v213
    v_mul_f32 v36, v36, v211
    v_mul_f32 v37, v37, v211
    v_mul_f32 v38, v38, v211
    v_mul_f32 v39, v39, v211
    v_mul_f32 v40, v40, v211
    v_mul_f32 v41, v41, v211
    v_mul_f32 v42, v42, v211
    v_mul_f32 v43, v43, v211
    v_mul_f32 v44, v44, v211
    v_mul_f32 v45, v45, v211
    v_mul_f32 v46, v46, v211
    v_mul_f32 v47, v47, v211
    v_mul_f32 v48, v48, v211
    v_mul_f32 v49, v49, v211
    v_mul_f32 v50, v50, v211
    v_mul_f32 v51, v51, v211
    v_mul_f32 v52, v52, v211
    v_mul_f32 v53, v53, v211
    v_mul_f32 v54, v54, v211
    v_mul_f32 v55, v55, v211
    v_mul_f32 v56, v56, v211
    v_mul_f32 v57, v57, v211
    v_mul_f32 v58, v58, v211
    v_mul_f32 v59, v59, v211
    v_mul_f32 v60, v60, v211
    v_mul_f32 v61, v61, v211
    v_mul_f32 v62, v62, v211
    v_mul_f32 v63, v63, v211
    v_mul_f32 v64, v64, v211
    v_mul_f32 v65, v65, v211
    v_mul_f32 v66, v66, v211
    v_mul_f32 v67, v67, v211
    v_mul_f32 v68, v68, v211
    v_mul_f32 v69, v69, v211
    v_mul_f32 v70, v70, v211
    v_mul_f32 v71, v71, v211
    v_mul_f32 v72, v72, v211
    v_mul_f32 v73, v73, v211
    v_mul_f32 v74, v74, v211
    v_mul_f32 v75, v75, v211
    v_mul_f32 v76, v76, v211
    v_mul_f32 v77, v77, v211
    v_mul_f32 v78, v78, v211
    v_mul_f32 v79, v79, v211
    v_mul_f32 v80, v80, v211
    v_mul_f32 v81, v81, v211
    v_mul_f32 v82, v82, v211
    v_mul_f32 v83, v83, v211
    v_mul_f32 v84, v84, v211
    v_mul_f32 v85, v85, v211
    v_mul_f32 v86, v86, v211
    v_mul_f32 v87, v87, v211
    v_mul_f32 v88, v88, v211
    v_mul_f32 v89, v89, v211
    v_mul_f32 v90, v90, v211
    v_mul_f32 v91, v91, v211
    v_mul_f32 v92, v92, v211
    v_mul_f32 v93, v93, v211
    v_mul_f32 v94, v94, v211
    v_mul_f32 v95, v95, v211
    v_mul_f32 v96, v96, v211
    v_mul_f32 v97, v97, v211
    v_mul_f32 v98, v98, v211
    v_mul_f32 v99, v99, v211
A_snrs5:
    v_mul_f32 v212, s48, v208
    v_fma_f32 v100, v100, s48, -v212
    v_exp_f32 v100, v100
    s_nop 0
    v_add_f32 v209, v209, v100
    v_fma_f32 v101, v101, s48, -v212
    v_exp_f32 v101, v101
    s_nop 0
    v_add_f32 v209, v209, v101
    v_cvt_pk_bf16_f32 v100, v100, v101
    v_fma_f32 v102, v102, s48, -v212
    v_exp_f32 v102, v102
    s_nop 0
    v_add_f32 v209, v209, v102
    v_fma_f32 v103, v103, s48, -v212
    v_exp_f32 v103, v103
    s_nop 0
    v_add_f32 v209, v209, v103
    v_cvt_pk_bf16_f32 v101, v102, v103
    v_fma_f32 v104, v104, s48, -v212
    v_exp_f32 v104, v104
    s_nop 0
    v_add_f32 v209, v209, v104
    v_fma_f32 v105, v105, s48, -v212
    v_exp_f32 v105, v105
    s_nop 0
    v_add_f32 v209, v209, v105
    v_cvt_pk_bf16_f32 v102, v104, v105
    v_fma_f32 v106, v106, s48, -v212
    v_exp_f32 v106, v106
    s_nop 0
    v_add_f32 v209, v209, v106
    v_fma_f32 v107, v107, s48, -v212
    v_exp_f32 v107, v107
    s_nop 0
    v_add_f32 v209, v209, v107
    v_cvt_pk_bf16_f32 v103, v106, v107
    v_fma_f32 v108, v108, s48, -v212
    v_exp_f32 v108, v108
    s_nop 0
    v_add_f32 v209, v209, v108
    v_fma_f32 v109, v109, s48, -v212
    v_exp_f32 v109, v109
    s_nop 0
    v_add_f32 v209, v209, v109
    v_cvt_pk_bf16_f32 v104, v108, v109
    v_fma_f32 v110, v110, s48, -v212
    v_exp_f32 v110, v110
    s_nop 0
    v_add_f32 v209, v209, v110
    v_fma_f32 v111, v111, s48, -v212
    v_exp_f32 v111, v111
    s_nop 0
    v_add_f32 v209, v209, v111
    v_cvt_pk_bf16_f32 v105, v110, v111
    v_fma_f32 v112, v112, s48, -v212
    v_exp_f32 v112, v112
    s_nop 0
    v_add_f32 v209, v209, v112
    v_fma_f32 v113, v113, s48, -v212
    v_exp_f32 v113, v113
    s_nop 0
    v_add_f32 v209, v209, v113
    v_cvt_pk_bf16_f32 v106, v112, v113
    v_fma_f32 v114, v114, s48, -v212
    v_exp_f32 v114, v114
    s_nop 0
    v_add_f32 v209, v209, v114
    v_fma_f32 v115, v115, s48, -v212
    v_exp_f32 v115, v115
    s_nop 0
    v_add_f32 v209, v209, v115
    v_cvt_pk_bf16_f32 v107, v114, v115
    ds_read_b64_tr_b16 v[180:181], v204 offset:16384
    ds_read_b64_tr_b16 v[182:183], v204 offset:18432
    s_waitcnt lgkmcnt(0)
    v_mfma_f32_32x32x16_bf16 v[36:51], v[180:183], v[100:103], v[36:51]
    ds_read_b64_tr_b16 v[184:185], v205 offset:16384
    ds_read_b64_tr_b16 v[186:187], v205 offset:18432
    s_waitcnt lgkmcnt(0)
    v_mfma_f32_32x32x16_bf16 v[52:67], v[184:187], v[100:103], v[52:67]
    ds_read_b64_tr_b16 v[188:189], v206 offset:16384
    ds_read_b64_tr_b16 v[190:191], v206 offset:18432
    s_waitcnt lgkmcnt(0)
    v_mfma_f32_32x32x16_bf16 v[68:83], v[188:191], v[100:103], v[68:83]
    ds_read_b64_tr_b16 v[192:193], v207 offset:16384
    ds_read_b64_tr_b16 v[194:195], v207 offset:18432
    s_waitcnt lgkmcnt(0)
    v_mfma_f32_32x32x16_bf16 v[84:99], v[192:195], v[100:103], v[84:99]
    ds_read_b64_tr_b16 v[180:181], v204 offset:20480
    ds_read_b64_tr_b16 v[182:183], v204 offset:22528
    s_waitcnt lgkmcnt(0)
    v_mfma_f32_32x32x16_bf16 v[36:51], v[180:183], v[104:107], v[36:51]
    ds_read_b64_tr_b16 v[184:185], v205 offset:20480
    ds_read_b64_tr_b16 v[186:187], v205 offset:22528
    s_waitcnt lgkmcnt(0)
    v_mfma_f32_32x32x16_bf16 v[52:67], v[184:187], v[104:107], v[52:67]
    ds_read_b64_tr_b16 v[188:189], v206 offset:20480
    ds_read_b64_tr_b16 v[190:191], v206 offset:22528
    s_waitcnt lgkmcnt(0)
    v_mfma_f32_32x32x16_bf16 v[68:83], v[188:191], v[104:107], v[68:83]
    ds_read_b64_tr_b16 v[192:193], v207 offset:20480
    ds_read_b64_tr_b16 v[194:195], v207 offset:22528
    s_waitcnt lgkmcnt(0)
    v_mfma_f32_32x32x16_bf16 v[84:99], v[192:195], v[104:107], v[84:99]
    s_waitcnt lgkmcnt(0)
A_sskips5:
    s_waitcnt vmcnt(8)
    s_barrier
    v_xor_b32 v196, 0x8000, v196
    v_xor_b32 v197, 0x8000, v197
    v_xor_b32 v198, 0x8000, v198
    v_xor_b32 v199, 0x8000, v199
    v_xor_b32 v200, 0x8000, v200
    v_xor_b32 v201, 0x8000, v201
    v_xor_b32 v202, 0x8000, v202
    v_xor_b32 v203, 0x8000, v203
    v_xor_b32 v204, 0x8000, v204
    v_xor_b32 v205, 0x8000, v205
    v_xor_b32 v206, 0x8000, v206
    v_xor_b32 v207, 0x8000, v207
    s_add_u32 s52, s52, 16384
    s_lshl_b32 s4, s56, 10
    s_add_u32 s5, s4, 16384
    s_mov_b32 m0, s5
    s_add_u32 s5, s4, s52
    s_add_u32 s5, s5, 0
    buffer_load_dwordx4 v221, s[12:15], s5 offen lds
    s_add_u32 s6, s4, 81920
    s_mov_b32 m0, s6
    s_nop 0
    buffer_load_dwordx4 v222, s[16:19], s5 offen lds
    s_lshl_b32 s4, s56, 10
    s_add_u32 s5, s4, 20480
    s_mov_b32 m0, s5
    s_add_u32 s5, s4, s52
    s_add_u32 s5, s5, 4096
    buffer_load_dwordx4 v221, s[12:15], s5 offen lds
    s_add_u32 s6, s4, 86016
    s_mov_b32 m0, s6
    s_nop 0
    buffer_load_dwordx4 v222, s[16:19], s5 offen lds
    s_lshl_b32 s4, s56, 10
    s_add_u32 s5, s4, 24576
    s_mov_b32 m0, s5
    s_add_u32 s5, s4, s52
    s_add_u32 s5, s5, 8192
    buffer_load_dwordx4 v221, s[12:15], s5 offen lds
    s_add_u32 s6, s4, 90112
    s_mov_b32 m0, s6
    s_nop 0
    buffer_load_dwordx4 v222, s[16:19], s5 offen lds
    s_lshl_b32 s4, s56, 10
    s_add_u32 s5, s4, 28672
    s_mov_b32 m0, s5
    s_add_u32 s5, s4, s52
    s_add_u32 s5, s5, 12288
    buffer_load_dwordx4 v221, s[12:15], s5 offen lds
    s_add_u32 s6, s4, 94208
    s_mov_b32 m0, s6
    s_nop 0
    buffer_load_dwordx4 v222, s[16:19], s5 offen lds
    s_cmp_lg_u32 s57, 0
    s_cbranch_scc1 A_sskips6
    ds_read_b128 v[164:167], v196 offset:0
    s_waitcnt lgkmcnt(0)
    v_mfma_f32_32x32x16_bf16 v[100:115], v[164:167], v[4:7], 0
    ds_read_b128 v[168:171], v197 offset:0
    s_waitcnt lgkmcnt(0)
    v_mfma_f32_32x32x16_bf16 v[100:115], v[168:171], v[8:11], v[100:115]
    ds_read_b128 v[172:175], v198 offset:0
    s_waitcnt lgkmcnt(0)
    v_mfma_f32_32x32x16_bf16 v[100:115], v[172:175], v[12:15], v[100:115]
    ds_read_b128 v[176:179], v199 offset:0
    s_waitcnt lgkmcnt(0)
    v_mfma_f32_32x32x16_bf16 v[100:115], v[176:179], v[16:19], v[100:115]
    ds_read_b128 v[164:167], v200 offset:0
    s_waitcnt lgkmcnt(0)
    v_mfma_f32_32x32x16_bf16 v[100:115], v[164:167], v[20:23], v[100:115]
    ds_read_b128 v[168:171], v201 offset:0
    s_waitcnt lgkmcnt(0)
    v_mfma_f32_32x32x16_bf16 v[100:115], v[168:171], v[24:27], v[100:115]
    ds_read_b128 v[172:175], v202 offset:0
    s_waitcnt lgkmcnt(0)
    v_mfma_f32_32x32x16_bf16 v[100:115], v[172:175], v[28:31], v[100:115]
    ds_read_b128 v[176:179], v203 offset:0
    s_waitcnt lgkmcnt(0)
    v_mfma_f32_32x32x16_bf16 v[100:115], v[176:179], v[32:35], v[100:115]
    s_nop 11
    v_max3_f32 v213, v100, v101, v102
    v_max3_f32 v214, v103, v104, v105
    v_max3_f32 v215, v106, v107, v108
    v_max3_f32 v216, v109, v110, v111
    v_max3_f32 v217, v112, v113, v114
    v_max3_f32 v213, v213, v214, v115
    v_max3_f32 v215, v215, v216, v217
    v_max_f32 v213, v213, v215
    v_mov_b32 v214, v213
    s_nop 1
    v_permlane32_swap_b32 v213, v214
    v_max3_f32 v213, v213, v214, v208
    v_sub_f32 v214, v213, v208
    v_cmp_lt_f32 vcc, s49, v214
    s_nop 1
    s_cbranch_vccz A_snrs6
    v_mul_f32 v214, s55, v214
    v_exp_f32 v211, v214
    s_nop 0
    v_mul_f32 v209, v209, v211
    v_mov_b32 v208, v213
    v_mul_f32 v36, v36, v211
    v_mul_f32 v37, v37, v211
    v_mul_f32 v38, v38, v211
    v_mul_f32 v39, v39, v211
    v_mul_f32 v40, v40, v211
    v_mul_f32 v41, v41, v211
    v_mul_f32 v42, v42, v211
    v_mul_f32 v43, v43, v211
    v_mul_f32 v44, v44, v211
    v_mul_f32 v45, v45, v211
    v_mul_f32 v46, v46, v211
    v_mul_f32 v47, v47, v211
    v_mul_f32 v48, v48, v211
    v_mul_f32 v49, v49, v211
    v_mul_f32 v50, v50, v211
    v_mul_f32 v51, v51, v211
    v_mul_f32 v52, v52, v211
    v_mul_f32 v53, v53, v211
    v_mul_f32 v54, v54, v211
    v_mul_f32 v55, v55, v211
    v_mul_f32 v56, v56, v211
    v_mul_f32 v57, v57, v211
    v_mul_f32 v58, v58, v211
    v_mul_f32 v59, v59, v211
    v_mul_f32 v60, v60, v211
    v_mul_f32 v61, v61, v211
    v_mul_f32 v62, v62, v211
    v_mul_f32 v63, v63, v211
    v_mul_f32 v64, v64, v211
    v_mul_f32 v65, v65, v211
    v_mul_f32 v66, v66, v211
    v_mul_f32 v67, v67, v211
    v_mul_f32 v68, v68, v211
    v_mul_f32 v69, v69, v211
    v_mul_f32 v70, v70, v211
    v_mul_f32 v71, v71, v211
    v_mul_f32 v72, v72, v211
    v_mul_f32 v73, v73, v211
    v_mul_f32 v74, v74, v211
    v_mul_f32 v75, v75, v211
    v_mul_f32 v76, v76, v211
    v_mul_f32 v77, v77, v211
    v_mul_f32 v78, v78, v211
    v_mul_f32 v79, v79, v211
    v_mul_f32 v80, v80, v211
    v_mul_f32 v81, v81, v211
    v_mul_f32 v82, v82, v211
    v_mul_f32 v83, v83, v211
    v_mul_f32 v84, v84, v211
    v_mul_f32 v85, v85, v211
    v_mul_f32 v86, v86, v211
    v_mul_f32 v87, v87, v211
    v_mul_f32 v88, v88, v211
    v_mul_f32 v89, v89, v211
    v_mul_f32 v90, v90, v211
    v_mul_f32 v91, v91, v211
    v_mul_f32 v92, v92, v211
    v_mul_f32 v93, v93, v211
    v_mul_f32 v94, v94, v211
    v_mul_f32 v95, v95, v211
    v_mul_f32 v96, v96, v211
    v_mul_f32 v97, v97, v211
    v_mul_f32 v98, v98, v211
    v_mul_f32 v99, v99, v211
A_snrs6:
    v_mul_f32 v212, s48, v208
    v_fma_f32 v100, v100, s48, -v212
    v_exp_f32 v100, v100
    s_nop 0
    v_add_f32 v209, v209, v100
    v_fma_f32 v101, v101, s48, -v212
    v_exp_f32 v101, v101
    s_nop 0
    v_add_f32 v209, v209, v101
    v_cvt_pk_bf16_f32 v100, v100, v101
    v_fma_f32 v102, v102, s48, -v212
    v_exp_f32 v102, v102
    s_nop 0
    v_add_f32 v209, v209, v102
    v_fma_f32 v103, v103, s48, -v212
    v_exp_f32 v103, v103
    s_nop 0
    v_add_f32 v209, v209, v103
    v_cvt_pk_bf16_f32 v101, v102, v103
    v_fma_f32 v104, v104, s48, -v212
    v_exp_f32 v104, v104
    s_nop 0
    v_add_f32 v209, v209, v104
    v_fma_f32 v105, v105, s48, -v212
    v_exp_f32 v105, v105
    s_nop 0
    v_add_f32 v209, v209, v105
    v_cvt_pk_bf16_f32 v102, v104, v105
    v_fma_f32 v106, v106, s48, -v212
    v_exp_f32 v106, v106
    s_nop 0
    v_add_f32 v209, v209, v106
    v_fma_f32 v107, v107, s48, -v212
    v_exp_f32 v107, v107
    s_nop 0
    v_add_f32 v209, v209, v107
    v_cvt_pk_bf16_f32 v103, v106, v107
    v_fma_f32 v108, v108, s48, -v212
    v_exp_f32 v108, v108
    s_nop 0
    v_add_f32 v209, v209, v108
    v_fma_f32 v109, v109, s48, -v212
    v_exp_f32 v109, v109
    s_nop 0
    v_add_f32 v209, v209, v109
    v_cvt_pk_bf16_f32 v104, v108, v109
    v_fma_f32 v110, v110, s48, -v212
    v_exp_f32 v110, v110
    s_nop 0
    v_add_f32 v209, v209, v110
    v_fma_f32 v111, v111, s48, -v212
    v_exp_f32 v111, v111
    s_nop 0
    v_add_f32 v209, v209, v111
    v_cvt_pk_bf16_f32 v105, v110, v111
    v_fma_f32 v112, v112, s48, -v212
    v_exp_f32 v112, v112
    s_nop 0
    v_add_f32 v209, v209, v112
    v_fma_f32 v113, v113, s48, -v212
    v_exp_f32 v113, v113
    s_nop 0
    v_add_f32 v209, v209, v113
    v_cvt_pk_bf16_f32 v106, v112, v113
    v_fma_f32 v114, v114, s48, -v212
    v_exp_f32 v114, v114
    s_nop 0
    v_add_f32 v209, v209, v114
    v_fma_f32 v115, v115, s48, -v212
    v_exp_f32 v115, v115
    s_nop 0
    v_add_f32 v209, v209, v115
    v_cvt_pk_bf16_f32 v107, v114, v115
    ds_read_b64_tr_b16 v[180:181], v204 offset:0
    ds_read_b64_tr_b16 v[182:183], v204 offset:2048
    s_waitcnt lgkmcnt(0)
    v_mfma_f32_32x32x16_bf16 v[36:51], v[180:183], v[100:103], v[36:51]
    ds_read_b64_tr_b16 v[184:185], v205 offset:0
    ds_read_b64_tr_b16 v[186:187], v205 offset:2048
    s_waitcnt lgkmcnt(0)
    v_mfma_f32_32x32x16_bf16 v[52:67], v[184:187], v[100:103], v[52:67]
    ds_read_b64_tr_b16 v[188:189], v206 offset:0
    ds_read_b64_tr_b16 v[190:191], v206 offset:2048
    s_waitcnt lgkmcnt(0)
    v_mfma_f32_32x32x16_bf16 v[68:83], v[188:191], v[100:103], v[68:83]
    ds_read_b64_tr_b16 v[192:193], v207 offset:0
    ds_read_b64_tr_b16 v[194:195], v207 offset:2048
    s_waitcnt lgkmcnt(0)
    v_mfma_f32_32x32x16_bf16 v[84:99], v[192:195], v[100:103], v[84:99]
    ds_read_b64_tr_b16 v[180:181], v204 offset:4096
    ds_read_b64_tr_b16 v[182:183], v204 offset:6144
    s_waitcnt lgkmcnt(0)
    v_mfma_f32_32x32x16_bf16 v[36:51], v[180:183], v[104:107], v[36:51]
    ds_read_b64_tr_b16 v[184:185], v205 offset:4096
    ds_read_b64_tr_b16 v[186:187], v205 offset:6144
    s_waitcnt lgkmcnt(0)
    v_mfma_f32_32x32x16_bf16 v[52:67], v[184:187], v[104:107], v[52:67]
    ds_read_b64_tr_b16 v[188:189], v206 offset:4096
    ds_read_b64_tr_b16 v[190:191], v206 offset:6144
    s_waitcnt lgkmcnt(0)
    v_mfma_f32_32x32x16_bf16 v[68:83], v[188:191], v[104:107], v[68:83]
    ds_read_b64_tr_b16 v[192:193], v207 offset:4096
    ds_read_b64_tr_b16 v[194:195], v207 offset:6144
    s_waitcnt lgkmcnt(0)
    v_mfma_f32_32x32x16_bf16 v[84:99], v[192:195], v[104:107], v[84:99]
    s_waitcnt lgkmcnt(0)
A_sskips6:
    s_waitcnt vmcnt(8)
    s_barrier
    s_add_u32 s52, s52, 16384
    s_lshl_b32 s4, s56, 10
    s_add_u32 s5, s4, 32768
    s_mov_b32 m0, s5
    s_add_u32 s5, s4, s52
    s_add_u32 s5, s5, 0
    buffer_load_dwordx4 v221, s[12:15], s5 offen lds
    s_add_u32 s6, s4, 98304
    s_mov_b32 m0, s6
    s_nop 0
    buffer_load_dwordx4 v222, s[16:19], s5 offen lds
    s_lshl_b32 s4, s56, 10
    s_add_u32 s5, s4, 36864
    s_mov_b32 m0, s5
    s_add_u32 s5, s4, s52
    s_add_u32 s5, s5, 4096
    buffer_load_dwordx4 v221, s[12:15], s5 offen lds
    s_add_u32 s6, s4, 102400
    s_mov_b32 m0, s6
    s_nop 0
    buffer_load_dwordx4 v222, s[16:19], s5 offen lds
    s_lshl_b32 s4, s56, 10
    s_add_u32 s5, s4, 40960
    s_mov_b32 m0, s5
    s_add_u32 s5, s4, s52
    s_add_u32 s5, s5, 8192
    buffer_load_dwordx4 v221, s[12:15], s5 offen lds
    s_add_u32 s6, s4, 106496
    s_mov_b32 m0, s6
    s_nop 0
    buffer_load_dwordx4 v222, s[16:19], s5 offen lds
    s_lshl_b32 s4, s56, 10
    s_add_u32 s5, s4, 45056
    s_mov_b32 m0, s5
    s_add_u32 s5, s4, s52
    s_add_u32 s5, s5, 12288
    buffer_load_dwordx4 v221, s[12:15], s5 offen lds
    s_add_u32 s6, s4, 110592
    s_mov_b32 m0, s6
    s_nop 0
    buffer_load_dwordx4 v222, s[16:19], s5 offen lds
    s_cmp_lg_u32 s57, 1
    s_cbranch_scc1 A_sskips7
    ds_read_b128 v[164:167], v196 offset:16384
    s_waitcnt lgkmcnt(0)
    v_mfma_f32_32x32x16_bf16 v[100:115], v[164:167], v[4:7], 0
    ds_read_b128 v[168:171], v197 offset:16384
    s_waitcnt lgkmcnt(0)
    v_mfma_f32_32x32x16_bf16 v[100:115], v[168:171], v[8:11], v[100:115]
    ds_read_b128 v[172:175], v198 offset:16384
    s_waitcnt lgkmcnt(0)
    v_mfma_f32_32x32x16_bf16 v[100:115], v[172:175], v[12:15], v[100:115]
    ds_read_b128 v[176:179], v199 offset:16384
    s_waitcnt lgkmcnt(0)
    v_mfma_f32_32x32x16_bf16 v[100:115], v[176:179], v[16:19], v[100:115]
    ds_read_b128 v[164:167], v200 offset:16384
    s_waitcnt lgkmcnt(0)
    v_mfma_f32_32x32x16_bf16 v[100:115], v[164:167], v[20:23], v[100:115]
    ds_read_b128 v[168:171], v201 offset:16384
    s_waitcnt lgkmcnt(0)
    v_mfma_f32_32x32x16_bf16 v[100:115], v[168:171], v[24:27], v[100:115]
    ds_read_b128 v[172:175], v202 offset:16384
    s_waitcnt lgkmcnt(0)
    v_mfma_f32_32x32x16_bf16 v[100:115], v[172:175], v[28:31], v[100:115]
    ds_read_b128 v[176:179], v203 offset:16384
    s_waitcnt lgkmcnt(0)
    v_mfma_f32_32x32x16_bf16 v[100:115], v[176:179], v[32:35], v[100:115]
    s_nop 11
    v_max3_f32 v213, v100, v101, v102
    v_max3_f32 v214, v103, v104, v105
    v_max3_f32 v215, v106, v107, v108
    v_max3_f32 v216, v109, v110, v111
    v_max3_f32 v217, v112, v113, v114
    v_max3_f32 v213, v213, v214, v115
    v_max3_f32 v215, v215, v216, v217
    v_max_f32 v213, v213, v215
    v_mov_b32 v214, v213
    s_nop 1
    v_permlane32_swap_b32 v213, v214
    v_max3_f32 v213, v213, v214, v208
    v_sub_f32 v214, v213, v208
    v_cmp_lt_f32 vcc, s49, v214
    s_nop 1
    s_cbranch_vccz A_snrs7
    v_mul_f32 v214, s55, v214
    v_exp_f32 v211, v214
    s_nop 0
    v_mul_f32 v209, v209, v211
    v_mov_b32 v208, v213
    v_mul_f32 v36, v36, v211
    v_mul_f32 v37, v37, v211
    v_mul_f32 v38, v38, v211
    v_mul_f32 v39, v39, v211
    v_mul_f32 v40, v40, v211
    v_mul_f32 v41, v41, v211
    v_mul_f32 v42, v42, v211
    v_mul_f32 v43, v43, v211
    v_mul_f32 v44, v44, v211
    v_mul_f32 v45, v45, v211
    v_mul_f32 v46, v46, v211
    v_mul_f32 v47, v47, v211
    v_mul_f32 v48, v48, v211
    v_mul_f32 v49, v49, v211
    v_mul_f32 v50, v50, v211
    v_mul_f32 v51, v51, v211
    v_mul_f32 v52, v52, v211
    v_mul_f32 v53, v53, v211
    v_mul_f32 v54, v54, v211
    v_mul_f32 v55, v55, v211
    v_mul_f32 v56, v56, v211
    v_mul_f32 v57, v57, v211
    v_mul_f32 v58, v58, v211
    v_mul_f32 v59, v59, v211
    v_mul_f32 v60, v60, v211
    v_mul_f32 v61, v61, v211
    v_mul_f32 v62, v62, v211
    v_mul_f32 v63, v63, v211
    v_mul_f32 v64, v64, v211
    v_mul_f32 v65, v65, v211
    v_mul_f32 v66, v66, v211
    v_mul_f32 v67, v67, v211
    v_mul_f32 v68, v68, v211
    v_mul_f32 v69, v69, v211
    v_mul_f32 v70, v70, v211
    v_mul_f32 v71, v71, v211
    v_mul_f32 v72, v72, v211
    v_mul_f32 v73, v73, v211
    v_mul_f32 v74, v74, v211
    v_mul_f32 v75, v75, v211
    v_mul_f32 v76, v76, v211
    v_mul_f32 v77, v77, v211
    v_mul_f32 v78, v78, v211
    v_mul_f32 v79, v79, v211
    v_mul_f32 v80, v80, v211
    v_mul_f32 v81, v81, v211
    v_mul_f32 v82, v82, v211
    v_mul_f32 v83, v83, v211
    v_mul_f32 v84, v84, v211
    v_mul_f32 v85, v85, v211
    v_mul_f32 v86, v86, v211
    v_mul_f32 v87, v87, v211
    v_mul_f32 v88, v88, v211
    v_mul_f32 v89, v89, v211
    v_mul_f32 v90, v90, v211
    v_mul_f32 v91, v91, v211
    v_mul_f32 v92, v92, v211
    v_mul_f32 v93, v93, v211
    v_mul_f32 v94, v94, v211
    v_mul_f32 v95, v95, v211
    v_mul_f32 v96, v96, v211
    v_mul_f32 v97, v97, v211
    v_mul_f32 v98, v98, v211
    v_mul_f32 v99, v99, v211
A_snrs7:
    v_mul_f32 v212, s48, v208
    v_fma_f32 v100, v100, s48, -v212
    v_exp_f32 v100, v100
    s_nop 0
    v_add_f32 v209, v209, v100
    v_fma_f32 v101, v101, s48, -v212
    v_exp_f32 v101, v101
    s_nop 0
    v_add_f32 v209, v209, v101
    v_cvt_pk_bf16_f32 v100, v100, v101
    v_fma_f32 v102, v102, s48, -v212
    v_exp_f32 v102, v102
    s_nop 0
    v_add_f32 v209, v209, v102
    v_fma_f32 v103, v103, s48, -v212
    v_exp_f32 v103, v103
    s_nop 0
    v_add_f32 v209, v209, v103
    v_cvt_pk_bf16_f32 v101, v102, v103
    v_fma_f32 v104, v104, s48, -v212
    v_exp_f32 v104, v104
    s_nop 0
    v_add_f32 v209, v209, v104
    v_fma_f32 v105, v105, s48, -v212
    v_exp_f32 v105, v105
    s_nop 0
    v_add_f32 v209, v209, v105
    v_cvt_pk_bf16_f32 v102, v104, v105
    v_fma_f32 v106, v106, s48, -v212
    v_exp_f32 v106, v106
    s_nop 0
    v_add_f32 v209, v209, v106
    v_fma_f32 v107, v107, s48, -v212
    v_exp_f32 v107, v107
    s_nop 0
    v_add_f32 v209, v209, v107
    v_cvt_pk_bf16_f32 v103, v106, v107
    v_fma_f32 v108, v108, s48, -v212
    v_exp_f32 v108, v108
    s_nop 0
    v_add_f32 v209, v209, v108
    v_fma_f32 v109, v109, s48, -v212
    v_exp_f32 v109, v109
    s_nop 0
    v_add_f32 v209, v209, v109
    v_cvt_pk_bf16_f32 v104, v108, v109
    v_fma_f32 v110, v110, s48, -v212
    v_exp_f32 v110, v110
    s_nop 0
    v_add_f32 v209, v209, v110
    v_fma_f32 v111, v111, s48, -v212
    v_exp_f32 v111, v111
    s_nop 0
    v_add_f32 v209, v209, v111
    v_cvt_pk_bf16_f32 v105, v110, v111
    v_fma_f32 v112, v112, s48, -v212
    v_exp_f32 v112, v112
    s_nop 0
    v_add_f32 v209, v209, v112
    v_fma_f32 v113, v113, s48, -v212
    v_exp_f32 v113, v113
    s_nop 0
    v_add_f32 v209, v209, v113
    v_cvt_pk_bf16_f32 v106, v112, v113
    v_fma_f32 v114, v114, s48, -v212
    v_exp_f32 v114, v114
    s_nop 0
    v_add_f32 v209, v209, v114
    v_fma_f32 v115, v115, s48, -v212
    v_exp_f32 v115, v115
    s_nop 0
    v_add_f32 v209, v209, v115
    v_cvt_pk_bf16_f32 v107, v114, v115
    ds_read_b64_tr_b16 v[180:181], v204 offset:16384
    ds_read_b64_tr_b16 v[182:183], v204 offset:18432
    s_waitcnt lgkmcnt(0)
    v_mfma_f32_32x32x16_bf16 v[36:51], v[180:183], v[100:103], v[36:51]
    ds_read_b64_tr_b16 v[184:185], v205 offset:16384
    ds_read_b64_tr_b16 v[186:187], v205 offset:18432
    s_waitcnt lgkmcnt(0)
    v_mfma_f32_32x32x16_bf16 v[52:67], v[184:187], v[100:103], v[52:67]
    ds_read_b64_tr_b16 v[188:189], v206 offset:16384
    ds_read_b64_tr_b16 v[190:191], v206 offset:18432
    s_waitcnt lgkmcnt(0)
    v_mfma_f32_32x32x16_bf16 v[68:83], v[188:191], v[100:103], v[68:83]
    ds_read_b64_tr_b16 v[192:193], v207 offset:16384
    ds_read_b64_tr_b16 v[194:195], v207 offset:18432
    s_waitcnt lgkmcnt(0)
    v_mfma_f32_32x32x16_bf16 v[84:99], v[192:195], v[100:103], v[84:99]
    ds_read_b64_tr_b16 v[180:181], v204 offset:20480
    ds_read_b64_tr_b16 v[182:183], v204 offset:22528
    s_waitcnt lgkmcnt(0)
    v_mfma_f32_32x32x16_bf16 v[36:51], v[180:183], v[104:107], v[36:51]
    ds_read_b64_tr_b16 v[184:185], v205 offset:20480
    ds_read_b64_tr_b16 v[186:187], v205 offset:22528
    s_waitcnt lgkmcnt(0)
    v_mfma_f32_32x32x16_bf16 v[52:67], v[184:187], v[104:107], v[52:67]
    ds_read_b64_tr_b16 v[188:189], v206 offset:20480
    ds_read_b64_tr_b16 v[190:191], v206 offset:22528
    s_waitcnt lgkmcnt(0)
    v_mfma_f32_32x32x16_bf16 v[68:83], v[188:191], v[104:107], v[68:83]
    ds_read_b64_tr_b16 v[192:193], v207 offset:20480
    ds_read_b64_tr_b16 v[194:195], v207 offset:22528
    s_waitcnt lgkmcnt(0)
    v_mfma_f32_32x32x16_bf16 v[84:99], v[192:195], v[104:107], v[84:99]
    s_waitcnt lgkmcnt(0)
A_sskips7:
    s_waitcnt vmcnt(8)
    s_barrier
    v_xor_b32 v196, 0x8000, v196
    v_xor_b32 v197, 0x8000, v197
    v_xor_b32 v198, 0x8000, v198
    v_xor_b32 v199, 0x8000, v199
    v_xor_b32 v200, 0x8000, v200
    v_xor_b32 v201, 0x8000, v201
    v_xor_b32 v202, 0x8000, v202
    v_xor_b32 v203, 0x8000, v203
    v_xor_b32 v204, 0x8000, v204
    v_xor_b32 v205, 0x8000, v205
    v_xor_b32 v206, 0x8000, v206
    v_xor_b32 v207, 0x8000, v207
    s_add_u32 s52, s52, 16384
    s_lshl_b32 s4, s56, 10
    s_add_u32 s5, s4, 49152
    s_mov_b32 m0, s5
    s_add_u32 s5, s4, s52
    s_add_u32 s5, s5, 0
    buffer_load_dwordx4 v221, s[12:15], s5 offen lds
    s_add_u32 s6, s4, 114688
    s_mov_b32 m0, s6
    s_nop 0
    buffer_load_dwordx4 v222, s[16:19], s5 offen lds
    s_lshl_b32 s4, s56, 10
    s_add_u32 s5, s4, 53248
    s_mov_b32 m0, s5
    s_add_u32 s5, s4, s52
    s_add_u32 s5, s5, 4096
    buffer_load_dwordx4 v221, s[12:15], s5 offen lds
    s_add_u32 s6, s4, 118784
    s_mov_b32 m0, s6
    s_nop 0
    buffer_load_dwordx4 v222, s[16:19], s5 offen lds
    s_lshl_b32 s4, s56, 10
    s_add_u32 s5, s4, 57344
    s_mov_b32 m0, s5
    s_add_u32 s5, s4, s52
    s_add_u32 s5, s5, 8192
    buffer_load_dwordx4 v221, s[12:15], s5 offen lds
    s_add_u32 s6, s4, 122880
    s_mov_b32 m0, s6
    s_nop 0
    buffer_load_dwordx4 v222, s[16:19], s5 offen lds
    s_lshl_b32 s4, s56, 10
    s_add_u32 s5, s4, 61440
    s_mov_b32 m0, s5
    s_add_u32 s5, s4, s52
    s_add_u32 s5, s5, 12288
    buffer_load_dwordx4 v221, s[12:15], s5 offen lds
    s_add_u32 s6, s4, 126976
    s_mov_b32 m0, s6
    s_nop 0
    buffer_load_dwordx4 v222, s[16:19], s5 offen lds
    s_cmp_lg_u32 s57, 0
    s_cbranch_scc1 A_sskips8
    ds_read_b128 v[164:167], v196 offset:0
    s_waitcnt lgkmcnt(0)
    v_mfma_f32_32x32x16_bf16 v[100:115], v[164:167], v[4:7], 0
    ds_read_b128 v[168:171], v197 offset:0
    s_waitcnt lgkmcnt(0)
    v_mfma_f32_32x32x16_bf16 v[100:115], v[168:171], v[8:11], v[100:115]
    ds_read_b128 v[172:175], v198 offset:0
    s_waitcnt lgkmcnt(0)
    v_mfma_f32_32x32x16_bf16 v[100:115], v[172:175], v[12:15], v[100:115]
    ds_read_b128 v[176:179], v199 offset:0
    s_waitcnt lgkmcnt(0)
    v_mfma_f32_32x32x16_bf16 v[100:115], v[176:179], v[16:19], v[100:115]
    ds_read_b128 v[164:167], v200 offset:0
    s_waitcnt lgkmcnt(0)
    v_mfma_f32_32x32x16_bf16 v[100:115], v[164:167], v[20:23], v[100:115]
    ds_read_b128 v[168:171], v201 offset:0
    s_waitcnt lgkmcnt(0)
    v_mfma_f32_32x32x16_bf16 v[100:115], v[168:171], v[24:27], v[100:115]
    ds_read_b128 v[172:175], v202 offset:0
    s_waitcnt lgkmcnt(0)
    v_mfma_f32_32x32x16_bf16 v[100:115], v[172:175], v[28:31], v[100:115]
    ds_read_b128 v[176:179], v203 offset:0
    s_waitcnt lgkmcnt(0)
    v_mfma_f32_32x32x16_bf16 v[100:115], v[176:179], v[32:35], v[100:115]
    s_nop 11
    v_max3_f32 v213, v100, v101, v102
    v_max3_f32 v214, v103, v104, v105
    v_max3_f32 v215, v106, v107, v108
    v_max3_f32 v216, v109, v110, v111
    v_max3_f32 v217, v112, v113, v114
    v_max3_f32 v213, v213, v214, v115
    v_max3_f32 v215, v215, v216, v217
    v_max_f32 v213, v213, v215
    v_mov_b32 v214, v213
    s_nop 1
    v_permlane32_swap_b32 v213, v214
    v_max3_f32 v213, v213, v214, v208
    v_sub_f32 v214, v213, v208
    v_cmp_lt_f32 vcc, s49, v214
    s_nop 1
    s_cbranch_vccz A_snrs8
    v_mul_f32 v214, s55, v214
    v_exp_f32 v211, v214
    s_nop 0
    v_mul_f32 v209, v209, v211
    v_mov_b32 v208, v213
    v_mul_f32 v36, v36, v211
    v_mul_f32 v37, v37, v211
    v_mul_f32 v38, v38, v211
    v_mul_f32 v39, v39, v211
    v_mul_f32 v40, v40, v211
    v_mul_f32 v41, v41, v211
    v_mul_f32 v42, v42, v211
    v_mul_f32 v43, v43, v211
    v_mul_f32 v44, v44, v211
    v_mul_f32 v45, v45, v211
    v_mul_f32 v46, v46, v211
    v_mul_f32 v47, v47, v211
    v_mul_f32 v48, v48, v211
    v_mul_f32 v49, v49, v211
    v_mul_f32 v50, v50, v211
    v_mul_f32 v51, v51, v211
    v_mul_f32 v52, v52, v211
    v_mul_f32 v53, v53, v211
    v_mul_f32 v54, v54, v211
    v_mul_f32 v55, v55, v211
    v_mul_f32 v56, v56, v211
    v_mul_f32 v57, v57, v211
    v_mul_f32 v58, v58, v211
    v_mul_f32 v59, v59, v211
    v_mul_f32 v60, v60, v211
    v_mul_f32 v61, v61, v211
    v_mul_f32 v62, v62, v211
    v_mul_f32 v63, v63, v211
    v_mul_f32 v64, v64, v211
    v_mul_f32 v65, v65, v211
    v_mul_f32 v66, v66, v211
    v_mul_f32 v67, v67, v211
    v_mul_f32 v68, v68, v211
    v_mul_f32 v69, v69, v211
    v_mul_f32 v70, v70, v211
    v_mul_f32 v71, v71, v211
    v_mul_f32 v72, v72, v211
    v_mul_f32 v73, v73, v211
    v_mul_f32 v74, v74, v211
    v_mul_f32 v75, v75, v211
    v_mul_f32 v76, v76, v211
    v_mul_f32 v77, v77, v211
    v_mul_f32 v78, v78, v211
    v_mul_f32 v79, v79, v211
    v_mul_f32 v80, v80, v211
    v_mul_f32 v81, v81, v211
    v_mul_f32 v82, v82, v211
    v_mul_f32 v83, v83, v211
    v_mul_f32 v84, v84, v211
    v_mul_f32 v85, v85, v211
    v_mul_f32 v86, v86, v211
    v_mul_f32 v87, v87, v211
    v_mul_f32 v88, v88, v211
    v_mul_f32 v89, v89, v211
    v_mul_f32 v90, v90, v211
    v_mul_f32 v91, v91, v211
    v_mul_f32 v92, v92, v211
    v_mul_f32 v93, v93, v211
    v_mul_f32 v94, v94, v211
    v_mul_f32 v95, v95, v211
    v_mul_f32 v96, v96, v211
    v_mul_f32 v97, v97, v211
    v_mul_f32 v98, v98, v211
    v_mul_f32 v99, v99, v211
A_snrs8:
    v_mul_f32 v212, s48, v208
    v_fma_f32 v100, v100, s48, -v212
    v_exp_f32 v100, v100
    s_nop 0
    v_add_f32 v209, v209, v100
    v_fma_f32 v101, v101, s48, -v212
    v_exp_f32 v101, v101
    s_nop 0
    v_add_f32 v209, v209, v101
    v_cvt_pk_bf16_f32 v100, v100, v101
    v_fma_f32 v102, v102, s48, -v212
    v_exp_f32 v102, v102
    s_nop 0
    v_add_f32 v209, v209, v102
    v_fma_f32 v103, v103, s48, -v212
    v_exp_f32 v103, v103
    s_nop 0
    v_add_f32 v209, v209, v103
    v_cvt_pk_bf16_f32 v101, v102, v103
    v_fma_f32 v104, v104, s48, -v212
    v_exp_f32 v104, v104
    s_nop 0
    v_add_f32 v209, v209, v104
    v_fma_f32 v105, v105, s48, -v212
    v_exp_f32 v105, v105
    s_nop 0
    v_add_f32 v209, v209, v105
    v_cvt_pk_bf16_f32 v102, v104, v105
    v_fma_f32 v106, v106, s48, -v212
    v_exp_f32 v106, v106
    s_nop 0
    v_add_f32 v209, v209, v106
    v_fma_f32 v107, v107, s48, -v212
    v_exp_f32 v107, v107
    s_nop 0
    v_add_f32 v209, v209, v107
    v_cvt_pk_bf16_f32 v103, v106, v107
    v_fma_f32 v108, v108, s48, -v212
    v_exp_f32 v108, v108
    s_nop 0
    v_add_f32 v209, v209, v108
    v_fma_f32 v109, v109, s48, -v212
    v_exp_f32 v109, v109
    s_nop 0
    v_add_f32 v209, v209, v109
    v_cvt_pk_bf16_f32 v104, v108, v109
    v_fma_f32 v110, v110, s48, -v212
    v_exp_f32 v110, v110
    s_nop 0
    v_add_f32 v209, v209, v110
    v_fma_f32 v111, v111, s48, -v212
    v_exp_f32 v111, v111
    s_nop 0
    v_add_f32 v209, v209, v111
    v_cvt_pk_bf16_f32 v105, v110, v111
    v_fma_f32 v112, v112, s48, -v212
    v_exp_f32 v112, v112
    s_nop 0
    v_add_f32 v209, v209, v112
    v_fma_f32 v113, v113, s48, -v212
    v_exp_f32 v113, v113
    s_nop 0
    v_add_f32 v209, v209, v113
    v_cvt_pk_bf16_f32 v106, v112, v113
    v_fma_f32 v114, v114, s48, -v212
    v_exp_f32 v114, v114
    s_nop 0
    v_add_f32 v209, v209, v114
    v_fma_f32 v115, v115, s48, -v212
    v_exp_f32 v115, v115
    s_nop 0
    v_add_f32 v209, v209, v115
    v_cvt_pk_bf16_f32 v107, v114, v115
    ds_read_b64_tr_b16 v[180:181], v204 offset:0
    ds_read_b64_tr_b16 v[182:183], v204 offset:2048
    s_waitcnt lgkmcnt(0)
    v_mfma_f32_32x32x16_bf16 v[36:51], v[180:183], v[100:103], v[36:51]
    ds_read_b64_tr_b16 v[184:185], v205 offset:0
    ds_read_b64_tr_b16 v[186:187], v205 offset:2048
    s_waitcnt lgkmcnt(0)
    v_mfma_f32_32x32x16_bf16 v[52:67], v[184:187], v[100:103], v[52:67]
    ds_read_b64_tr_b16 v[188:189], v206 offset:0
    ds_read_b64_tr_b16 v[190:191], v206 offset:2048
    s_waitcnt lgkmcnt(0)
    v_mfma_f32_32x32x16_bf16 v[68:83], v[188:191], v[100:103], v[68:83]
    ds_read_b64_tr_b16 v[192:193], v207 offset:0
    ds_read_b64_tr_b16 v[194:195], v207 offset:2048
    s_waitcnt lgkmcnt(0)
    v_mfma_f32_32x32x16_bf16 v[84:99], v[192:195], v[100:103], v[84:99]
    ds_read_b64_tr_b16 v[180:181], v204 offset:4096
    ds_read_b64_tr_b16 v[182:183], v204 offset:6144
    s_waitcnt lgkmcnt(0)
    v_mfma_f32_32x32x16_bf16 v[36:51], v[180:183], v[104:107], v[36:51]
    ds_read_b64_tr_b16 v[184:185], v205 offset:4096
    ds_read_b64_tr_b16 v[186:187], v205 offset:6144
    s_waitcnt lgkmcnt(0)
    v_mfma_f32_32x32x16_bf16 v[52:67], v[184:187], v[104:107], v[52:67]
    ds_read_b64_tr_b16 v[188:189], v206 offset:4096
    ds_read_b64_tr_b16 v[190:191], v206 offset:6144
    s_waitcnt lgkmcnt(0)
    v_mfma_f32_32x32x16_bf16 v[68:83], v[188:191], v[104:107], v[68:83]
    ds_read_b64_tr_b16 v[192:193], v207 offset:4096
    ds_read_b64_tr_b16 v[194:195], v207 offset:6144
    s_waitcnt lgkmcnt(0)
    v_mfma_f32_32x32x16_bf16 v[84:99], v[192:195], v[104:107], v[84:99]
    s_waitcnt lgkmcnt(0)
A_sskips8:
    s_waitcnt vmcnt(8)
    s_barrier
    s_add_u32 s52, s52, 16384
    s_lshl_b32 s4, s56, 10
    s_add_u32 s5, s4, 0
    s_mov_b32 m0, s5
    s_add_u32 s5, s4, s52
    s_add_u32 s5, s5, 0
    buffer_load_dwordx4 v221, s[12:15], s5 offen lds
    s_add_u32 s6, s4, 65536
    s_mov_b32 m0, s6
    s_nop 0
    buffer_load_dwordx4 v222, s[16:19], s5 offen lds
    s_lshl_b32 s4, s56, 10
    s_add_u32 s5, s4, 4096
    s_mov_b32 m0, s5
    s_add_u32 s5, s4, s52
    s_add_u32 s5, s5, 4096
    buffer_load_dwordx4 v221, s[12:15], s5 offen lds
    s_add_u32 s6, s4, 69632
    s_mov_b32 m0, s6
    s_nop 0
    buffer_load_dwordx4 v222, s[16:19], s5 offen lds
    s_lshl_b32 s4, s56, 10
    s_add_u32 s5, s4, 8192
    s_mov_b32 m0, s5
    s_add_u32 s5, s4, s52
    s_add_u32 s5, s5, 8192
    buffer_load_dwordx4 v221, s[12:15], s5 offen lds
    s_add_u32 s6, s4, 73728
    s_mov_b32 m0, s6
    s_nop 0
    buffer_load_dwordx4 v222, s[16:19], s5 offen lds
    s_lshl_b32 s4, s56, 10
    s_add_u32 s5, s4, 12288
    s_mov_b32 m0, s5
    s_add_u32 s5, s4, s52
    s_add_u32 s5, s5, 12288
    buffer_load_dwordx4 v221, s[12:15], s5 offen lds
    s_add_u32 s6, s4, 77824
    s_mov_b32 m0, s6
    s_nop 0
    buffer_load_dwordx4 v222, s[16:19], s5 offen lds
    s_cmp_lg_u32 s57, 1
    s_cbranch_scc1 A_sskips9
    ds_read_b128 v[164:167], v196 offset:16384
    s_waitcnt lgkmcnt(0)
    v_mfma_f32_32x32x16_bf16 v[100:115], v[164:167], v[4:7], 0
    ds_read_b128 v[168:171], v197 offset:16384
    s_waitcnt lgkmcnt(0)
    v_mfma_f32_32x32x16_bf16 v[100:115], v[168:171], v[8:11], v[100:115]
    ds_read_b128 v[172:175], v198 offset:16384
    s_waitcnt lgkmcnt(0)
    v_mfma_f32_32x32x16_bf16 v[100:115], v[172:175], v[12:15], v[100:115]
    ds_read_b128 v[176:179], v199 offset:16384
    s_waitcnt lgkmcnt(0)
    v_mfma_f32_32x32x16_bf16 v[100:115], v[176:179], v[16:19], v[100:115]
    ds_read_b128 v[164:167], v200 offset:16384
    s_waitcnt lgkmcnt(0)
    v_mfma_f32_32x32x16_bf16 v[100:115], v[164:167], v[20:23], v[100:115]
    ds_read_b128 v[168:171], v201 offset:16384
    s_waitcnt lgkmcnt(0)
    v_mfma_f32_32x32x16_bf16 v[100:115], v[168:171], v[24:27], v[100:115]
    ds_read_b128 v[172:175], v202 offset:16384
    s_waitcnt lgkmcnt(0)
    v_mfma_f32_32x32x16_bf16 v[100:115], v[172:175], v[28:31], v[100:115]
    ds_read_b128 v[176:179], v203 offset:16384
    s_waitcnt lgkmcnt(0)
    v_mfma_f32_32x32x16_bf16 v[100:115], v[176:179], v[32:35], v[100:115]
    s_nop 11
    v_max3_f32 v213, v100, v101, v102
    v_max3_f32 v214, v103, v104, v105
    v_max3_f32 v215, v106, v107, v108
    v_max3_f32 v216, v109, v110, v111
    v_max3_f32 v217, v112, v113, v114
    v_max3_f32 v213, v213, v214, v115
    v_max3_f32 v215, v215, v216, v217
    v_max_f32 v213, v213, v215
    v_mov_b32 v214, v213
    s_nop 1
    v_permlane32_swap_b32 v213, v214
    v_max3_f32 v213, v213, v214, v208
    v_sub_f32 v214, v213, v208
    v_cmp_lt_f32 vcc, s49, v214
    s_nop 1
    s_cbranch_vccz A_snrs9
    v_mul_f32 v214, s55, v214
    v_exp_f32 v211, v214
    s_nop 0
    v_mul_f32 v209, v209, v211
    v_mov_b32 v208, v213
    v_mul_f32 v36, v36, v211
    v_mul_f32 v37, v37, v211
    v_mul_f32 v38, v38, v211
    v_mul_f32 v39, v39, v211
    v_mul_f32 v40, v40, v211
    v_mul_f32 v41, v41, v211
    v_mul_f32 v42, v42, v211
    v_mul_f32 v43, v43, v211
    v_mul_f32 v44, v44, v211
    v_mul_f32 v45, v45, v211
    v_mul_f32 v46, v46, v211
    v_mul_f32 v47, v47, v211
    v_mul_f32 v48, v48, v211
    v_mul_f32 v49, v49, v211
    v_mul_f32 v50, v50, v211
    v_mul_f32 v51, v51, v211
    v_mul_f32 v52, v52, v211
    v_mul_f32 v53, v53, v211
    v_mul_f32 v54, v54, v211
    v_mul_f32 v55, v55, v211
    v_mul_f32 v56, v56, v211
    v_mul_f32 v57, v57, v211
    v_mul_f32 v58, v58, v211
    v_mul_f32 v59, v59, v211
    v_mul_f32 v60, v60, v211
    v_mul_f32 v61, v61, v211
    v_mul_f32 v62, v62, v211
    v_mul_f32 v63, v63, v211
    v_mul_f32 v64, v64, v211
    v_mul_f32 v65, v65, v211
    v_mul_f32 v66, v66, v211
    v_mul_f32 v67, v67, v211
    v_mul_f32 v68, v68, v211
    v_mul_f32 v69, v69, v211
    v_mul_f32 v70, v70, v211
    v_mul_f32 v71, v71, v211
    v_mul_f32 v72, v72, v211
    v_mul_f32 v73, v73, v211
    v_mul_f32 v74, v74, v211
    v_mul_f32 v75, v75, v211
    v_mul_f32 v76, v76, v211
    v_mul_f32 v77, v77, v211
    v_mul_f32 v78, v78, v211
    v_mul_f32 v79, v79, v211
    v_mul_f32 v80, v80, v211
    v_mul_f32 v81, v81, v211
    v_mul_f32 v82, v82, v211
    v_mul_f32 v83, v83, v211
    v_mul_f32 v84, v84, v211
    v_mul_f32 v85, v85, v211
    v_mul_f32 v86, v86, v211
    v_mul_f32 v87, v87, v211
    v_mul_f32 v88, v88, v211
    v_mul_f32 v89, v89, v211
    v_mul_f32 v90, v90, v211
    v_mul_f32 v91, v91, v211
    v_mul_f32 v92, v92, v211
    v_mul_f32 v93, v93, v211
    v_mul_f32 v94, v94, v211
    v_mul_f32 v95, v95, v211
    v_mul_f32 v96, v96, v211
    v_mul_f32 v97, v97, v211
    v_mul_f32 v98, v98, v211
    v_mul_f32 v99, v99, v211
A_snrs9:
    v_mul_f32 v212, s48, v208
    v_fma_f32 v100, v100, s48, -v212
    v_exp_f32 v100, v100
    s_nop 0
    v_add_f32 v209, v209, v100
    v_fma_f32 v101, v101, s48, -v212
    v_exp_f32 v101, v101
    s_nop 0
    v_add_f32 v209, v209, v101
    v_cvt_pk_bf16_f32 v100, v100, v101
    v_fma_f32 v102, v102, s48, -v212
    v_exp_f32 v102, v102
    s_nop 0
    v_add_f32 v209, v209, v102
    v_fma_f32 v103, v103, s48, -v212
    v_exp_f32 v103, v103
    s_nop 0
    v_add_f32 v209, v209, v103
    v_cvt_pk_bf16_f32 v101, v102, v103
    v_fma_f32 v104, v104, s48, -v212
    v_exp_f32 v104, v104
    s_nop 0
    v_add_f32 v209, v209, v104
    v_fma_f32 v105, v105, s48, -v212
    v_exp_f32 v105, v105
    s_nop 0
    v_add_f32 v209, v209, v105
    v_cvt_pk_bf16_f32 v102, v104, v105
    v_fma_f32 v106, v106, s48, -v212
    v_exp_f32 v106, v106
    s_nop 0
    v_add_f32 v209, v209, v106
    v_fma_f32 v107, v107, s48, -v212
    v_exp_f32 v107, v107
    s_nop 0
    v_add_f32 v209, v209, v107
    v_cvt_pk_bf16_f32 v103, v106, v107
    v_fma_f32 v108, v108, s48, -v212
    v_exp_f32 v108, v108
    s_nop 0
    v_add_f32 v209, v209, v108
    v_fma_f32 v109, v109, s48, -v212
    v_exp_f32 v109, v109
    s_nop 0
    v_add_f32 v209, v209, v109
    v_cvt_pk_bf16_f32 v104, v108, v109
    v_fma_f32 v110, v110, s48, -v212
    v_exp_f32 v110, v110
    s_nop 0
    v_add_f32 v209, v209, v110
    v_fma_f32 v111, v111, s48, -v212
    v_exp_f32 v111, v111
    s_nop 0
    v_add_f32 v209, v209, v111
    v_cvt_pk_bf16_f32 v105, v110, v111
    v_fma_f32 v112, v112, s48, -v212
    v_exp_f32 v112, v112
    s_nop 0
    v_add_f32 v209, v209, v112
    v_fma_f32 v113, v113, s48, -v212
    v_exp_f32 v113, v113
    s_nop 0
    v_add_f32 v209, v209, v113
    v_cvt_pk_bf16_f32 v106, v112, v113
    v_fma_f32 v114, v114, s48, -v212
    v_exp_f32 v114, v114
    s_nop 0
    v_add_f32 v209, v209, v114
    v_fma_f32 v115, v115, s48, -v212
    v_exp_f32 v115, v115
    s_nop 0
    v_add_f32 v209, v209, v115
    v_cvt_pk_bf16_f32 v107, v114, v115
    ds_read_b64_tr_b16 v[180:181], v204 offset:16384
    ds_read_b64_tr_b16 v[182:183], v204 offset:18432
    s_waitcnt lgkmcnt(0)
    v_mfma_f32_32x32x16_bf16 v[36:51], v[180:183], v[100:103], v[36:51]
    ds_read_b64_tr_b16 v[184:185], v205 offset:16384
    ds_read_b64_tr_b16 v[186:187], v205 offset:18432
    s_waitcnt lgkmcnt(0)
    v_mfma_f32_32x32x16_bf16 v[52:67], v[184:187], v[100:103], v[52:67]
    ds_read_b64_tr_b16 v[188:189], v206 offset:16384
    ds_read_b64_tr_b16 v[190:191], v206 offset:18432
    s_waitcnt lgkmcnt(0)
    v_mfma_f32_32x32x16_bf16 v[68:83], v[188:191], v[100:103], v[68:83]
    ds_read_b64_tr_b16 v[192:193], v207 offset:16384
    ds_read_b64_tr_b16 v[194:195], v207 offset:18432
    s_waitcnt lgkmcnt(0)
    v_mfma_f32_32x32x16_bf16 v[84:99], v[192:195], v[100:103], v[84:99]
    ds_read_b64_tr_b16 v[180:181], v204 offset:20480
    ds_read_b64_tr_b16 v[182:183], v204 offset:22528
    s_waitcnt lgkmcnt(0)
    v_mfma_f32_32x32x16_bf16 v[36:51], v[180:183], v[104:107], v[36:51]
    ds_read_b64_tr_b16 v[184:185], v205 offset:20480
    ds_read_b64_tr_b16 v[186:187], v205 offset:22528
    s_waitcnt lgkmcnt(0)
    v_mfma_f32_32x32x16_bf16 v[52:67], v[184:187], v[104:107], v[52:67]
    ds_read_b64_tr_b16 v[188:189], v206 offset:20480
    ds_read_b64_tr_b16 v[190:191], v206 offset:22528
    s_waitcnt lgkmcnt(0)
    v_mfma_f32_32x32x16_bf16 v[68:83], v[188:191], v[104:107], v[68:83]
    ds_read_b64_tr_b16 v[192:193], v207 offset:20480
    ds_read_b64_tr_b16 v[194:195], v207 offset:22528
    s_waitcnt lgkmcnt(0)
    v_mfma_f32_32x32x16_bf16 v[84:99], v[192:195], v[104:107], v[84:99]
    s_waitcnt lgkmcnt(0)
A_sskips9:
    s_waitcnt vmcnt(8)
    s_barrier
    v_xor_b32 v196, 0x8000, v196
    v_xor_b32 v197, 0x8000, v197
    v_xor_b32 v198, 0x8000, v198
    v_xor_b32 v199, 0x8000, v199
    v_xor_b32 v200, 0x8000, v200
    v_xor_b32 v201, 0x8000, v201
    v_xor_b32 v202, 0x8000, v202
    v_xor_b32 v203, 0x8000, v203
    v_xor_b32 v204, 0x8000, v204
    v_xor_b32 v205, 0x8000, v205
    v_xor_b32 v206, 0x8000, v206
    v_xor_b32 v207, 0x8000, v207
    s_add_u32 s52, s52, 16384
    s_lshl_b32 s4, s56, 10
    s_add_u32 s5, s4, 16384
    s_mov_b32 m0, s5
    s_add_u32 s5, s4, s52
    s_add_u32 s5, s5, 0
    buffer_load_dwordx4 v221, s[12:15], s5 offen lds
    s_add_u32 s6, s4, 81920
    s_mov_b32 m0, s6
    s_nop 0
    buffer_load_dwordx4 v222, s[16:19], s5 offen lds
    s_lshl_b32 s4, s56, 10
    s_add_u32 s5, s4, 20480
    s_mov_b32 m0, s5
    s_add_u32 s5, s4, s52
    s_add_u32 s5, s5, 4096
    buffer_load_dwordx4 v221, s[12:15], s5 offen lds
    s_add_u32 s6, s4, 86016
    s_mov_b32 m0, s6
    s_nop 0
    buffer_load_dwordx4 v222, s[16:19], s5 offen lds
    s_lshl_b32 s4, s56, 10
    s_add_u32 s5, s4, 24576
    s_mov_b32 m0, s5
    s_add_u32 s5, s4, s52
    s_add_u32 s5, s5, 8192
    buffer_load_dwordx4 v221, s[12:15], s5 offen lds
    s_add_u32 s6, s4, 90112
    s_mov_b32 m0, s6
    s_nop 0
    buffer_load_dwordx4 v222, s[16:19], s5 offen lds
    s_lshl_b32 s4, s56, 10
    s_add_u32 s5, s4, 28672
    s_mov_b32 m0, s5
    s_add_u32 s5, s4, s52
    s_add_u32 s5, s5, 12288
    buffer_load_dwordx4 v221, s[12:15], s5 offen lds
    s_add_u32 s6, s4, 94208
    s_mov_b32 m0, s6
    s_nop 0
    buffer_load_dwordx4 v222, s[16:19], s5 offen lds
    s_cmp_lg_u32 s57, 0
    s_cbranch_scc1 A_sskips10
    ds_read_b128 v[164:167], v196 offset:0
    s_waitcnt lgkmcnt(0)
    v_mfma_f32_32x32x16_bf16 v[100:115], v[164:167], v[4:7], 0
    ds_read_b128 v[168:171], v197 offset:0
    s_waitcnt lgkmcnt(0)
    v_mfma_f32_32x32x16_bf16 v[100:115], v[168:171], v[8:11], v[100:115]
    ds_read_b128 v[172:175], v198 offset:0
    s_waitcnt lgkmcnt(0)
    v_mfma_f32_32x32x16_bf16 v[100:115], v[172:175], v[12:15], v[100:115]
    ds_read_b128 v[176:179], v199 offset:0
    s_waitcnt lgkmcnt(0)
    v_mfma_f32_32x32x16_bf16 v[100:115], v[176:179], v[16:19], v[100:115]
    ds_read_b128 v[164:167], v200 offset:0
    s_waitcnt lgkmcnt(0)
    v_mfma_f32_32x32x16_bf16 v[100:115], v[164:167], v[20:23], v[100:115]
    ds_read_b128 v[168:171], v201 offset:0
    s_waitcnt lgkmcnt(0)
    v_mfma_f32_32x32x16_bf16 v[100:115], v[168:171], v[24:27], v[100:115]
    ds_read_b128 v[172:175], v202 offset:0
    s_waitcnt lgkmcnt(0)
    v_mfma_f32_32x32x16_bf16 v[100:115], v[172:175], v[28:31], v[100:115]
    ds_read_b128 v[176:179], v203 offset:0
    s_waitcnt lgkmcnt(0)
    v_mfma_f32_32x32x16_bf16 v[100:115], v[176:179], v[32:35], v[100:115]
    s_nop 11
    v_max3_f32 v213, v100, v101, v102
    v_max3_f32 v214, v103, v104, v105
    v_max3_f32 v215, v106, v107, v108
    v_max3_f32 v216, v109, v110, v111
    v_max3_f32 v217, v112, v113, v114
    v_max3_f32 v213, v213, v214, v115
    v_max3_f32 v215, v215, v216, v217
    v_max_f32 v213, v213, v215
    v_mov_b32 v214, v213
    s_nop 1
    v_permlane32_swap_b32 v213, v214
    v_max3_f32 v213, v213, v214, v208
    v_sub_f32 v214, v213, v208
    v_cmp_lt_f32 vcc, s49, v214
    s_nop 1
    s_cbranch_vccz A_snrs10
    v_mul_f32 v214, s55, v214
    v_exp_f32 v211, v214
    s_nop 0
    v_mul_f32 v209, v209, v211
    v_mov_b32 v208, v213
    v_mul_f32 v36, v36, v211
    v_mul_f32 v37, v37, v211
    v_mul_f32 v38, v38, v211
    v_mul_f32 v39, v39, v211
    v_mul_f32 v40, v40, v211
    v_mul_f32 v41, v41, v211
    v_mul_f32 v42, v42, v211
    v_mul_f32 v43, v43, v211
    v_mul_f32 v44, v44, v211
    v_mul_f32 v45, v45, v211
    v_mul_f32 v46, v46, v211
    v_mul_f32 v47, v47, v211
    v_mul_f32 v48, v48, v211
    v_mul_f32 v49, v49, v211
    v_mul_f32 v50, v50, v211
    v_mul_f32 v51, v51, v211
    v_mul_f32 v52, v52, v211
    v_mul_f32 v53, v53, v211
    v_mul_f32 v54, v54, v211
    v_mul_f32 v55, v55, v211
    v_mul_f32 v56, v56, v211
    v_mul_f32 v57, v57, v211
    v_mul_f32 v58, v58, v211
    v_mul_f32 v59, v59, v211
    v_mul_f32 v60, v60, v211
    v_mul_f32 v61, v61, v211
    v_mul_f32 v62, v62, v211
    v_mul_f32 v63, v63, v211
    v_mul_f32 v64, v64, v211
    v_mul_f32 v65, v65, v211
    v_mul_f32 v66, v66, v211
    v_mul_f32 v67, v67, v211
    v_mul_f32 v68, v68, v211
    v_mul_f32 v69, v69, v211
    v_mul_f32 v70, v70, v211
    v_mul_f32 v71, v71, v211
    v_mul_f32 v72, v72, v211
    v_mul_f32 v73, v73, v211
    v_mul_f32 v74, v74, v211
    v_mul_f32 v75, v75, v211
    v_mul_f32 v76, v76, v211
    v_mul_f32 v77, v77, v211
    v_mul_f32 v78, v78, v211
    v_mul_f32 v79, v79, v211
    v_mul_f32 v80, v80, v211
    v_mul_f32 v81, v81, v211
    v_mul_f32 v82, v82, v211
    v_mul_f32 v83, v83, v211
    v_mul_f32 v84, v84, v211
    v_mul_f32 v85, v85, v211
    v_mul_f32 v86, v86, v211
    v_mul_f32 v87, v87, v211
    v_mul_f32 v88, v88, v211
    v_mul_f32 v89, v89, v211
    v_mul_f32 v90, v90, v211
    v_mul_f32 v91, v91, v211
    v_mul_f32 v92, v92, v211
    v_mul_f32 v93, v93, v211
    v_mul_f32 v94, v94, v211
    v_mul_f32 v95, v95, v211
    v_mul_f32 v96, v96, v211
    v_mul_f32 v97, v97, v211
    v_mul_f32 v98, v98, v211
    v_mul_f32 v99, v99, v211
A_snrs10:
    v_mul_f32 v212, s48, v208
    v_fma_f32 v100, v100, s48, -v212
    v_exp_f32 v100, v100
    s_nop 0
    v_add_f32 v209, v209, v100
    v_fma_f32 v101, v101, s48, -v212
    v_exp_f32 v101, v101
    s_nop 0
    v_add_f32 v209, v209, v101
    v_cvt_pk_bf16_f32 v100, v100, v101
    v_fma_f32 v102, v102, s48, -v212
    v_exp_f32 v102, v102
    s_nop 0
    v_add_f32 v209, v209, v102
    v_fma_f32 v103, v103, s48, -v212
    v_exp_f32 v103, v103
    s_nop 0
    v_add_f32 v209, v209, v103
    v_cvt_pk_bf16_f32 v101, v102, v103
    v_fma_f32 v104, v104, s48, -v212
    v_exp_f32 v104, v104
    s_nop 0
    v_add_f32 v209, v209, v104
    v_fma_f32 v105, v105, s48, -v212
    v_exp_f32 v105, v105
    s_nop 0
    v_add_f32 v209, v209, v105
    v_cvt_pk_bf16_f32 v102, v104, v105
    v_fma_f32 v106, v106, s48, -v212
    v_exp_f32 v106, v106
    s_nop 0
    v_add_f32 v209, v209, v106
    v_fma_f32 v107, v107, s48, -v212
    v_exp_f32 v107, v107
    s_nop 0
    v_add_f32 v209, v209, v107
    v_cvt_pk_bf16_f32 v103, v106, v107
    v_fma_f32 v108, v108, s48, -v212
    v_exp_f32 v108, v108
    s_nop 0
    v_add_f32 v209, v209, v108
    v_fma_f32 v109, v109, s48, -v212
    v_exp_f32 v109, v109
    s_nop 0
    v_add_f32 v209, v209, v109
    v_cvt_pk_bf16_f32 v104, v108, v109
    v_fma_f32 v110, v110, s48, -v212
    v_exp_f32 v110, v110
    s_nop 0
    v_add_f32 v209, v209, v110
    v_fma_f32 v111, v111, s48, -v212
    v_exp_f32 v111, v111
    s_nop 0
    v_add_f32 v209, v209, v111
    v_cvt_pk_bf16_f32 v105, v110, v111
    v_fma_f32 v112, v112, s48, -v212
    v_exp_f32 v112, v112
    s_nop 0
    v_add_f32 v209, v209, v112
    v_fma_f32 v113, v113, s48, -v212
    v_exp_f32 v113, v113
    s_nop 0
    v_add_f32 v209, v209, v113
    v_cvt_pk_bf16_f32 v106, v112, v113
    v_fma_f32 v114, v114, s48, -v212
    v_exp_f32 v114, v114
    s_nop 0
    v_add_f32 v209, v209, v114
    v_fma_f32 v115, v115, s48, -v212
    v_exp_f32 v115, v115
    s_nop 0
    v_add_f32 v209, v209, v115
    v_cvt_pk_bf16_f32 v107, v114, v115
    ds_read_b64_tr_b16 v[180:181], v204 offset:0
    ds_read_b64_tr_b16 v[182:183], v204 offset:2048
    s_waitcnt lgkmcnt(0)
    v_mfma_f32_32x32x16_bf16 v[36:51], v[180:183], v[100:103], v[36:51]
    ds_read_b64_tr_b16 v[184:185], v205 offset:0
    ds_read_b64_tr_b16 v[186:187], v205 offset:2048
    s_waitcnt lgkmcnt(0)
    v_mfma_f32_32x32x16_bf16 v[52:67], v[184:187], v[100:103], v[52:67]
    ds_read_b64_tr_b16 v[188:189], v206 offset:0
    ds_read_b64_tr_b16 v[190:191], v206 offset:2048
    s_waitcnt lgkmcnt(0)
    v_mfma_f32_32x32x16_bf16 v[68:83], v[188:191], v[100:103], v[68:83]
    ds_read_b64_tr_b16 v[192:193], v207 offset:0
    ds_read_b64_tr_b16 v[194:195], v207 offset:2048
    s_waitcnt lgkmcnt(0)
    v_mfma_f32_32x32x16_bf16 v[84:99], v[192:195], v[100:103], v[84:99]
    ds_read_b64_tr_b16 v[180:181], v204 offset:4096
    ds_read_b64_tr_b16 v[182:183], v204 offset:6144
    s_waitcnt lgkmcnt(0)
    v_mfma_f32_32x32x16_bf16 v[36:51], v[180:183], v[104:107], v[36:51]
    ds_read_b64_tr_b16 v[184:185], v205 offset:4096
    ds_read_b64_tr_b16 v[186:187], v205 offset:6144
    s_waitcnt lgkmcnt(0)
    v_mfma_f32_32x32x16_bf16 v[52:67], v[184:187], v[104:107], v[52:67]
    ds_read_b64_tr_b16 v[188:189], v206 offset:4096
    ds_read_b64_tr_b16 v[190:191], v206 offset:6144
    s_waitcnt lgkmcnt(0)
    v_mfma_f32_32x32x16_bf16 v[68:83], v[188:191], v[104:107], v[68:83]
    ds_read_b64_tr_b16 v[192:193], v207 offset:4096
    ds_read_b64_tr_b16 v[194:195], v207 offset:6144
    s_waitcnt lgkmcnt(0)
    v_mfma_f32_32x32x16_bf16 v[84:99], v[192:195], v[104:107], v[84:99]
    s_waitcnt lgkmcnt(0)
A_sskips10:
    s_waitcnt vmcnt(8)
    s_barrier
    s_add_u32 s52, s52, 16384
    s_lshl_b32 s4, s56, 10
    s_add_u32 s5, s4, 32768
    s_mov_b32 m0, s5
    s_add_u32 s5, s4, s52
    s_add_u32 s5, s5, 0
    buffer_load_dwordx4 v221, s[12:15], s5 offen lds
    s_add_u32 s6, s4, 98304
    s_mov_b32 m0, s6
    s_nop 0
    buffer_load_dwordx4 v222, s[16:19], s5 offen lds
    s_lshl_b32 s4, s56, 10
    s_add_u32 s5, s4, 36864
    s_mov_b32 m0, s5
    s_add_u32 s5, s4, s52
    s_add_u32 s5, s5, 4096
    buffer_load_dwordx4 v221, s[12:15], s5 offen lds
    s_add_u32 s6, s4, 102400
    s_mov_b32 m0, s6
    s_nop 0
    buffer_load_dwordx4 v222, s[16:19], s5 offen lds
    s_lshl_b32 s4, s56, 10
    s_add_u32 s5, s4, 40960
    s_mov_b32 m0, s5
    s_add_u32 s5, s4, s52
    s_add_u32 s5, s5, 8192
    buffer_load_dwordx4 v221, s[12:15], s5 offen lds
    s_add_u32 s6, s4, 106496
    s_mov_b32 m0, s6
    s_nop 0
    buffer_load_dwordx4 v222, s[16:19], s5 offen lds
    s_lshl_b32 s4, s56, 10
    s_add_u32 s5, s4, 45056
    s_mov_b32 m0, s5
    s_add_u32 s5, s4, s52
    s_add_u32 s5, s5, 12288
    buffer_load_dwordx4 v221, s[12:15], s5 offen lds
    s_add_u32 s6, s4, 110592
    s_mov_b32 m0, s6
    s_nop 0
    buffer_load_dwordx4 v222, s[16:19], s5 offen lds
    s_cmp_lg_u32 s57, 1
    s_cbranch_scc1 A_sskips11
    ds_read_b128 v[164:167], v196 offset:16384
    s_waitcnt lgkmcnt(0)
    v_mfma_f32_32x32x16_bf16 v[100:115], v[164:167], v[4:7], 0
    ds_read_b128 v[168:171], v197 offset:16384
    s_waitcnt lgkmcnt(0)
    v_mfma_f32_32x32x16_bf16 v[100:115], v[168:171], v[8:11], v[100:115]
    ds_read_b128 v[172:175], v198 offset:16384
    s_waitcnt lgkmcnt(0)
    v_mfma_f32_32x32x16_bf16 v[100:115], v[172:175], v[12:15], v[100:115]
    ds_read_b128 v[176:179], v199 offset:16384
    s_waitcnt lgkmcnt(0)
    v_mfma_f32_32x32x16_bf16 v[100:115], v[176:179], v[16:19], v[100:115]
    ds_read_b128 v[164:167], v200 offset:16384
    s_waitcnt lgkmcnt(0)
    v_mfma_f32_32x32x16_bf16 v[100:115], v[164:167], v[20:23], v[100:115]
    ds_read_b128 v[168:171], v201 offset:16384
    s_waitcnt lgkmcnt(0)
    v_mfma_f32_32x32x16_bf16 v[100:115], v[168:171], v[24:27], v[100:115]
    ds_read_b128 v[172:175], v202 offset:16384
    s_waitcnt lgkmcnt(0)
    v_mfma_f32_32x32x16_bf16 v[100:115], v[172:175], v[28:31], v[100:115]
    ds_read_b128 v[176:179], v203 offset:16384
    s_waitcnt lgkmcnt(0)
    v_mfma_f32_32x32x16_bf16 v[100:115], v[176:179], v[32:35], v[100:115]
    s_nop 11
    v_max3_f32 v213, v100, v101, v102
    v_max3_f32 v214, v103, v104, v105
    v_max3_f32 v215, v106, v107, v108
    v_max3_f32 v216, v109, v110, v111
    v_max3_f32 v217, v112, v113, v114
    v_max3_f32 v213, v213, v214, v115
    v_max3_f32 v215, v215, v216, v217
    v_max_f32 v213, v213, v215
    v_mov_b32 v214, v213
    s_nop 1
    v_permlane32_swap_b32 v213, v214
    v_max3_f32 v213, v213, v214, v208
    v_sub_f32 v214, v213, v208
    v_cmp_lt_f32 vcc, s49, v214
    s_nop 1
    s_cbranch_vccz A_snrs11
    v_mul_f32 v214, s55, v214
    v_exp_f32 v211, v214
    s_nop 0
    v_mul_f32 v209, v209, v211
    v_mov_b32 v208, v213
    v_mul_f32 v36, v36, v211
    v_mul_f32 v37, v37, v211
    v_mul_f32 v38, v38, v211
    v_mul_f32 v39, v39, v211
    v_mul_f32 v40, v40, v211
    v_mul_f32 v41, v41, v211
    v_mul_f32 v42, v42, v211
    v_mul_f32 v43, v43, v211
    v_mul_f32 v44, v44, v211
    v_mul_f32 v45, v45, v211
    v_mul_f32 v46, v46, v211
    v_mul_f32 v47, v47, v211
    v_mul_f32 v48, v48, v211
    v_mul_f32 v49, v49, v211
    v_mul_f32 v50, v50, v211
    v_mul_f32 v51, v51, v211
    v_mul_f32 v52, v52, v211
    v_mul_f32 v53, v53, v211
    v_mul_f32 v54, v54, v211
    v_mul_f32 v55, v55, v211
    v_mul_f32 v56, v56, v211
    v_mul_f32 v57, v57, v211
    v_mul_f32 v58, v58, v211
    v_mul_f32 v59, v59, v211
    v_mul_f32 v60, v60, v211
    v_mul_f32 v61, v61, v211
    v_mul_f32 v62, v62, v211
    v_mul_f32 v63, v63, v211
    v_mul_f32 v64, v64, v211
    v_mul_f32 v65, v65, v211
    v_mul_f32 v66, v66, v211
    v_mul_f32 v67, v67, v211
    v_mul_f32 v68, v68, v211
    v_mul_f32 v69, v69, v211
    v_mul_f32 v70, v70, v211
    v_mul_f32 v71, v71, v211
    v_mul_f32 v72, v72, v211
    v_mul_f32 v73, v73, v211
    v_mul_f32 v74, v74, v211
    v_mul_f32 v75, v75, v211
    v_mul_f32 v76, v76, v211
    v_mul_f32 v77, v77, v211
    v_mul_f32 v78, v78, v211
    v_mul_f32 v79, v79, v211
    v_mul_f32 v80, v80, v211
    v_mul_f32 v81, v81, v211
    v_mul_f32 v82, v82, v211
    v_mul_f32 v83, v83, v211
    v_mul_f32 v84, v84, v211
    v_mul_f32 v85, v85, v211
    v_mul_f32 v86, v86, v211
    v_mul_f32 v87, v87, v211
    v_mul_f32 v88, v88, v211
    v_mul_f32 v89, v89, v211
    v_mul_f32 v90, v90, v211
    v_mul_f32 v91, v91, v211
    v_mul_f32 v92, v92, v211
    v_mul_f32 v93, v93, v211
    v_mul_f32 v94, v94, v211
    v_mul_f32 v95, v95, v211
    v_mul_f32 v96, v96, v211
    v_mul_f32 v97, v97, v211
    v_mul_f32 v98, v98, v211
    v_mul_f32 v99, v99, v211
A_snrs11:
    v_mul_f32 v212, s48, v208
    v_fma_f32 v100, v100, s48, -v212
    v_exp_f32 v100, v100
    s_nop 0
    v_add_f32 v209, v209, v100
    v_fma_f32 v101, v101, s48, -v212
    v_exp_f32 v101, v101
    s_nop 0
    v_add_f32 v209, v209, v101
    v_cvt_pk_bf16_f32 v100, v100, v101
    v_fma_f32 v102, v102, s48, -v212
    v_exp_f32 v102, v102
    s_nop 0
    v_add_f32 v209, v209, v102
    v_fma_f32 v103, v103, s48, -v212
    v_exp_f32 v103, v103
    s_nop 0
    v_add_f32 v209, v209, v103
    v_cvt_pk_bf16_f32 v101, v102, v103
    v_fma_f32 v104, v104, s48, -v212
    v_exp_f32 v104, v104
    s_nop 0
    v_add_f32 v209, v209, v104
    v_fma_f32 v105, v105, s48, -v212
    v_exp_f32 v105, v105
    s_nop 0
    v_add_f32 v209, v209, v105
    v_cvt_pk_bf16_f32 v102, v104, v105
    v_fma_f32 v106, v106, s48, -v212
    v_exp_f32 v106, v106
    s_nop 0
    v_add_f32 v209, v209, v106
    v_fma_f32 v107, v107, s48, -v212
    v_exp_f32 v107, v107
    s_nop 0
    v_add_f32 v209, v209, v107
    v_cvt_pk_bf16_f32 v103, v106, v107
    v_fma_f32 v108, v108, s48, -v212
    v_exp_f32 v108, v108
    s_nop 0
    v_add_f32 v209, v209, v108
    v_fma_f32 v109, v109, s48, -v212
    v_exp_f32 v109, v109
    s_nop 0
    v_add_f32 v209, v209, v109
    v_cvt_pk_bf16_f32 v104, v108, v109
    v_fma_f32 v110, v110, s48, -v212
    v_exp_f32 v110, v110
    s_nop 0
    v_add_f32 v209, v209, v110
    v_fma_f32 v111, v111, s48, -v212
    v_exp_f32 v111, v111
    s_nop 0
    v_add_f32 v209, v209, v111
    v_cvt_pk_bf16_f32 v105, v110, v111
    v_fma_f32 v112, v112, s48, -v212
    v_exp_f32 v112, v112
    s_nop 0
    v_add_f32 v209, v209, v112
    v_fma_f32 v113, v113, s48, -v212
    v_exp_f32 v113, v113
    s_nop 0
    v_add_f32 v209, v209, v113
    v_cvt_pk_bf16_f32 v106, v112, v113
    v_fma_f32 v114, v114, s48, -v212
    v_exp_f32 v114, v114
    s_nop 0
    v_add_f32 v209, v209, v114
    v_fma_f32 v115, v115, s48, -v212
    v_exp_f32 v115, v115
    s_nop 0
    v_add_f32 v209, v209, v115
    v_cvt_pk_bf16_f32 v107, v114, v115
    ds_read_b64_tr_b16 v[180:181], v204 offset:16384
    ds_read_b64_tr_b16 v[182:183], v204 offset:18432
    s_waitcnt lgkmcnt(0)
    v_mfma_f32_32x32x16_bf16 v[36:51], v[180:183], v[100:103], v[36:51]
    ds_read_b64_tr_b16 v[184:185], v205 offset:16384
    ds_read_b64_tr_b16 v[186:187], v205 offset:18432
    s_waitcnt lgkmcnt(0)
    v_mfma_f32_32x32x16_bf16 v[52:67], v[184:187], v[100:103], v[52:67]
    ds_read_b64_tr_b16 v[188:189], v206 offset:16384
    ds_read_b64_tr_b16 v[190:191], v206 offset:18432
    s_waitcnt lgkmcnt(0)
    v_mfma_f32_32x32x16_bf16 v[68:83], v[188:191], v[100:103], v[68:83]
    ds_read_b64_tr_b16 v[192:193], v207 offset:16384
    ds_read_b64_tr_b16 v[194:195], v207 offset:18432
    s_waitcnt lgkmcnt(0)
    v_mfma_f32_32x32x16_bf16 v[84:99], v[192:195], v[100:103], v[84:99]
    ds_read_b64_tr_b16 v[180:181], v204 offset:20480
    ds_read_b64_tr_b16 v[182:183], v204 offset:22528
    s_waitcnt lgkmcnt(0)
    v_mfma_f32_32x32x16_bf16 v[36:51], v[180:183], v[104:107], v[36:51]
    ds_read_b64_tr_b16 v[184:185], v205 offset:20480
    ds_read_b64_tr_b16 v[186:187], v205 offset:22528
    s_waitcnt lgkmcnt(0)
    v_mfma_f32_32x32x16_bf16 v[52:67], v[184:187], v[104:107], v[52:67]
    ds_read_b64_tr_b16 v[188:189], v206 offset:20480
    ds_read_b64_tr_b16 v[190:191], v206 offset:22528
    s_waitcnt lgkmcnt(0)
    v_mfma_f32_32x32x16_bf16 v[68:83], v[188:191], v[104:107], v[68:83]
    ds_read_b64_tr_b16 v[192:193], v207 offset:20480
    ds_read_b64_tr_b16 v[194:195], v207 offset:22528
    s_waitcnt lgkmcnt(0)
    v_mfma_f32_32x32x16_bf16 v[84:99], v[192:195], v[104:107], v[84:99]
    s_waitcnt lgkmcnt(0)
A_sskips11:
    s_waitcnt vmcnt(8)
    s_barrier
    v_xor_b32 v196, 0x8000, v196
    v_xor_b32 v197, 0x8000, v197
    v_xor_b32 v198, 0x8000, v198
    v_xor_b32 v199, 0x8000, v199
    v_xor_b32 v200, 0x8000, v200
    v_xor_b32 v201, 0x8000, v201
    v_xor_b32 v202, 0x8000, v202
    v_xor_b32 v203, 0x8000, v203
    v_xor_b32 v204, 0x8000, v204
    v_xor_b32 v205, 0x8000, v205
    v_xor_b32 v206, 0x8000, v206
    v_xor_b32 v207, 0x8000, v207
    s_add_u32 s52, s52, 16384
    s_lshl_b32 s4, s56, 10
    s_add_u32 s5, s4, 49152
    s_mov_b32 m0, s5
    s_add_u32 s5, s4, s52
    s_add_u32 s5, s5, 0
    buffer_load_dwordx4 v221, s[12:15], s5 offen lds
    s_add_u32 s6, s4, 114688
    s_mov_b32 m0, s6
    s_nop 0
    buffer_load_dwordx4 v222, s[16:19], s5 offen lds
    s_lshl_b32 s4, s56, 10
    s_add_u32 s5, s4, 53248
    s_mov_b32 m0, s5
    s_add_u32 s5, s4, s52
    s_add_u32 s5, s5, 4096
    buffer_load_dwordx4 v221, s[12:15], s5 offen lds
    s_add_u32 s6, s4, 118784
    s_mov_b32 m0, s6
    s_nop 0
    buffer_load_dwordx4 v222, s[16:19], s5 offen lds
    s_lshl_b32 s4, s56, 10
    s_add_u32 s5, s4, 57344
    s_mov_b32 m0, s5
    s_add_u32 s5, s4, s52
    s_add_u32 s5, s5, 8192
    buffer_load_dwordx4 v221, s[12:15], s5 offen lds
    s_add_u32 s6, s4, 122880
    s_mov_b32 m0, s6
    s_nop 0
    buffer_load_dwordx4 v222, s[16:19], s5 offen lds
    s_lshl_b32 s4, s56, 10
    s_add_u32 s5, s4, 61440
    s_mov_b32 m0, s5
    s_add_u32 s5, s4, s52
    s_add_u32 s5, s5, 12288
    buffer_load_dwordx4 v221, s[12:15], s5 offen lds
    s_add_u32 s6, s4, 126976
    s_mov_b32 m0, s6
    s_nop 0
    buffer_load_dwordx4 v222, s[16:19], s5 offen lds
    s_cmp_lg_u32 s57, 0
    s_cbranch_scc1 A_sskips12
    ds_read_b128 v[164:167], v196 offset:0
    s_waitcnt lgkmcnt(0)
    v_mfma_f32_32x32x16_bf16 v[100:115], v[164:167], v[4:7], 0
    ds_read_b128 v[168:171], v197 offset:0
    s_waitcnt lgkmcnt(0)
    v_mfma_f32_32x32x16_bf16 v[100:115], v[168:171], v[8:11], v[100:115]
    ds_read_b128 v[172:175], v198 offset:0
    s_waitcnt lgkmcnt(0)
    v_mfma_f32_32x32x16_bf16 v[100:115], v[172:175], v[12:15], v[100:115]
    ds_read_b128 v[176:179], v199 offset:0
    s_waitcnt lgkmcnt(0)
    v_mfma_f32_32x32x16_bf16 v[100:115], v[176:179], v[16:19], v[100:115]
    ds_read_b128 v[164:167], v200 offset:0
    s_waitcnt lgkmcnt(0)
    v_mfma_f32_32x32x16_bf16 v[100:115], v[164:167], v[20:23], v[100:115]
    ds_read_b128 v[168:171], v201 offset:0
    s_waitcnt lgkmcnt(0)
    v_mfma_f32_32x32x16_bf16 v[100:115], v[168:171], v[24:27], v[100:115]
    ds_read_b128 v[172:175], v202 offset:0
    s_waitcnt lgkmcnt(0)
    v_mfma_f32_32x32x16_bf16 v[100:115], v[172:175], v[28:31], v[100:115]
    ds_read_b128 v[176:179], v203 offset:0
    s_waitcnt lgkmcnt(0)
    v_mfma_f32_32x32x16_bf16 v[100:115], v[176:179], v[32:35], v[100:115]
    s_nop 11
    v_max3_f32 v213, v100, v101, v102
    v_max3_f32 v214, v103, v104, v105
    v_max3_f32 v215, v106, v107, v108
    v_max3_f32 v216, v109, v110, v111
    v_max3_f32 v217, v112, v113, v114
    v_max3_f32 v213, v213, v214, v115
    v_max3_f32 v215, v215, v216, v217
    v_max_f32 v213, v213, v215
    v_mov_b32 v214, v213
    s_nop 1
    v_permlane32_swap_b32 v213, v214
    v_max3_f32 v213, v213, v214, v208
    v_sub_f32 v214, v213, v208
    v_cmp_lt_f32 vcc, s49, v214
    s_nop 1
    s_cbranch_vccz A_snrs12
    v_mul_f32 v214, s55, v214
    v_exp_f32 v211, v214
    s_nop 0
    v_mul_f32 v209, v209, v211
    v_mov_b32 v208, v213
    v_mul_f32 v36, v36, v211
    v_mul_f32 v37, v37, v211
    v_mul_f32 v38, v38, v211
    v_mul_f32 v39, v39, v211
    v_mul_f32 v40, v40, v211
    v_mul_f32 v41, v41, v211
    v_mul_f32 v42, v42, v211
    v_mul_f32 v43, v43, v211
    v_mul_f32 v44, v44, v211
    v_mul_f32 v45, v45, v211
    v_mul_f32 v46, v46, v211
    v_mul_f32 v47, v47, v211
    v_mul_f32 v48, v48, v211
    v_mul_f32 v49, v49, v211
    v_mul_f32 v50, v50, v211
    v_mul_f32 v51, v51, v211
    v_mul_f32 v52, v52, v211
    v_mul_f32 v53, v53, v211
    v_mul_f32 v54, v54, v211
    v_mul_f32 v55, v55, v211
    v_mul_f32 v56, v56, v211
    v_mul_f32 v57, v57, v211
    v_mul_f32 v58, v58, v211
    v_mul_f32 v59, v59, v211
    v_mul_f32 v60, v60, v211
    v_mul_f32 v61, v61, v211
    v_mul_f32 v62, v62, v211
    v_mul_f32 v63, v63, v211
    v_mul_f32 v64, v64, v211
    v_mul_f32 v65, v65, v211
    v_mul_f32 v66, v66, v211
    v_mul_f32 v67, v67, v211
    v_mul_f32 v68, v68, v211
    v_mul_f32 v69, v69, v211
    v_mul_f32 v70, v70, v211
    v_mul_f32 v71, v71, v211
    v_mul_f32 v72, v72, v211
    v_mul_f32 v73, v73, v211
    v_mul_f32 v74, v74, v211
    v_mul_f32 v75, v75, v211
    v_mul_f32 v76, v76, v211
    v_mul_f32 v77, v77, v211
    v_mul_f32 v78, v78, v211
    v_mul_f32 v79, v79, v211
    v_mul_f32 v80, v80, v211
    v_mul_f32 v81, v81, v211
    v_mul_f32 v82, v82, v211
    v_mul_f32 v83, v83, v211
    v_mul_f32 v84, v84, v211
    v_mul_f32 v85, v85, v211
    v_mul_f32 v86, v86, v211
    v_mul_f32 v87, v87, v211
    v_mul_f32 v88, v88, v211
    v_mul_f32 v89, v89, v211
    v_mul_f32 v90, v90, v211
    v_mul_f32 v91, v91, v211
    v_mul_f32 v92, v92, v211
    v_mul_f32 v93, v93, v211
    v_mul_f32 v94, v94, v211
    v_mul_f32 v95, v95, v211
    v_mul_f32 v96, v96, v211
    v_mul_f32 v97, v97, v211
    v_mul_f32 v98, v98, v211
    v_mul_f32 v99, v99, v211
A_snrs12:
    v_mul_f32 v212, s48, v208
    v_fma_f32 v100, v100, s48, -v212
    v_exp_f32 v100, v100
    s_nop 0
    v_add_f32 v209, v209, v100
    v_fma_f32 v101, v101, s48, -v212
    v_exp_f32 v101, v101
    s_nop 0
    v_add_f32 v209, v209, v101
    v_cvt_pk_bf16_f32 v100, v100, v101
    v_fma_f32 v102, v102, s48, -v212
    v_exp_f32 v102, v102
    s_nop 0
    v_add_f32 v209, v209, v102
    v_fma_f32 v103, v103, s48, -v212
    v_exp_f32 v103, v103
    s_nop 0
    v_add_f32 v209, v209, v103
    v_cvt_pk_bf16_f32 v101, v102, v103
    v_fma_f32 v104, v104, s48, -v212
    v_exp_f32 v104, v104
    s_nop 0
    v_add_f32 v209, v209, v104
    v_fma_f32 v105, v105, s48, -v212
    v_exp_f32 v105, v105
    s_nop 0
    v_add_f32 v209, v209, v105
    v_cvt_pk_bf16_f32 v102, v104, v105
    v_fma_f32 v106, v106, s48, -v212
    v_exp_f32 v106, v106
    s_nop 0
    v_add_f32 v209, v209, v106
    v_fma_f32 v107, v107, s48, -v212
    v_exp_f32 v107, v107
    s_nop 0
    v_add_f32 v209, v209, v107
    v_cvt_pk_bf16_f32 v103, v106, v107
    v_fma_f32 v108, v108, s48, -v212
    v_exp_f32 v108, v108
    s_nop 0
    v_add_f32 v209, v209, v108
    v_fma_f32 v109, v109, s48, -v212
    v_exp_f32 v109, v109
    s_nop 0
    v_add_f32 v209, v209, v109
    v_cvt_pk_bf16_f32 v104, v108, v109
    v_fma_f32 v110, v110, s48, -v212
    v_exp_f32 v110, v110
    s_nop 0
    v_add_f32 v209, v209, v110
    v_fma_f32 v111, v111, s48, -v212
    v_exp_f32 v111, v111
    s_nop 0
    v_add_f32 v209, v209, v111
    v_cvt_pk_bf16_f32 v105, v110, v111
    v_fma_f32 v112, v112, s48, -v212
    v_exp_f32 v112, v112
    s_nop 0
    v_add_f32 v209, v209, v112
    v_fma_f32 v113, v113, s48, -v212
    v_exp_f32 v113, v113
    s_nop 0
    v_add_f32 v209, v209, v113
    v_cvt_pk_bf16_f32 v106, v112, v113
    v_fma_f32 v114, v114, s48, -v212
    v_exp_f32 v114, v114
    s_nop 0
    v_add_f32 v209, v209, v114
    v_fma_f32 v115, v115, s48, -v212
    v_exp_f32 v115, v115
    s_nop 0
    v_add_f32 v209, v209, v115
    v_cvt_pk_bf16_f32 v107, v114, v115
    ds_read_b64_tr_b16 v[180:181], v204 offset:0
    ds_read_b64_tr_b16 v[182:183], v204 offset:2048
    s_waitcnt lgkmcnt(0)
    v_mfma_f32_32x32x16_bf16 v[36:51], v[180:183], v[100:103], v[36:51]
    ds_read_b64_tr_b16 v[184:185], v205 offset:0
    ds_read_b64_tr_b16 v[186:187], v205 offset:2048
    s_waitcnt lgkmcnt(0)
    v_mfma_f32_32x32x16_bf16 v[52:67], v[184:187], v[100:103], v[52:67]
    ds_read_b64_tr_b16 v[188:189], v206 offset:0
    ds_read_b64_tr_b16 v[190:191], v206 offset:2048
    s_waitcnt lgkmcnt(0)
    v_mfma_f32_32x32x16_bf16 v[68:83], v[188:191], v[100:103], v[68:83]
    ds_read_b64_tr_b16 v[192:193], v207 offset:0
    ds_read_b64_tr_b16 v[194:195], v207 offset:2048
    s_waitcnt lgkmcnt(0)
    v_mfma_f32_32x32x16_bf16 v[84:99], v[192:195], v[100:103], v[84:99]
    ds_read_b64_tr_b16 v[180:181], v204 offset:4096
    ds_read_b64_tr_b16 v[182:183], v204 offset:6144
    s_waitcnt lgkmcnt(0)
    v_mfma_f32_32x32x16_bf16 v[36:51], v[180:183], v[104:107], v[36:51]
    ds_read_b64_tr_b16 v[184:185], v205 offset:4096
    ds_read_b64_tr_b16 v[186:187], v205 offset:6144
    s_waitcnt lgkmcnt(0)
    v_mfma_f32_32x32x16_bf16 v[52:67], v[184:187], v[104:107], v[52:67]
    ds_read_b64_tr_b16 v[188:189], v206 offset:4096
    ds_read_b64_tr_b16 v[190:191], v206 offset:6144
    s_waitcnt lgkmcnt(0)
    v_mfma_f32_32x32x16_bf16 v[68:83], v[188:191], v[104:107], v[68:83]
    ds_read_b64_tr_b16 v[192:193], v207 offset:4096
    ds_read_b64_tr_b16 v[194:195], v207 offset:6144
    s_waitcnt lgkmcnt(0)
    v_mfma_f32_32x32x16_bf16 v[84:99], v[192:195], v[104:107], v[84:99]
    s_waitcnt lgkmcnt(0)
A_sskips12:
    s_waitcnt vmcnt(8)
    s_barrier
    s_cmp_lg_u32 s57, 1
    s_cbranch_scc1 A_sskips13
    ds_read_b128 v[164:167], v196 offset:16384
    s_waitcnt lgkmcnt(0)
    v_mfma_f32_32x32x16_bf16 v[100:115], v[164:167], v[4:7], 0
    ds_read_b128 v[168:171], v197 offset:16384
    s_waitcnt lgkmcnt(0)
    v_mfma_f32_32x32x16_bf16 v[100:115], v[168:171], v[8:11], v[100:115]
    ds_read_b128 v[172:175], v198 offset:16384
    s_waitcnt lgkmcnt(0)
    v_mfma_f32_32x32x16_bf16 v[100:115], v[172:175], v[12:15], v[100:115]
    ds_read_b128 v[176:179], v199 offset:16384
    s_waitcnt lgkmcnt(0)
    v_mfma_f32_32x32x16_bf16 v[100:115], v[176:179], v[16:19], v[100:115]
    ds_read_b128 v[164:167], v200 offset:16384
    s_waitcnt lgkmcnt(0)
    v_mfma_f32_32x32x16_bf16 v[100:115], v[164:167], v[20:23], v[100:115]
    ds_read_b128 v[168:171], v201 offset:16384
    s_waitcnt lgkmcnt(0)
    v_mfma_f32_32x32x16_bf16 v[100:115], v[168:171], v[24:27], v[100:115]
    ds_read_b128 v[172:175], v202 offset:16384
    s_waitcnt lgkmcnt(0)
    v_mfma_f32_32x32x16_bf16 v[100:115], v[172:175], v[28:31], v[100:115]
    ds_read_b128 v[176:179], v203 offset:16384
    s_waitcnt lgkmcnt(0)
    v_mfma_f32_32x32x16_bf16 v[100:115], v[176:179], v[32:35], v[100:115]
    s_nop 11
    v_max3_f32 v213, v100, v101, v102
    v_max3_f32 v214, v103, v104, v105
    v_max3_f32 v215, v106, v107, v108
    v_max3_f32 v216, v109, v110, v111
    v_max3_f32 v217, v112, v113, v114
    v_max3_f32 v213, v213, v214, v115
    v_max3_f32 v215, v215, v216, v217
    v_max_f32 v213, v213, v215
    v_mov_b32 v214, v213
    s_nop 1
    v_permlane32_swap_b32 v213, v214
    v_max3_f32 v213, v213, v214, v208
    v_sub_f32 v214, v213, v208
    v_cmp_lt_f32 vcc, s49, v214
    s_nop 1
    s_cbranch_vccz A_snrs13
    v_mul_f32 v214, s55, v214
    v_exp_f32 v211, v214
    s_nop 0
    v_mul_f32 v209, v209, v211
    v_mov_b32 v208, v213
    v_mul_f32 v36, v36, v211
    v_mul_f32 v37, v37, v211
    v_mul_f32 v38, v38, v211
    v_mul_f32 v39, v39, v211
    v_mul_f32 v40, v40, v211
    v_mul_f32 v41, v41, v211
    v_mul_f32 v42, v42, v211
    v_mul_f32 v43, v43, v211
    v_mul_f32 v44, v44, v211
    v_mul_f32 v45, v45, v211
    v_mul_f32 v46, v46, v211
    v_mul_f32 v47, v47, v211
    v_mul_f32 v48, v48, v211
    v_mul_f32 v49, v49, v211
    v_mul_f32 v50, v50, v211
    v_mul_f32 v51, v51, v211
    v_mul_f32 v52, v52, v211
    v_mul_f32 v53, v53, v211
    v_mul_f32 v54, v54, v211
    v_mul_f32 v55, v55, v211
    v_mul_f32 v56, v56, v211
    v_mul_f32 v57, v57, v211
    v_mul_f32 v58, v58, v211
    v_mul_f32 v59, v59, v211
    v_mul_f32 v60, v60, v211
    v_mul_f32 v61, v61, v211
    v_mul_f32 v62, v62, v211
    v_mul_f32 v63, v63, v211
    v_mul_f32 v64, v64, v211
    v_mul_f32 v65, v65, v211
    v_mul_f32 v66, v66, v211
    v_mul_f32 v67, v67, v211
    v_mul_f32 v68, v68, v211
    v_mul_f32 v69, v69, v211
    v_mul_f32 v70, v70, v211
    v_mul_f32 v71, v71, v211
    v_mul_f32 v72, v72, v211
    v_mul_f32 v73, v73, v211
    v_mul_f32 v74, v74, v211
    v_mul_f32 v75, v75, v211
    v_mul_f32 v76, v76, v211
    v_mul_f32 v77, v77, v211
    v_mul_f32 v78, v78, v211
    v_mul_f32 v79, v79, v211
    v_mul_f32 v80, v80, v211
    v_mul_f32 v81, v81, v211
    v_mul_f32 v82, v82, v211
    v_mul_f32 v83, v83, v211
    v_mul_f32 v84, v84, v211
    v_mul_f32 v85, v85, v211
    v_mul_f32 v86, v86, v211
    v_mul_f32 v87, v87, v211
    v_mul_f32 v88, v88, v211
    v_mul_f32 v89, v89, v211
    v_mul_f32 v90, v90, v211
    v_mul_f32 v91, v91, v211
    v_mul_f32 v92, v92, v211
    v_mul_f32 v93, v93, v211
    v_mul_f32 v94, v94, v211
    v_mul_f32 v95, v95, v211
    v_mul_f32 v96, v96, v211
    v_mul_f32 v97, v97, v211
    v_mul_f32 v98, v98, v211
    v_mul_f32 v99, v99, v211
A_snrs13:
    v_mul_f32 v212, s48, v208
    v_fma_f32 v100, v100, s48, -v212
    v_exp_f32 v100, v100
    s_nop 0
    v_add_f32 v209, v209, v100
    v_fma_f32 v101, v101, s48, -v212
    v_exp_f32 v101, v101
    s_nop 0
    v_add_f32 v209, v209, v101
    v_cvt_pk_bf16_f32 v100, v100, v101
    v_fma_f32 v102, v102, s48, -v212
    v_exp_f32 v102, v102
    s_nop 0
    v_add_f32 v209, v209, v102
    v_fma_f32 v103, v103, s48, -v212
    v_exp_f32 v103, v103
    s_nop 0
    v_add_f32 v209, v209, v103
    v_cvt_pk_bf16_f32 v101, v102, v103
    v_fma_f32 v104, v104, s48, -v212
    v_exp_f32 v104, v104
    s_nop 0
    v_add_f32 v209, v209, v104
    v_fma_f32 v105, v105, s48, -v212
    v_exp_f32 v105, v105
    s_nop 0
    v_add_f32 v209, v209, v105
    v_cvt_pk_bf16_f32 v102, v104, v105
    v_fma_f32 v106, v106, s48, -v212
    v_exp_f32 v106, v106
    s_nop 0
    v_add_f32 v209, v209, v106
    v_fma_f32 v107, v107, s48, -v212
    v_exp_f32 v107, v107
    s_nop 0
    v_add_f32 v209, v209, v107
    v_cvt_pk_bf16_f32 v103, v106, v107
    v_fma_f32 v108, v108, s48, -v212
    v_exp_f32 v108, v108
    s_nop 0
    v_add_f32 v209, v209, v108
    v_fma_f32 v109, v109, s48, -v212
    v_exp_f32 v109, v109
    s_nop 0
    v_add_f32 v209, v209, v109
    v_cvt_pk_bf16_f32 v104, v108, v109
    v_fma_f32 v110, v110, s48, -v212
    v_exp_f32 v110, v110
    s_nop 0
    v_add_f32 v209, v209, v110
    v_fma_f32 v111, v111, s48, -v212
    v_exp_f32 v111, v111
    s_nop 0
    v_add_f32 v209, v209, v111
    v_cvt_pk_bf16_f32 v105, v110, v111
    v_fma_f32 v112, v112, s48, -v212
    v_exp_f32 v112, v112
    s_nop 0
    v_add_f32 v209, v209, v112
    v_fma_f32 v113, v113, s48, -v212
    v_exp_f32 v113, v113
    s_nop 0
    v_add_f32 v209, v209, v113
    v_cvt_pk_bf16_f32 v106, v112, v113
    v_fma_f32 v114, v114, s48, -v212
    v_exp_f32 v114, v114
    s_nop 0
    v_add_f32 v209, v209, v114
    v_fma_f32 v115, v115, s48, -v212
    v_exp_f32 v115, v115
    s_nop 0
    v_add_f32 v209, v209, v115
    v_cvt_pk_bf16_f32 v107, v114, v115
    ds_read_b64_tr_b16 v[180:181], v204 offset:16384
    ds_read_b64_tr_b16 v[182:183], v204 offset:18432
    s_waitcnt lgkmcnt(0)
    v_mfma_f32_32x32x16_bf16 v[36:51], v[180:183], v[100:103], v[36:51]
    ds_read_b64_tr_b16 v[184:185], v205 offset:16384
    ds_read_b64_tr_b16 v[186:187], v205 offset:18432
    s_waitcnt lgkmcnt(0)
    v_mfma_f32_32x32x16_bf16 v[52:67], v[184:187], v[100:103], v[52:67]
    ds_read_b64_tr_b16 v[188:189], v206 offset:16384
    ds_read_b64_tr_b16 v[190:191], v206 offset:18432
    s_waitcnt lgkmcnt(0)
    v_mfma_f32_32x32x16_bf16 v[68:83], v[188:191], v[100:103], v[68:83]
    ds_read_b64_tr_b16 v[192:193], v207 offset:16384
    ds_read_b64_tr_b16 v[194:195], v207 offset:18432
    s_waitcnt lgkmcnt(0)
    v_mfma_f32_32x32x16_bf16 v[84:99], v[192:195], v[100:103], v[84:99]
    ds_read_b64_tr_b16 v[180:181], v204 offset:20480
    ds_read_b64_tr_b16 v[182:183], v204 offset:22528
    s_waitcnt lgkmcnt(0)
    v_mfma_f32_32x32x16_bf16 v[36:51], v[180:183], v[104:107], v[36:51]
    ds_read_b64_tr_b16 v[184:185], v205 offset:20480
    ds_read_b64_tr_b16 v[186:187], v205 offset:22528
    s_waitcnt lgkmcnt(0)
    v_mfma_f32_32x32x16_bf16 v[52:67], v[184:187], v[104:107], v[52:67]
    ds_read_b64_tr_b16 v[188:189], v206 offset:20480
    ds_read_b64_tr_b16 v[190:191], v206 offset:22528
    s_waitcnt lgkmcnt(0)
    v_mfma_f32_32x32x16_bf16 v[68:83], v[188:191], v[104:107], v[68:83]
    ds_read_b64_tr_b16 v[192:193], v207 offset:20480
    ds_read_b64_tr_b16 v[194:195], v207 offset:22528
    s_waitcnt lgkmcnt(0)
    v_mfma_f32_32x32x16_bf16 v[84:99], v[192:195], v[104:107], v[84:99]
    s_waitcnt lgkmcnt(0)
A_sskips13:
    s_waitcnt vmcnt(0)
    s_barrier
    v_xor_b32 v196, 0x8000, v196
    v_xor_b32 v197, 0x8000, v197
    v_xor_b32 v198, 0x8000, v198
    v_xor_b32 v199, 0x8000, v199
    v_xor_b32 v200, 0x8000, v200
    v_xor_b32 v201, 0x8000, v201
    v_xor_b32 v202, 0x8000, v202
    v_xor_b32 v203, 0x8000, v203
    v_xor_b32 v204, 0x8000, v204
    v_xor_b32 v205, 0x8000, v205
    v_xor_b32 v206, 0x8000, v206
    v_xor_b32 v207, 0x8000, v207
    s_cmp_lg_u32 s57, 0
    s_cbranch_scc1 A_sskips14
    ds_read_b128 v[164:167], v196 offset:0
    s_waitcnt lgkmcnt(0)
    v_mfma_f32_32x32x16_bf16 v[100:115], v[164:167], v[4:7], 0
    ds_read_b128 v[168:171], v197 offset:0
    s_waitcnt lgkmcnt(0)
    v_mfma_f32_32x32x16_bf16 v[100:115], v[168:171], v[8:11], v[100:115]
    ds_read_b128 v[172:175], v198 offset:0
    s_waitcnt lgkmcnt(0)
    v_mfma_f32_32x32x16_bf16 v[100:115], v[172:175], v[12:15], v[100:115]
    ds_read_b128 v[176:179], v199 offset:0
    s_waitcnt lgkmcnt(0)
    v_mfma_f32_32x32x16_bf16 v[100:115], v[176:179], v[16:19], v[100:115]
    ds_read_b128 v[164:167], v200 offset:0
    s_waitcnt lgkmcnt(0)
    v_mfma_f32_32x32x16_bf16 v[100:115], v[164:167], v[20:23], v[100:115]
    ds_read_b128 v[168:171], v201 offset:0
    s_waitcnt lgkmcnt(0)
    v_mfma_f32_32x32x16_bf16 v[100:115], v[168:171], v[24:27], v[100:115]
    ds_read_b128 v[172:175], v202 offset:0
    s_waitcnt lgkmcnt(0)
    v_mfma_f32_32x32x16_bf16 v[100:115], v[172:175], v[28:31], v[100:115]
    ds_read_b128 v[176:179], v203 offset:0
    s_waitcnt lgkmcnt(0)
    v_mfma_f32_32x32x16_bf16 v[100:115], v[176:179], v[32:35], v[100:115]
    s_nop 11
    v_max3_f32 v213, v100, v101, v102
    v_max3_f32 v214, v103, v104, v105
    v_max3_f32 v215, v106, v107, v108
    v_max3_f32 v216, v109, v110, v111
    v_max3_f32 v217, v112, v113, v114
    v_max3_f32 v213, v213, v214, v115
    v_max3_f32 v215, v215, v216, v217
    v_max_f32 v213, v213, v215
    v_mov_b32 v214, v213
    s_nop 1
    v_permlane32_swap_b32 v213, v214
    v_max3_f32 v213, v213, v214, v208
    v_sub_f32 v214, v213, v208
    v_cmp_lt_f32 vcc, s49, v214
    s_nop 1
    s_cbranch_vccz A_snrs14
    v_mul_f32 v214, s55, v214
    v_exp_f32 v211, v214
    s_nop 0
    v_mul_f32 v209, v209, v211
    v_mov_b32 v208, v213
    v_mul_f32 v36, v36, v211
    v_mul_f32 v37, v37, v211
    v_mul_f32 v38, v38, v211
    v_mul_f32 v39, v39, v211
    v_mul_f32 v40, v40, v211
    v_mul_f32 v41, v41, v211
    v_mul_f32 v42, v42, v211
    v_mul_f32 v43, v43, v211
    v_mul_f32 v44, v44, v211
    v_mul_f32 v45, v45, v211
    v_mul_f32 v46, v46, v211
    v_mul_f32 v47, v47, v211
    v_mul_f32 v48, v48, v211
    v_mul_f32 v49, v49, v211
    v_mul_f32 v50, v50, v211
    v_mul_f32 v51, v51, v211
    v_mul_f32 v52, v52, v211
    v_mul_f32 v53, v53, v211
    v_mul_f32 v54, v54, v211
    v_mul_f32 v55, v55, v211
    v_mul_f32 v56, v56, v211
    v_mul_f32 v57, v57, v211
    v_mul_f32 v58, v58, v211
    v_mul_f32 v59, v59, v211
    v_mul_f32 v60, v60, v211
    v_mul_f32 v61, v61, v211
    v_mul_f32 v62, v62, v211
    v_mul_f32 v63, v63, v211
    v_mul_f32 v64, v64, v211
    v_mul_f32 v65, v65, v211
    v_mul_f32 v66, v66, v211
    v_mul_f32 v67, v67, v211
    v_mul_f32 v68, v68, v211
    v_mul_f32 v69, v69, v211
    v_mul_f32 v70, v70, v211
    v_mul_f32 v71, v71, v211
    v_mul_f32 v72, v72, v211
    v_mul_f32 v73, v73, v211
    v_mul_f32 v74, v74, v211
    v_mul_f32 v75, v75, v211
    v_mul_f32 v76, v76, v211
    v_mul_f32 v77, v77, v211
    v_mul_f32 v78, v78, v211
    v_mul_f32 v79, v79, v211
    v_mul_f32 v80, v80, v211
    v_mul_f32 v81, v81, v211
    v_mul_f32 v82, v82, v211
    v_mul_f32 v83, v83, v211
    v_mul_f32 v84, v84, v211
    v_mul_f32 v85, v85, v211
    v_mul_f32 v86, v86, v211
    v_mul_f32 v87, v87, v211
    v_mul_f32 v88, v88, v211
    v_mul_f32 v89, v89, v211
    v_mul_f32 v90, v90, v211
    v_mul_f32 v91, v91, v211
    v_mul_f32 v92, v92, v211
    v_mul_f32 v93, v93, v211
    v_mul_f32 v94, v94, v211
    v_mul_f32 v95, v95, v211
    v_mul_f32 v96, v96, v211
    v_mul_f32 v97, v97, v211
    v_mul_f32 v98, v98, v211
    v_mul_f32 v99, v99, v211
A_snrs14:
    v_mul_f32 v212, s48, v208
    v_fma_f32 v100, v100, s48, -v212
    v_exp_f32 v100, v100
    s_nop 0
    v_add_f32 v209, v209, v100
    v_fma_f32 v101, v101, s48, -v212
    v_exp_f32 v101, v101
    s_nop 0
    v_add_f32 v209, v209, v101
    v_cvt_pk_bf16_f32 v100, v100, v101
    v_fma_f32 v102, v102, s48, -v212
    v_exp_f32 v102, v102
    s_nop 0
    v_add_f32 v209, v209, v102
    v_fma_f32 v103, v103, s48, -v212
    v_exp_f32 v103, v103
    s_nop 0
    v_add_f32 v209, v209, v103
    v_cvt_pk_bf16_f32 v101, v102, v103
    v_fma_f32 v104, v104, s48, -v212
    v_exp_f32 v104, v104
    s_nop 0
    v_add_f32 v209, v209, v104
    v_fma_f32 v105, v105, s48, -v212
    v_exp_f32 v105, v105
    s_nop 0
    v_add_f32 v209, v209, v105
    v_cvt_pk_bf16_f32 v102, v104, v105
    v_fma_f32 v106, v106, s48, -v212
    v_exp_f32 v106, v106
    s_nop 0
    v_add_f32 v209, v209, v106
    v_fma_f32 v107, v107, s48, -v212
    v_exp_f32 v107, v107
    s_nop 0
    v_add_f32 v209, v209, v107
    v_cvt_pk_bf16_f32 v103, v106, v107
    v_fma_f32 v108, v108, s48, -v212
    v_exp_f32 v108, v108
    s_nop 0
    v_add_f32 v209, v209, v108
    v_fma_f32 v109, v109, s48, -v212
    v_exp_f32 v109, v109
    s_nop 0
    v_add_f32 v209, v209, v109
    v_cvt_pk_bf16_f32 v104, v108, v109
    v_fma_f32 v110, v110, s48, -v212
    v_exp_f32 v110, v110
    s_nop 0
    v_add_f32 v209, v209, v110
    v_fma_f32 v111, v111, s48, -v212
    v_exp_f32 v111, v111
    s_nop 0
    v_add_f32 v209, v209, v111
    v_cvt_pk_bf16_f32 v105, v110, v111
    v_fma_f32 v112, v112, s48, -v212
    v_exp_f32 v112, v112
    s_nop 0
    v_add_f32 v209, v209, v112
    v_fma_f32 v113, v113, s48, -v212
    v_exp_f32 v113, v113
    s_nop 0
    v_add_f32 v209, v209, v113
    v_cvt_pk_bf16_f32 v106, v112, v113
    v_fma_f32 v114, v114, s48, -v212
    v_exp_f32 v114, v114
    s_nop 0
    v_add_f32 v209, v209, v114
    v_fma_f32 v115, v115, s48, -v212
    v_exp_f32 v115, v115
    s_nop 0
    v_add_f32 v209, v209, v115
    v_cvt_pk_bf16_f32 v107, v114, v115
    ds_read_b64_tr_b16 v[180:181], v204 offset:0
    ds_read_b64_tr_b16 v[182:183], v204 offset:2048
    s_waitcnt lgkmcnt(0)
    v_mfma_f32_32x32x16_bf16 v[36:51], v[180:183], v[100:103], v[36:51]
    ds_read_b64_tr_b16 v[184:185], v205 offset:0
    ds_read_b64_tr_b16 v[186:187], v205 offset:2048
    s_waitcnt lgkmcnt(0)
    v_mfma_f32_32x32x16_bf16 v[52:67], v[184:187], v[100:103], v[52:67]
    ds_read_b64_tr_b16 v[188:189], v206 offset:0
    ds_read_b64_tr_b16 v[190:191], v206 offset:2048
    s_waitcnt lgkmcnt(0)
    v_mfma_f32_32x32x16_bf16 v[68:83], v[188:191], v[100:103], v[68:83]
    ds_read_b64_tr_b16 v[192:193], v207 offset:0
    ds_read_b64_tr_b16 v[194:195], v207 offset:2048
    s_waitcnt lgkmcnt(0)
    v_mfma_f32_32x32x16_bf16 v[84:99], v[192:195], v[100:103], v[84:99]
    ds_read_b64_tr_b16 v[180:181], v204 offset:4096
    ds_read_b64_tr_b16 v[182:183], v204 offset:6144
    s_waitcnt lgkmcnt(0)
    v_mfma_f32_32x32x16_bf16 v[36:51], v[180:183], v[104:107], v[36:51]
    ds_read_b64_tr_b16 v[184:185], v205 offset:4096
    ds_read_b64_tr_b16 v[186:187], v205 offset:6144
    s_waitcnt lgkmcnt(0)
    v_mfma_f32_32x32x16_bf16 v[52:67], v[184:187], v[104:107], v[52:67]
    ds_read_b64_tr_b16 v[188:189], v206 offset:4096
    ds_read_b64_tr_b16 v[190:191], v206 offset:6144
    s_waitcnt lgkmcnt(0)
    v_mfma_f32_32x32x16_bf16 v[68:83], v[188:191], v[104:107], v[68:83]
    ds_read_b64_tr_b16 v[192:193], v207 offset:4096
    ds_read_b64_tr_b16 v[194:195], v207 offset:6144
    s_waitcnt lgkmcnt(0)
    v_mfma_f32_32x32x16_bf16 v[84:99], v[192:195], v[104:107], v[84:99]
    s_waitcnt lgkmcnt(0)
A_sskips14:
    s_waitcnt vmcnt(0)
    s_barrier
    s_cmp_lg_u32 s57, 1
    s_cbranch_scc1 A_sskips15
    ds_read_b128 v[164:167], v196 offset:16384
    s_waitcnt lgkmcnt(0)
    v_mfma_f32_32x32x16_bf16 v[100:115], v[164:167], v[4:7], 0
    ds_read_b128 v[168:171], v197 offset:16384
    s_waitcnt lgkmcnt(0)
    v_mfma_f32_32x32x16_bf16 v[100:115], v[168:171], v[8:11], v[100:115]
    ds_read_b128 v[172:175], v198 offset:16384
    s_waitcnt lgkmcnt(0)
    v_mfma_f32_32x32x16_bf16 v[100:115], v[172:175], v[12:15], v[100:115]
    ds_read_b128 v[176:179], v199 offset:16384
    s_waitcnt lgkmcnt(0)
    v_mfma_f32_32x32x16_bf16 v[100:115], v[176:179], v[16:19], v[100:115]
    ds_read_b128 v[164:167], v200 offset:16384
    s_waitcnt lgkmcnt(0)
    v_mfma_f32_32x32x16_bf16 v[100:115], v[164:167], v[20:23], v[100:115]
    ds_read_b128 v[168:171], v201 offset:16384
    s_waitcnt lgkmcnt(0)
    v_mfma_f32_32x32x16_bf16 v[100:115], v[168:171], v[24:27], v[100:115]
    ds_read_b128 v[172:175], v202 offset:16384
    s_waitcnt lgkmcnt(0)
    v_mfma_f32_32x32x16_bf16 v[100:115], v[172:175], v[28:31], v[100:115]
    ds_read_b128 v[176:179], v203 offset:16384
    s_waitcnt lgkmcnt(0)
    v_mfma_f32_32x32x16_bf16 v[100:115], v[176:179], v[32:35], v[100:115]
    s_nop 11
    v_max3_f32 v213, v100, v101, v102
    v_max3_f32 v214, v103, v104, v105
    v_max3_f32 v215, v106, v107, v108
    v_max3_f32 v216, v109, v110, v111
    v_max3_f32 v217, v112, v113, v114
    v_max3_f32 v213, v213, v214, v115
    v_max3_f32 v215, v215, v216, v217
    v_max_f32 v213, v213, v215
    v_mov_b32 v214, v213
    s_nop 1
    v_permlane32_swap_b32 v213, v214
    v_max3_f32 v213, v213, v214, v208
    v_sub_f32 v214, v213, v208
    v_cmp_lt_f32 vcc, s49, v214
    s_nop 1
    s_cbranch_vccz A_snrs15
    v_mul_f32 v214, s55, v214
    v_exp_f32 v211, v214
    s_nop 0
    v_mul_f32 v209, v209, v211
    v_mov_b32 v208, v213
    v_mul_f32 v36, v36, v211
    v_mul_f32 v37, v37, v211
    v_mul_f32 v38, v38, v211
    v_mul_f32 v39, v39, v211
    v_mul_f32 v40, v40, v211
    v_mul_f32 v41, v41, v211
    v_mul_f32 v42, v42, v211
    v_mul_f32 v43, v43, v211
    v_mul_f32 v44, v44, v211
    v_mul_f32 v45, v45, v211
    v_mul_f32 v46, v46, v211
    v_mul_f32 v47, v47, v211
    v_mul_f32 v48, v48, v211
    v_mul_f32 v49, v49, v211
    v_mul_f32 v50, v50, v211
    v_mul_f32 v51, v51, v211
    v_mul_f32 v52, v52, v211
    v_mul_f32 v53, v53, v211
    v_mul_f32 v54, v54, v211
    v_mul_f32 v55, v55, v211
    v_mul_f32 v56, v56, v211
    v_mul_f32 v57, v57, v211
    v_mul_f32 v58, v58, v211
    v_mul_f32 v59, v59, v211
    v_mul_f32 v60, v60, v211
    v_mul_f32 v61, v61, v211
    v_mul_f32 v62, v62, v211
    v_mul_f32 v63, v63, v211
    v_mul_f32 v64, v64, v211
    v_mul_f32 v65, v65, v211
    v_mul_f32 v66, v66, v211
    v_mul_f32 v67, v67, v211
    v_mul_f32 v68, v68, v211
    v_mul_f32 v69, v69, v211
    v_mul_f32 v70, v70, v211
    v_mul_f32 v71, v71, v211
    v_mul_f32 v72, v72, v211
    v_mul_f32 v73, v73, v211
    v_mul_f32 v74, v74, v211
    v_mul_f32 v75, v75, v211
    v_mul_f32 v76, v76, v211
    v_mul_f32 v77, v77, v211
    v_mul_f32 v78, v78, v211
    v_mul_f32 v79, v79, v211
    v_mul_f32 v80, v80, v211
    v_mul_f32 v81, v81, v211
    v_mul_f32 v82, v82, v211
    v_mul_f32 v83, v83, v211
    v_mul_f32 v84, v84, v211
    v_mul_f32 v85, v85, v211
    v_mul_f32 v86, v86, v211
    v_mul_f32 v87, v87, v211
    v_mul_f32 v88, v88, v211
    v_mul_f32 v89, v89, v211
    v_mul_f32 v90, v90, v211
    v_mul_f32 v91, v91, v211
    v_mul_f32 v92, v92, v211
    v_mul_f32 v93, v93, v211
    v_mul_f32 v94, v94, v211
    v_mul_f32 v95, v95, v211
    v_mul_f32 v96, v96, v211
    v_mul_f32 v97, v97, v211
    v_mul_f32 v98, v98, v211
    v_mul_f32 v99, v99, v211
A_snrs15:
    v_mul_f32 v212, s48, v208
    v_fma_f32 v100, v100, s48, -v212
    v_exp_f32 v100, v100
    s_nop 0
    v_add_f32 v209, v209, v100
    v_fma_f32 v101, v101, s48, -v212
    v_exp_f32 v101, v101
    s_nop 0
    v_add_f32 v209, v209, v101
    v_cvt_pk_bf16_f32 v100, v100, v101
    v_fma_f32 v102, v102, s48, -v212
    v_exp_f32 v102, v102
    s_nop 0
    v_add_f32 v209, v209, v102
    v_fma_f32 v103, v103, s48, -v212
    v_exp_f32 v103, v103
    s_nop 0
    v_add_f32 v209, v209, v103
    v_cvt_pk_bf16_f32 v101, v102, v103
    v_fma_f32 v104, v104, s48, -v212
    v_exp_f32 v104, v104
    s_nop 0
    v_add_f32 v209, v209, v104
    v_fma_f32 v105, v105, s48, -v212
    v_exp_f32 v105, v105
    s_nop 0
    v_add_f32 v209, v209, v105
    v_cvt_pk_bf16_f32 v102, v104, v105
    v_fma_f32 v106, v106, s48, -v212
    v_exp_f32 v106, v106
    s_nop 0
    v_add_f32 v209, v209, v106
    v_fma_f32 v107, v107, s48, -v212
    v_exp_f32 v107, v107
    s_nop 0
    v_add_f32 v209, v209, v107
    v_cvt_pk_bf16_f32 v103, v106, v107
    v_fma_f32 v108, v108, s48, -v212
    v_exp_f32 v108, v108
    s_nop 0
    v_add_f32 v209, v209, v108
    v_fma_f32 v109, v109, s48, -v212
    v_exp_f32 v109, v109
    s_nop 0
    v_add_f32 v209, v209, v109
    v_cvt_pk_bf16_f32 v104, v108, v109
    v_fma_f32 v110, v110, s48, -v212
    v_exp_f32 v110, v110
    s_nop 0
    v_add_f32 v209, v209, v110
    v_fma_f32 v111, v111, s48, -v212
    v_exp_f32 v111, v111
    s_nop 0
    v_add_f32 v209, v209, v111
    v_cvt_pk_bf16_f32 v105, v110, v111
    v_fma_f32 v112, v112, s48, -v212
    v_exp_f32 v112, v112
    s_nop 0
    v_add_f32 v209, v209, v112
    v_fma_f32 v113, v113, s48, -v212
    v_exp_f32 v113, v113
    s_nop 0
    v_add_f32 v209, v209, v113
    v_cvt_pk_bf16_f32 v106, v112, v113
    v_fma_f32 v114, v114, s48, -v212
    v_exp_f32 v114, v114
    s_nop 0
    v_add_f32 v209, v209, v114
    v_fma_f32 v115, v115, s48, -v212
    v_exp_f32 v115, v115
    s_nop 0
    v_add_f32 v209, v209, v115
    v_cvt_pk_bf16_f32 v107, v114, v115
    ds_read_b64_tr_b16 v[180:181], v204 offset:16384
    ds_read_b64_tr_b16 v[182:183], v204 offset:18432
    s_waitcnt lgkmcnt(0)
    v_mfma_f32_32x32x16_bf16 v[36:51], v[180:183], v[100:103], v[36:51]
    ds_read_b64_tr_b16 v[184:185], v205 offset:16384
    ds_read_b64_tr_b16 v[186:187], v205 offset:18432
    s_waitcnt lgkmcnt(0)
    v_mfma_f32_32x32x16_bf16 v[52:67], v[184:187], v[100:103], v[52:67]
    ds_read_b64_tr_b16 v[188:189], v206 offset:16384
    ds_read_b64_tr_b16 v[190:191], v206 offset:18432
    s_waitcnt lgkmcnt(0)
    v_mfma_f32_32x32x16_bf16 v[68:83], v[188:191], v[100:103], v[68:83]
    ds_read_b64_tr_b16 v[192:193], v207 offset:16384
    ds_read_b64_tr_b16 v[194:195], v207 offset:18432
    s_waitcnt lgkmcnt(0)
    v_mfma_f32_32x32x16_bf16 v[84:99], v[192:195], v[100:103], v[84:99]
    ds_read_b64_tr_b16 v[180:181], v204 offset:20480
    ds_read_b64_tr_b16 v[182:183], v204 offset:22528
    s_waitcnt lgkmcnt(0)
    v_mfma_f32_32x32x16_bf16 v[36:51], v[180:183], v[104:107], v[36:51]
    ds_read_b64_tr_b16 v[184:185], v205 offset:20480
    ds_read_b64_tr_b16 v[186:187], v205 offset:22528
    s_waitcnt lgkmcnt(0)
    v_mfma_f32_32x32x16_bf16 v[52:67], v[184:187], v[104:107], v[52:67]
    ds_read_b64_tr_b16 v[188:189], v206 offset:20480
    ds_read_b64_tr_b16 v[190:191], v206 offset:22528
    s_waitcnt lgkmcnt(0)
    v_mfma_f32_32x32x16_bf16 v[68:83], v[188:191], v[104:107], v[68:83]
    ds_read_b64_tr_b16 v[192:193], v207 offset:20480
    ds_read_b64_tr_b16 v[194:195], v207 offset:22528
    s_waitcnt lgkmcnt(0)
    v_mfma_f32_32x32x16_bf16 v[84:99], v[192:195], v[104:107], v[84:99]
    s_waitcnt lgkmcnt(0)
A_sskips15:
    s_waitcnt vmcnt(0)
    s_barrier
    v_xor_b32 v196, 0x8000, v196
    v_xor_b32 v197, 0x8000, v197
    v_xor_b32 v198, 0x8000, v198
    v_xor_b32 v199, 0x8000, v199
    v_xor_b32 v200, 0x8000, v200
    v_xor_b32 v201, 0x8000, v201
    v_xor_b32 v202, 0x8000, v202
    v_xor_b32 v203, 0x8000, v203
    v_xor_b32 v204, 0x8000, v204
    v_xor_b32 v205, 0x8000, v205
    v_xor_b32 v206, 0x8000, v206
    v_xor_b32 v207, 0x8000, v207
    v_mov_b32 v210, v209
    s_nop 1
    v_permlane32_swap_b32 v209, v210
    v_add_f32 v209, v209, v210
    s_lshl_b32 s4, s56, 14
    v_lshlrev_b32 v217, 2, v1
    v_add_u32 v217, s4, v217
    ds_write_b32 v217, v36 offset:0
    ds_write_b32 v217, v37 offset:256
    ds_write_b32 v217, v38 offset:512
    ds_write_b32 v217, v39 offset:768
    ds_write_b32 v217, v40 offset:1024
    ds_write_b32 v217, v41 offset:1280
    ds_write_b32 v217, v42 offset:1536
    ds_write_b32 v217, v43 offset:1792
    ds_write_b32 v217, v44 offset:2048
    ds_write_b32 v217, v45 offset:2304
    ds_write_b32 v217, v46 offset:2560
    ds_write_b32 v217, v47 offset:2816
    ds_write_b32 v217, v48 offset:3072
    ds_write_b32 v217, v49 offset:3328
    ds_write_b32 v217, v50 offset:3584
    ds_write_b32 v217, v51 offset:3840
    ds_write_b32 v217, v52 offset:4096
    ds_write_b32 v217, v53 offset:4352
    ds_write_b32 v217, v54 offset:4608
    ds_write_b32 v217, v55 offset:4864
    ds_write_b32 v217, v56 offset:5120
    ds_write_b32 v217, v57 offset:5376
    ds_write_b32 v217, v58 offset:5632
    ds_write_b32 v217, v59 offset:5888
    ds_write_b32 v217, v60 offset:6144
    ds_write_b32 v217, v61 offset:6400
    ds_write_b32 v217, v62 offset:6656
    ds_write_b32 v217, v63 offset:6912
    ds_write_b32 v217, v64 offset:7168
    ds_write_b32 v217, v65 offset:7424
    ds_write_b32 v217, v66 offset:7680
    ds_write_b32 v217, v67 offset:7936
    ds_write_b32 v217, v68 offset:8192
    ds_write_b32 v217, v69 offset:8448
    ds_write_b32 v217, v70 offset:8704
    ds_write_b32 v217, v71 offset:8960
    ds_write_b32 v217, v72 offset:9216
    ds_write_b32 v217, v73 offset:9472
    ds_write_b32 v217, v74 offset:9728
    ds_write_b32 v217, v75 offset:9984
    ds_write_b32 v217, v76 offset:10240
    ds_write_b32 v217, v77 offset:10496
    ds_write_b32 v217, v78 offset:10752
    ds_write_b32 v217, v79 offset:11008
    ds_write_b32 v217, v80 offset:11264
    ds_write_b32 v217, v81 offset:11520
    ds_write_b32 v217, v82 offset:11776
    ds_write_b32 v217, v83 offset:12032
    ds_write_b32 v217, v84 offset:12288
    ds_write_b32 v217, v85 offset:12544
    ds_write_b32 v217, v86 offset:12800
    ds_write_b32 v217, v87 offset:13056
    ds_write_b32 v217, v88 offset:13312
    ds_write_b32 v217, v89 offset:13568
    ds_write_b32 v217, v90 offset:13824
    ds_write_b32 v217, v91 offset:14080
    ds_write_b32 v217, v92 offset:14336
    ds_write_b32 v217, v93 offset:14592
    ds_write_b32 v217, v94 offset:14848
    ds_write_b32 v217, v95 offset:15104
    ds_write_b32 v217, v96 offset:15360
    ds_write_b32 v217, v97 offset:15616
    ds_write_b32 v217, v98 offset:15872
    ds_write_b32 v217, v99 offset:16128
    s_lshl_b32 s4, s56, 9
    v_lshlrev_b32 v218, 2, v1
    v_add_u32 v218, s4, v218
    v_add_u32 v218, 65536, v218
    ds_write_b32 v218, v208
    ds_write_b32 v218, v209 offset:256
    s_waitcnt lgkmcnt(0)
    s_barrier
    v_lshlrev_b32 v218, 2, v1
    v_add_u32 v218, 65536, v218
    ds_read_b32 v132, v218 offset:0
    ds_read_b32 v136, v218 offset:256
    ds_read_b32 v133, v218 offset:512
    ds_read_b32 v137, v218 offset:768
    ds_read_b32 v134, v218 offset:1024
    ds_read_b32 v138, v218 offset:1280
    ds_read_b32 v135, v218 offset:1536
    ds_read_b32 v139, v218 offset:1792
    s_lshl_b32 s4, s56, 12
    v_lshlrev_b32 v217, 2, v1
    v_add_u32 v217, s4, v217
    ds_read_b32 v100, v217 offset:0
    ds_read_b32 v101, v217 offset:256
    ds_read_b32 v102, v217 offset:512
    ds_read_b32 v103, v217 offset:768
    ds_read_b32 v104, v217 offset:1024
    ds_read_b32 v105, v217 offset:1280
    ds_read_b32 v106, v217 offset:1536
    ds_read_b32 v107, v217 offset:1792
    ds_read_b32 v108, v217 offset:2048
    ds_read_b32 v109, v217 offset:2304
    ds_read_b32 v110, v217 offset:2560
    ds_read_b32 v111, v217 offset:2816
    ds_read_b32 v112, v217 offset:3072
    ds_read_b32 v113, v217 offset:3328
    ds_read_b32 v114, v217 offset:3584
    ds_read_b32 v115, v217 offset:3840
    ds_read_b32 v116, v217 offset:16384
    ds_read_b32 v117, v217 offset:16640
    ds_read_b32 v118, v217 offset:16896
    ds_read_b32 v119, v217 offset:17152
    ds_read_b32 v120, v217 offset:17408
    ds_read_b32 v121, v217 offset:17664
    ds_read_b32 v122, v217 offset:17920
    ds_read_b32 v123, v217 offset:18176
    ds_read_b32 v124, v217 offset:18432
    ds_read_b32 v125, v217 offset:18688
    ds_read_b32 v126, v217 offset:18944
    ds_read_b32 v127, v217 offset:19200
    ds_read_b32 v128, v217 offset:19456
    ds_read_b32 v129, v217 offset:19712
    ds_read_b32 v130, v217 offset:19968
    ds_read_b32 v131, v217 offset:20224
    ds_read_b32 v36, v217 offset:32768
    ds_read_b32 v37, v217 offset:33024
    ds_read_b32 v38, v217 offset:33280
    ds_read_b32 v39, v217 offset:33536
    ds_read_b32 v40, v217 offset:33792
    ds_read_b32 v41, v217 offset:34048
    ds_read_b32 v42, v217 offset:34304
    ds_read_b32 v43, v217 offset:34560
    ds_read_b32 v44, v217 offset:34816
    ds_read_b32 v45, v217 offset:35072
    ds_read_b32 v46, v217 offset:35328
    ds_read_b32 v47, v217 offset:35584
    ds_read_b32 v48, v217 offset:35840
    ds_read_b32 v49, v217 offset:36096
    ds_read_b32 v50, v217 offset:36352
    ds_read_b32 v51, v217 offset:36608
    ds_read_b32 v52, v217 offset:49152
    ds_read_b32 v53, v217 offset:49408
    ds_read_b32 v54, v217 offset:49664
    ds_read_b32 v55, v217 offset:49920
    ds_read_b32 v56, v217 offset:50176
    ds_read_b32 v57, v217 offset:50432
    ds_read_b32 v58, v217 offset:50688
    ds_read_b32 v59, v217 offset:50944
    ds_read_b32 v60, v217 offset:51200
    ds_read_b32 v61, v217 offset:51456
    ds_read_b32 v62, v217 offset:51712
    ds_read_b32 v63, v217 offset:51968
    ds_read_b32 v64, v217 offset:52224
    ds_read_b32 v65, v217 offset:52480
    ds_read_b32 v66, v217 offset:52736
    ds_read_b32 v67, v217 offset:52992
    s_waitcnt lgkmcnt(15)
    v_max3_f32 v213, v132, v133, v134
    v_max_f32 v213, v213, v135
    v_sub_f32 v132, v132, v213
    v_mul_f32 v132, s48, v132
    v_exp_f32 v132, v132
    v_sub_f32 v133, v133, v213
    v_mul_f32 v133, s48, v133
    v_exp_f32 v133, v133
    v_sub_f32 v134, v134, v213
    v_mul_f32 v134, s48, v134
    v_exp_f32 v134, v134
    v_sub_f32 v135, v135, v213
    v_mul_f32 v135, s48, v135
    v_exp_f32 v135, v135
    v_mul_f32 v209, v132, v136
    v_fmac_f32 v209, v133, v137
    v_fmac_f32 v209, v134, v138
    v_fmac_f32 v209, v135, v139
    v_rcp_f32 v209, v209
    s_nop 0
    v_mul_f32 v132, v132, v209
    v_mul_f32 v133, v133, v209
    v_mul_f32 v134, v134, v209
    v_mul_f32 v135, v135, v209
    v_mul_f32 v68, v100, v132
    v_fmac_f32 v68, v116, v133
    v_fmac_f32 v68, v36, v134
    v_fmac_f32 v68, v52, v135
    v_mul_f32 v69, v101, v132
    v_fmac_f32 v69, v117, v133
    v_fmac_f32 v69, v37, v134
    s_waitcnt lgkmcnt(14)
    v_fmac_f32 v69, v53, v135
    v_mul_f32 v70, v102, v132
    v_fmac_f32 v70, v118, v133
    v_fmac_f32 v70, v38, v134
    s_waitcnt lgkmcnt(13)
    v_fmac_f32 v70, v54, v135
    v_mul_f32 v71, v103, v132
    v_fmac_f32 v71, v119, v133
    v_fmac_f32 v71, v39, v134
    s_waitcnt lgkmcnt(12)
    v_fmac_f32 v71, v55, v135
    v_mul_f32 v72, v104, v132
    v_fmac_f32 v72, v120, v133
    v_fmac_f32 v72, v40, v134
    s_waitcnt lgkmcnt(11)
    v_fmac_f32 v72, v56, v135
    v_mul_f32 v73, v105, v132
    v_fmac_f32 v73, v121, v133
    v_fmac_f32 v73, v41, v134
    s_waitcnt lgkmcnt(10)
    v_fmac_f32 v73, v57, v135
    v_mul_f32 v74, v106, v132
    v_fmac_f32 v74, v122, v133
    v_fmac_f32 v74, v42, v134
    s_waitcnt lgkmcnt(9)
    v_fmac_f32 v74, v58, v135
    v_mul_f32 v75, v107, v132
    v_fmac_f32 v75, v123, v133
    v_fmac_f32 v75, v43, v134
    s_waitcnt lgkmcnt(8)
    v_fmac_f32 v75, v59, v135
    v_mul_f32 v76, v108, v132
    v_fmac_f32 v76, v124, v133
    v_fmac_f32 v76, v44, v134
    s_waitcnt lgkmcnt(7)
    v_fmac_f32 v76, v60, v135
    v_mul_f32 v77, v109, v132
    v_fmac_f32 v77, v125, v133
    v_fmac_f32 v77, v45, v134
    s_waitcnt lgkmcnt(6)
    v_fmac_f32 v77, v61, v135
    v_mul_f32 v78, v110, v132
    v_fmac_f32 v78, v126, v133
    v_fmac_f32 v78, v46, v134
    s_waitcnt lgkmcnt(5)
    v_fmac_f32 v78, v62, v135
    v_mul_f32 v79, v111, v132
    v_fmac_f32 v79, v127, v133
    v_fmac_f32 v79, v47, v134
    s_waitcnt lgkmcnt(4)
    v_fmac_f32 v79, v63, v135
    v_mul_f32 v80, v112, v132
    v_fmac_f32 v80, v128, v133
    v_fmac_f32 v80, v48, v134
    s_waitcnt lgkmcnt(3)
    v_fmac_f32 v80, v64, v135
    v_mul_f32 v81, v113, v132
    v_fmac_f32 v81, v129, v133
    v_fmac_f32 v81, v49, v134
    s_waitcnt lgkmcnt(2)
    v_fmac_f32 v81, v65, v135
    v_mul_f32 v82, v114, v132
    v_fmac_f32 v82, v130, v133
    v_fmac_f32 v82, v50, v134
    s_waitcnt lgkmcnt(1)
    v_fmac_f32 v82, v66, v135
    v_mul_f32 v83, v115, v132
    v_fmac_f32 v83, v131, v133
    v_fmac_f32 v83, v51, v134
    s_waitcnt lgkmcnt(0)
    v_fmac_f32 v83, v67, v135
    v_lshrrev_b32 v215, 5, v1
    v_and_b32 v216, 31, v1
    v_add_u32 v217, 128, v216
    v_cmp_gt_u32 vcc, 80, v217
    v_subrev_u32 v218, 80, v217
    s_nop 0
    v_cndmask_b32 v218, v218, v217, vcc
    v_mov_b32 v219, 8192
    v_cndmask_b32 v219, v219, 0, vcc
    v_lshrrev_b32 v217, 5, v218
    v_and_b32 v218, 31, v218
    v_lshlrev_b32 v218, 4, v218
    v_lshl_add_u32 v218, v217, 18, v218
    v_add_u32 v218, v218, v219
    s_mul_i32 s4, s28, 786432
    s_lshl_b32 s5, s31, 13
    s_add_u32 s4, s4, s5
    v_add_u32 v218, s4, v218
    v_lshl_add_u32 v218, v215, 3, v218
    s_mov_b32 s60, 0
    s_mov_b32 s61, 2048
    s_mov_b32 s62, 4096
    s_mov_b32 s63, 6144
    s_lshl_b32 s4, s56, 11
    v_add_u32 v218, s4, v218
    v_cvt_pk_bf16_f32 v68, v68, v69
    v_cvt_pk_bf16_f32 v69, v70, v71
    buffer_store_dwordx2 v[68:69], v218, s[24:27], 0 offen offset:0
    v_cvt_pk_bf16_f32 v72, v72, v73
    v_cvt_pk_bf16_f32 v73, v74, v75
    buffer_store_dwordx2 v[72:73], v218, s[24:27], 0 offen offset:512
    v_cvt_pk_bf16_f32 v76, v76, v77
    v_cvt_pk_bf16_f32 v77, v78, v79
    buffer_store_dwordx2 v[76:77], v218, s[24:27], 0 offen offset:1024
    v_cvt_pk_bf16_f32 v80, v80, v81
    v_cvt_pk_bf16_f32 v81, v82, v83
    buffer_store_dwordx2 v[80:81], v218, s[24:27], 0 offen offset:1536
A_end:
    s_endpgm
.globl gqa_oproj_kernel
.p2align 8
.type gqa_oproj_kernel,@function
gqa_oproj_kernel:
    s_cmp_ge_u32 s2, 256
    s_cbranch_scc1 B_end
    s_load_dwordx16 s[32:47], s[0:1], 0
    v_lshrrev_b32 v2, 6, v0
    v_and_b32 v1, 63, v0
    s_nop 0
    v_readfirstlane_b32 s3, v2
    s_lshr_b32 s28, s2, 4
    s_and_b32 s29, s2, 15
    s_waitcnt lgkmcnt(0)
    s_mov_b32 s8, s40
    s_and_b32 s9, s41, 0xffff
    s_mov_b32 s10, 4194304
    s_mov_b32 s11, 0x20000
    s_mov_b32 s12, s46
    s_and_b32 s13, s47, 0xffff
    s_mov_b32 s14, 12582912
    s_mov_b32 s15, 0x20000
    s_mov_b32 s16, s42
    s_and_b32 s17, s43, 0xffff
    s_mov_b32 s18, 1310720
    s_mov_b32 s19, 0x20000
    v_lshrrev_b32 v2, 4, v1
    v_and_b32 v3, 15, v1
    v_lshrrev_b32 v4, 5, v1
    v_and_b32 v5, 31, v1
    v_lshrrev_b32 v6, 2, v1
    v_and_b32 v7, 3, v1
    v_lshlrev_b32 v7, 4, v7
    v_lshl_add_u32 v8, v6, 10, v7
    v_lshrrev_b32 v6, 2, v3
    v_lshl_add_u32 v6, v4, 3, v6
    v_lshlrev_b32 v6, 6, v6
    v_and_b32 v7, 1, v2
    v_lshl_add_u32 v6, v7, 5, v6
    v_and_b32 v7, 3, v1
    v_lshl_add_u32 v6, v7, 3, v6
    s_lshl_b32 s4, s3, 13
    v_add_u32 v9, s4, v6
    s_mul_i32 s4, s28, 786432
    s_lshl_b32 s5, s3, 16
    s_add_u32 s4, s4, s5
    v_lshlrev_b32 v6, 4, v1
    v_add_u32 v10, s4, v6
    s_lshl_b32 s52, s3, 20
    s_lshl_b32 s4, s29, 6
    s_add_u32 s52, s52, s4
    s_lshl_b32 s53, s3, 13
    s_add_u32 s4, s53, 0
    s_mov_b32 m0, s4
    s_add_u32 s5, s52, 0
    buffer_load_dwordx4 v8, s[8:11], s5 offen lds
    s_add_u32 s4, s53, 1024
    s_mov_b32 m0, s4
    s_add_u32 s5, s52, 16384
    buffer_load_dwordx4 v8, s[8:11], s5 offen lds
    s_add_u32 s4, s53, 2048
    s_mov_b32 m0, s4
    s_add_u32 s5, s52, 32768
    buffer_load_dwordx4 v8, s[8:11], s5 offen lds
    s_add_u32 s4, s53, 3072
    s_mov_b32 m0, s4
    s_add_u32 s5, s52, 49152
    buffer_load_dwordx4 v8, s[8:11], s5 offen lds
    v_add_u32 v116, 0x40000, v10
    v_add_u32 v117, 0x80000, v10
    s_mov_b32 s60, 0
    buffer_load_dwordx4 v[20:23], v10, s[12:15], s60 offen
    buffer_load_dwordx4 v[24:27], v116, s[12:15], s60 offen
    buffer_load_dwordx4 v[28:31], v117, s[12:15], s60 offen
    s_mov_b32 s60, 1024
    buffer_load_dwordx4 v[32:35], v10, s[12:15], s60 offen
    buffer_load_dwordx4 v[36:39], v116, s[12:15], s60 offen
    buffer_load_dwordx4 v[40:43], v117, s[12:15], s60 offen
    s_mov_b32 s60, 2048
    buffer_load_dwordx4 v[44:47], v10, s[12:15], s60 offen
    buffer_load_dwordx4 v[48:51], v116, s[12:15], s60 offen
    buffer_load_dwordx4 v[52:55], v117, s[12:15], s60 offen
    s_add_u32 s4, s53, 4096
    s_mov_b32 m0, s4
    s_add_u32 s5, s52, 65536
    buffer_load_dwordx4 v8, s[8:11], s5 offen lds
    s_add_u32 s4, s53, 5120
    s_mov_b32 m0, s4
    s_add_u32 s5, s52, 81920
    buffer_load_dwordx4 v8, s[8:11], s5 offen lds
    s_add_u32 s4, s53, 6144
    s_mov_b32 m0, s4
    s_add_u32 s5, s52, 98304
    buffer_load_dwordx4 v8, s[8:11], s5 offen lds
    s_add_u32 s4, s53, 7168
    s_mov_b32 m0, s4
    s_add_u32 s5, s52, 114688
    buffer_load_dwordx4 v8, s[8:11], s5 offen lds
    s_mov_b32 s60, 3072
    buffer_load_dwordx4 v[56:59], v10, s[12:15], s60 offen
    buffer_load_dwordx4 v[60:63], v116, s[12:15], s60 offen
    buffer_load_dwordx4 v[64:67], v117, s[12:15], s60 offen
    s_waitcnt vmcnt(13)
    ds_read_b64_tr_b16 v[12:13], v9 offset:0
    ds_read_b64_tr_b16 v[14:15], v9 offset:256
    s_waitcnt lgkmcnt(0)
    v_mfma_f32_32x32x16_bf16 v[68:83], v[12:15], v[20:23], 0
    v_mfma_f32_32x32x16_bf16 v[84:99], v[12:15], v[24:27], 0
    v_mfma_f32_32x32x16_bf16 v[100:115], v[12:15], v[28:31], 0
    s_mov_b32 s60, 4096
    buffer_load_dwordx4 v[20:23], v10, s[12:15], s60 offen
    buffer_load_dwordx4 v[24:27], v116, s[12:15], s60 offen
    buffer_load_dwordx4 v[28:31], v117, s[12:15], s60 offen
    s_waitcnt vmcnt(13)
    ds_read_b64_tr_b16 v[16:17], v9 offset:1024
    ds_read_b64_tr_b16 v[18:19], v9 offset:1280
    s_waitcnt lgkmcnt(0)
    v_mfma_f32_32x32x16_bf16 v[68:83], v[16:19], v[32:35], v[68:83]
    v_mfma_f32_32x32x16_bf16 v[84:99], v[16:19], v[36:39], v[84:99]
    v_mfma_f32_32x32x16_bf16 v[100:115], v[16:19], v[40:43], v[100:115]
    s_mov_b32 s60, 5120
    buffer_load_dwordx4 v[32:35], v10, s[12:15], s60 offen
    buffer_load_dwordx4 v[36:39], v116, s[12:15], s60 offen
    buffer_load_dwordx4 v[40:43], v117, s[12:15], s60 offen
    s_waitcnt vmcnt(13)
    ds_read_b64_tr_b16 v[12:13], v9 offset:2048
    ds_read_b64_tr_b16 v[14:15], v9 offset:2304
    s_waitcnt lgkmcnt(0)
    v_mfma_f32_32x32x16_bf16 v[68:83], v[12:15], v[44:47], v[68:83]
    v_mfma_f32_32x32x16_bf16 v[84:99], v[12:15], v[48:51], v[84:99]
    v_mfma_f32_32x32x16_bf16 v[100:115], v[12:15], v[52:55], v[100:115]
    s_mov_b32 s60, 6144
    buffer_load_dwordx4 v[44:47], v10, s[12:15], s60 offen
    buffer_load_dwordx4 v[48:51], v116, s[12:15], s60 offen
    buffer_load_dwordx4 v[52:55], v117, s[12:15], s60 offen
    s_waitcnt vmcnt(9)
    ds_read_b64_tr_b16 v[16:17], v9 offset:3072
    ds_read_b64_tr_b16 v[18:19], v9 offset:3328
    s_waitcnt lgkmcnt(0)
    v_mfma_f32_32x32x16_bf16 v[68:83], v[16:19], v[56:59], v[68:83]
    v_mfma_f32_32x32x16_bf16 v[84:99], v[16:19], v[60:63], v[84:99]
    v_mfma_f32_32x32x16_bf16 v[100:115], v[16:19], v[64:67], v[100:115]
    s_add_u32 s4, s53, 0
    s_mov_b32 m0, s4
    s_add_u32 s5, s52, 131072
    buffer_load_dwordx4 v8, s[8:11], s5 offen lds
    s_add_u32 s4, s53, 1024
    s_mov_b32 m0, s4
    s_add_u32 s5, s52, 147456
    buffer_load_dwordx4 v8, s[8:11], s5 offen lds
    s_add_u32 s4, s53, 2048
    s_mov_b32 m0, s4
    s_add_u32 s5, s52, 163840
    buffer_load_dwordx4 v8, s[8:11], s5 offen lds
    s_add_u32 s4, s53, 3072
    s_mov_b32 m0, s4
    s_add_u32 s5, s52, 180224
    buffer_load_dwordx4 v8, s[8:11], s5 offen lds
    s_mov_b32 s60, 7168
    buffer_load_dwordx4 v[56:59], v10, s[12:15], s60 offen
    buffer_load_dwordx4 v[60:63], v116, s[12:15], s60 offen
    buffer_load_dwordx4 v[64:67], v117, s[12:15], s60 offen
    s_waitcnt vmcnt(13)
    ds_read_b64_tr_b16 v[12:13], v9 offset:4096
    ds_read_b64_tr_b16 v[14:15], v9 offset:4352
    s_waitcnt lgkmcnt(0)
    v_mfma_f32_32x32x16_bf16 v[68:83], v[12:15], v[20:23], v[68:83]
    v_mfma_f32_32x32x16_bf16 v[84:99], v[12:15], v[24:27], v[84:99]
    v_mfma_f32_32x32x16_bf16 v[100:115], v[12:15], v[28:31], v[100:115]
    s_mov_b32 s60, 8192
    buffer_load_dwordx4 v[20:23], v10, s[12:15], s60 offen
    buffer_load_dwordx4 v[24:27], v116, s[12:15], s60 offen
    buffer_load_dwordx4 v[28:31], v117, s[12:15], s60 offen
    s_waitcnt vmcnt(13)
    ds_read_b64_tr_b16 v[16:17], v9 offset:5120
    ds_read_b64_tr_b16 v[18:19], v9 offset:5376
    s_waitcnt lgkmcnt(0)
    v_mfma_f32_32x32x16_bf16 v[68:83], v[16:19], v[32:35], v[68:83]
    v_mfma_f32_32x32x16_bf16 v[84:99], v[16:19], v[36:39], v[84:99]
    v_mfma_f32_32x32x16_bf16 v[100:115], v[16:19], v[40:43], v[100:115]
    s_mov_b32 s60, 9216
    buffer_load_dwordx4 v[32:35], v10, s[12:15], s60 offen
    buffer_load_dwordx4 v[36:39], v116, s[12:15], s60 offen
    buffer_load_dwordx4 v[40:43], v117, s[12:15], s60 offen
    s_waitcnt vmcnt(13)
    ds_read_b64_tr_b16 v[12:13], v9 offset:6144
    ds_read_b64_tr_b16 v[14:15], v9 offset:6400
    s_waitcnt lgkmcnt(0)
    v_mfma_f32_32x32x16_bf16 v[68:83], v[12:15], v[44:47], v[68:83]
    v_mfma_f32_32x32x16_bf16 v[84:99], v[12:15], v[48:51], v[84:99]
    v_mfma_f32_32x32x16_bf16 v[100:115], v[12:15], v[52:55], v[100:115]
    s_mov_b32 s60, 10240
    buffer_load_dwordx4 v[44:47], v10, s[12:15], s60 offen
    buffer_load_dwordx4 v[48:51], v116, s[12:15], s60 offen
    buffer_load_dwordx4 v[52:55], v117, s[12:15], s60 offen
    s_waitcnt vmcnt(9)
    ds_read_b64_tr_b16 v[16:17], v9 offset:7168
    ds_read_b64_tr_b16 v[18:19], v9 offset:7424
    s_waitcnt lgkmcnt(0)
    v_mfma_f32_32x32x16_bf16 v[68:83], v[16:19], v[56:59], v[68:83]
    v_mfma_f32_32x32x16_bf16 v[84:99], v[16:19], v[60:63], v[84:99]
    v_mfma_f32_32x32x16_bf16 v[100:115], v[16:19], v[64:67], v[100:115]
    s_add_u32 s4, s53, 4096
    s_mov_b32 m0, s4
    s_add_u32 s5, s52, 196608
    buffer_load_dwordx4 v8, s[8:11], s5 offen lds
    s_add_u32 s4, s53, 5120
    s_mov_b32 m0, s4
    s_add_u32 s5, s52, 212992
    buffer_load_dwordx4 v8, s[8:11], s5 offen lds
    s_add_u32 s4, s53, 6144
    s_mov_b32 m0, s4
    s_add_u32 s5, s52, 229376
    buffer_load_dwordx4 v8, s[8:11], s5 offen lds
    s_add_u32 s4, s53, 7168
    s_mov_b32 m0, s4
    s_add_u32 s5, s52, 245760
    buffer_load_dwordx4 v8, s[8:11], s5 offen lds
    s_mov_b32 s60, 11264
    buffer_load_dwordx4 v[56:59], v10, s[12:15], s60 offen
    buffer_load_dwordx4 v[60:63], v116, s[12:15], s60 offen
    buffer_load_dwordx4 v[64:67], v117, s[12:15], s60 offen
    s_waitcnt vmcnt(13)
    ds_read_b64_tr_b16 v[12:13], v9 offset:0
    ds_read_b64_tr_b16 v[14:15], v9 offset:256
    s_waitcnt lgkmcnt(0)
    v_mfma_f32_32x32x16_bf16 v[68:83], v[12:15], v[20:23], v[68:83]
    v_mfma_f32_32x32x16_bf16 v[84:99], v[12:15], v[24:27], v[84:99]
    v_mfma_f32_32x32x16_bf16 v[100:115], v[12:15], v[28:31], v[100:115]
    s_mov_b32 s60, 12288
    buffer_load_dwordx4 v[20:23], v10, s[12:15], s60 offen
    buffer_load_dwordx4 v[24:27], v116, s[12:15], s60 offen
    buffer_load_dwordx4 v[28:31], v117, s[12:15], s60 offen
    s_waitcnt vmcnt(13)
    ds_read_b64_tr_b16 v[16:17], v9 offset:1024
    ds_read_b64_tr_b16 v[18:19], v9 offset:1280
    s_waitcnt lgkmcnt(0)
    v_mfma_f32_32x32x16_bf16 v[68:83], v[16:19], v[32:35], v[68:83]
    v_mfma_f32_32x32x16_bf16 v[84:99], v[16:19], v[36:39], v[84:99]
    v_mfma_f32_32x32x16_bf16 v[100:115], v[16:19], v[40:43], v[100:115]
    s_mov_b32 s60, 13312
    buffer_load_dwordx4 v[32:35], v10, s[12:15], s60 offen
    buffer_load_dwordx4 v[36:39], v116, s[12:15], s60 offen
    buffer_load_dwordx4 v[40:43], v117, s[12:15], s60 offen
    s_waitcnt vmcnt(13)
    ds_read_b64_tr_b16 v[12:13], v9 offset:2048
    ds_read_b64_tr_b16 v[14:15], v9 offset:2304
    s_waitcnt lgkmcnt(0)
    v_mfma_f32_32x32x16_bf16 v[68:83], v[12:15], v[44:47], v[68:83]
    v_mfma_f32_32x32x16_bf16 v[84:99], v[12:15], v[48:51], v[84:99]
    v_mfma_f32_32x32x16_bf16 v[100:115], v[12:15], v[52:55], v[100:115]
    s_mov_b32 s60, 14336
    buffer_load_dwordx4 v[44:47], v10, s[12:15], s60 offen
    buffer_load_dwordx4 v[48:51], v116, s[12:15], s60 offen
    buffer_load_dwordx4 v[52:55], v117, s[12:15], s60 offen
    s_waitcnt vmcnt(9)
    ds_read_b64_tr_b16 v[16:17], v9 offset:3072
    ds_read_b64_tr_b16 v[18:19], v9 offset:3328
    s_waitcnt lgkmcnt(0)
    v_mfma_f32_32x32x16_bf16 v[68:83], v[16:19], v[56:59], v[68:83]
    v_mfma_f32_32x32x16_bf16 v[84:99], v[16:19], v[60:63], v[84:99]
    v_mfma_f32_32x32x16_bf16 v[100:115], v[16:19], v[64:67], v[100:115]
    s_add_u32 s4, s53, 0
    s_mov_b32 m0, s4
    s_add_u32 s5, s52, 262144
    buffer_load_dwordx4 v8, s[8:11], s5 offen lds
    s_add_u32 s4, s53, 1024
    s_mov_b32 m0, s4
    s_add_u32 s5, s52, 278528
    buffer_load_dwordx4 v8, s[8:11], s5 offen lds
    s_add_u32 s4, s53, 2048
    s_mov_b32 m0, s4
    s_add_u32 s5, s52, 294912
    buffer_load_dwordx4 v8, s[8:11], s5 offen lds
    s_add_u32 s4, s53, 3072
    s_mov_b32 m0, s4
    s_add_u32 s5, s52, 311296
    buffer_load_dwordx4 v8, s[8:11], s5 offen lds
    s_mov_b32 s60, 15360
    buffer_load_dwordx4 v[56:59], v10, s[12:15], s60 offen
    buffer_load_dwordx4 v[60:63], v116, s[12:15], s60 offen
    buffer_load_dwordx4 v[64:67], v117, s[12:15], s60 offen
    s_waitcnt vmcnt(13)
    ds_read_b64_tr_b16 v[12:13], v9 offset:4096
    ds_read_b64_tr_b16 v[14:15], v9 offset:4352
    s_waitcnt lgkmcnt(0)
    v_mfma_f32_32x32x16_bf16 v[68:83], v[12:15], v[20:23], v[68:83]
    v_mfma_f32_32x32x16_bf16 v[84:99], v[12:15], v[24:27], v[84:99]
    v_mfma_f32_32x32x16_bf16 v[100:115], v[12:15], v[28:31], v[100:115]
    s_mov_b32 s60, 16384
    buffer_load_dwordx4 v[20:23], v10, s[12:15], s60 offen
    buffer_load_dwordx4 v[24:27], v116, s[12:15], s60 offen
    buffer_load_dwordx4 v[28:31], v117, s[12:15], s60 offen
    s_waitcnt vmcnt(13)
    ds_read_b64_tr_b16 v[16:17], v9 offset:5120
    ds_read_b64_tr_b16 v[18:19], v9 offset:5376
    s_waitcnt lgkmcnt(0)
    v_mfma_f32_32x32x16_bf16 v[68:83], v[16:19], v[32:35], v[68:83]
    v_mfma_f32_32x32x16_bf16 v[84:99], v[16:19], v[36:39], v[84:99]
    v_mfma_f32_32x32x16_bf16 v[100:115], v[16:19], v[40:43], v[100:115]
    s_mov_b32 s60, 17408
    buffer_load_dwordx4 v[32:35], v10, s[12:15], s60 offen
    buffer_load_dwordx4 v[36:39], v116, s[12:15], s60 offen
    buffer_load_dwordx4 v[40:43], v117, s[12:15], s60 offen
    s_waitcnt vmcnt(13)
    ds_read_b64_tr_b16 v[12:13], v9 offset:6144
    ds_read_b64_tr_b16 v[14:15], v9 offset:6400
    s_waitcnt lgkmcnt(0)
    v_mfma_f32_32x32x16_bf16 v[68:83], v[12:15], v[44:47], v[68:83]
    v_mfma_f32_32x32x16_bf16 v[84:99], v[12:15], v[48:51], v[84:99]
    v_mfma_f32_32x32x16_bf16 v[100:115], v[12:15], v[52:55], v[100:115]
    s_mov_b32 s60, 18432
    buffer_load_dwordx4 v[44:47], v10, s[12:15], s60 offen
    buffer_load_dwordx4 v[48:51], v116, s[12:15], s60 offen
    buffer_load_dwordx4 v[52:55], v117, s[12:15], s60 offen
    s_waitcnt vmcnt(9)
    ds_read_b64_tr_b16 v[16:17], v9 offset:7168
    ds_read_b64_tr_b16 v[18:19], v9 offset:7424
    s_waitcnt lgkmcnt(0)
    v_mfma_f32_32x32x16_bf16 v[68:83], v[16:19], v[56:59], v[68:83]
    v_mfma_f32_32x32x16_bf16 v[84:99], v[16:19], v[60:63], v[84:99]
    v_mfma_f32_32x32x16_bf16 v[100:115], v[16:19], v[64:67], v[100:115]
    s_add_u32 s4, s53, 4096
    s_mov_b32 m0, s4
    s_add_u32 s5, s52, 327680
    buffer_load_dwordx4 v8, s[8:11], s5 offen lds
    s_add_u32 s4, s53, 5120
    s_mov_b32 m0, s4
    s_add_u32 s5, s52, 344064
    buffer_load_dwordx4 v8, s[8:11], s5 offen lds
    s_add_u32 s4, s53, 6144
    s_mov_b32 m0, s4
    s_add_u32 s5, s52, 360448
    buffer_load_dwordx4 v8, s[8:11], s5 offen lds
    s_add_u32 s4, s53, 7168
    s_mov_b32 m0, s4
    s_add_u32 s5, s52, 376832
    buffer_load_dwordx4 v8, s[8:11], s5 offen lds
    s_mov_b32 s60, 19456
    buffer_load_dwordx4 v[56:59], v10, s[12:15], s60 offen
    buffer_load_dwordx4 v[60:63], v116, s[12:15], s60 offen
    buffer_load_dwordx4 v[64:67], v117, s[12:15], s60 offen
    s_waitcnt vmcnt(13)
    ds_read_b64_tr_b16 v[12:13], v9 offset:0
    ds_read_b64_tr_b16 v[14:15], v9 offset:256
    s_waitcnt lgkmcnt(0)
    v_mfma_f32_32x32x16_bf16 v[68:83], v[12:15], v[20:23], v[68:83]
    v_mfma_f32_32x32x16_bf16 v[84:99], v[12:15], v[24:27], v[84:99]
    v_mfma_f32_32x32x16_bf16 v[100:115], v[12:15], v[28:31], v[100:115]
    s_mov_b32 s60, 20480
    buffer_load_dwordx4 v[20:23], v10, s[12:15], s60 offen
    buffer_load_dwordx4 v[24:27], v116, s[12:15], s60 offen
    buffer_load_dwordx4 v[28:31], v117, s[12:15], s60 offen
    s_waitcnt vmcnt(13)
    ds_read_b64_tr_b16 v[16:17], v9 offset:1024
    ds_read_b64_tr_b16 v[18:19], v9 offset:1280
    s_waitcnt lgkmcnt(0)
    v_mfma_f32_32x32x16_bf16 v[68:83], v[16:19], v[32:35], v[68:83]
    v_mfma_f32_32x32x16_bf16 v[84:99], v[16:19], v[36:39], v[84:99]
    v_mfma_f32_32x32x16_bf16 v[100:115], v[16:19], v[40:43], v[100:115]
    s_mov_b32 s60, 21504
    buffer_load_dwordx4 v[32:35], v10, s[12:15], s60 offen
    buffer_load_dwordx4 v[36:39], v116, s[12:15], s60 offen
    buffer_load_dwordx4 v[40:43], v117, s[12:15], s60 offen
    s_waitcnt vmcnt(13)
    ds_read_b64_tr_b16 v[12:13], v9 offset:2048
    ds_read_b64_tr_b16 v[14:15], v9 offset:2304
    s_waitcnt lgkmcnt(0)
    v_mfma_f32_32x32x16_bf16 v[68:83], v[12:15], v[44:47], v[68:83]
    v_mfma_f32_32x32x16_bf16 v[84:99], v[12:15], v[48:51], v[84:99]
    v_mfma_f32_32x32x16_bf16 v[100:115], v[12:15], v[52:55], v[100:115]
    s_mov_b32 s60, 22528
    buffer_load_dwordx4 v[44:47], v10, s[12:15], s60 offen
    buffer_load_dwordx4 v[48:51], v116, s[12:15], s60 offen
    buffer_load_dwordx4 v[52:55], v117, s[12:15], s60 offen
    s_waitcnt vmcnt(9)
    ds_read_b64_tr_b16 v[16:17], v9 offset:3072
    ds_read_b64_tr_b16 v[18:19], v9 offset:3328
    s_waitcnt lgkmcnt(0)
    v_mfma_f32_32x32x16_bf16 v[68:83], v[16:19], v[56:59], v[68:83]
    v_mfma_f32_32x32x16_bf16 v[84:99], v[16:19], v[60:63], v[84:99]
    v_mfma_f32_32x32x16_bf16 v[100:115], v[16:19], v[64:67], v[100:115]
    s_add_u32 s4, s53, 0
    s_mov_b32 m0, s4
    s_add_u32 s5, s52, 393216
    buffer_load_dwordx4 v8, s[8:11], s5 offen lds
    s_add_u32 s4, s53, 1024
    s_mov_b32 m0, s4
    s_add_u32 s5, s52, 409600
    buffer_load_dwordx4 v8, s[8:11], s5 offen lds
    s_add_u32 s4, s53, 2048
    s_mov_b32 m0, s4
    s_add_u32 s5, s52, 425984
    buffer_load_dwordx4 v8, s[8:11], s5 offen lds
    s_add_u32 s4, s53, 3072
    s_mov_b32 m0, s4
    s_add_u32 s5, s52, 442368
    buffer_load_dwordx4 v8, s[8:11], s5 offen lds
    s_mov_b32 s60, 23552
    buffer_load_dwordx4 v[56:59], v10, s[12:15], s60 offen
    buffer_load_dwordx4 v[60:63], v116, s[12:15], s60 offen
    buffer_load_dwordx4 v[64:67], v117, s[12:15], s60 offen
    s_waitcnt vmcnt(13)
    ds_read_b64_tr_b16 v[12:13], v9 offset:4096
    ds_read_b64_tr_b16 v[14:15], v9 offset:4352
    s_waitcnt lgkmcnt(0)
    v_mfma_f32_32x32x16_bf16 v[68:83], v[12:15], v[20:23], v[68:83]
    v_mfma_f32_32x32x16_bf16 v[84:99], v[12:15], v[24:27], v[84:99]
    v_mfma_f32_32x32x16_bf16 v[100:115], v[12:15], v[28:31], v[100:115]
    s_mov_b32 s60, 24576
    buffer_load_dwordx4 v[20:23], v10, s[12:15], s60 offen
    buffer_load_dwordx4 v[24:27], v116, s[12:15], s60 offen
    buffer_load_dwordx4 v[28:31], v117, s[12:15], s60 offen
    s_waitcnt vmcnt(13)
    ds_read_b64_tr_b16 v[16:17], v9 offset:5120
    ds_read_b64_tr_b16 v[18:19], v9 offset:5376
    s_waitcnt lgkmcnt(0)
    v_mfma_f32_32x32x16_bf16 v[68:83], v[16:19], v[32:35], v[68:83]
    v_mfma_f32_32x32x16_bf16 v[84:99], v[16:19], v[36:39], v[84:99]
    v_mfma_f32_32x32x16_bf16 v[100:115], v[16:19], v[40:43], v[100:115]
    s_mov_b32 s60, 25600
    buffer_load_dwordx4 v[32:35], v10, s[12:15], s60 offen
    buffer_load_dwordx4 v[36:39], v116, s[12:15], s60 offen
    buffer_load_dwordx4 v[40:43], v117, s[12:15], s60 offen
    s_waitcnt vmcnt(13)
    ds_read_b64_tr_b16 v[12:13], v9 offset:6144
    ds_read_b64_tr_b16 v[14:15], v9 offset:6400
    s_waitcnt lgkmcnt(0)
    v_mfma_f32_32x32x16_bf16 v[68:83], v[12:15], v[44:47], v[68:83]
    v_mfma_f32_32x32x16_bf16 v[84:99], v[12:15], v[48:51], v[84:99]
    v_mfma_f32_32x32x16_bf16 v[100:115], v[12:15], v[52:55], v[100:115]
    s_mov_b32 s60, 26624
    buffer_load_dwordx4 v[44:47], v10, s[12:15], s60 offen
    buffer_load_dwordx4 v[48:51], v116, s[12:15], s60 offen
    buffer_load_dwordx4 v[52:55], v117, s[12:15], s60 offen
    s_waitcnt vmcnt(9)
    ds_read_b64_tr_b16 v[16:17], v9 offset:7168
    ds_read_b64_tr_b16 v[18:19], v9 offset:7424
    s_waitcnt lgkmcnt(0)
    v_mfma_f32_32x32x16_bf16 v[68:83], v[16:19], v[56:59], v[68:83]
    v_mfma_f32_32x32x16_bf16 v[84:99], v[16:19], v[60:63], v[84:99]
    v_mfma_f32_32x32x16_bf16 v[100:115], v[16:19], v[64:67], v[100:115]
    s_add_u32 s4, s53, 4096
    s_mov_b32 m0, s4
    s_add_u32 s5, s52, 458752
    buffer_load_dwordx4 v8, s[8:11], s5 offen lds
    s_add_u32 s4, s53, 5120
    s_mov_b32 m0, s4
    s_add_u32 s5, s52, 475136
    buffer_load_dwordx4 v8, s[8:11], s5 offen lds
    s_add_u32 s4, s53, 6144
    s_mov_b32 m0, s4
    s_add_u32 s5, s52, 491520
    buffer_load_dwordx4 v8, s[8:11], s5 offen lds
    s_add_u32 s4, s53, 7168
    s_mov_b32 m0, s4
    s_add_u32 s5, s52, 507904
    buffer_load_dwordx4 v8, s[8:11], s5 offen lds
    s_mov_b32 s60, 27648
    buffer_load_dwordx4 v[56:59], v10, s[12:15], s60 offen
    buffer_load_dwordx4 v[60:63], v116, s[12:15], s60 offen
    buffer_load_dwordx4 v[64:67], v117, s[12:15], s60 offen
    s_waitcnt vmcnt(13)
    ds_read_b64_tr_b16 v[12:13], v9 offset:0
    ds_read_b64_tr_b16 v[14:15], v9 offset:256
    s_waitcnt lgkmcnt(0)
    v_mfma_f32_32x32x16_bf16 v[68:83], v[12:15], v[20:23], v[68:83]
    v_mfma_f32_32x32x16_bf16 v[84:99], v[12:15], v[24:27], v[84:99]
    v_mfma_f32_32x32x16_bf16 v[100:115], v[12:15], v[28:31], v[100:115]
    s_mov_b32 s60, 28672
    buffer_load_dwordx4 v[20:23], v10, s[12:15], s60 offen
    buffer_load_dwordx4 v[24:27], v116, s[12:15], s60 offen
    buffer_load_dwordx4 v[28:31], v117, s[12:15], s60 offen
    s_waitcnt vmcnt(13)
    ds_read_b64_tr_b16 v[16:17], v9 offset:1024
    ds_read_b64_tr_b16 v[18:19], v9 offset:1280
    s_waitcnt lgkmcnt(0)
    v_mfma_f32_32x32x16_bf16 v[68:83], v[16:19], v[32:35], v[68:83]
    v_mfma_f32_32x32x16_bf16 v[84:99], v[16:19], v[36:39], v[84:99]
    v_mfma_f32_32x32x16_bf16 v[100:115], v[16:19], v[40:43], v[100:115]
    s_mov_b32 s60, 29696
    buffer_load_dwordx4 v[32:35], v10, s[12:15], s60 offen
    buffer_load_dwordx4 v[36:39], v116, s[12:15], s60 offen
    buffer_load_dwordx4 v[40:43], v117, s[12:15], s60 offen
    s_waitcnt vmcnt(13)
    ds_read_b64_tr_b16 v[12:13], v9 offset:2048
    ds_read_b64_tr_b16 v[14:15], v9 offset:2304
    s_waitcnt lgkmcnt(0)
    v_mfma_f32_32x32x16_bf16 v[68:83], v[12:15], v[44:47], v[68:83]
    v_mfma_f32_32x32x16_bf16 v[84:99], v[12:15], v[48:51], v[84:99]
    v_mfma_f32_32x32x16_bf16 v[100:115], v[12:15], v[52:55], v[100:115]
    s_mov_b32 s60, 30720
    buffer_load_dwordx4 v[44:47], v10, s[12:15], s60 offen
    buffer_load_dwordx4 v[48:51], v116, s[12:15], s60 offen
    buffer_load_dwordx4 v[52:55], v117, s[12:15], s60 offen
    s_waitcnt vmcnt(9)
    ds_read_b64_tr_b16 v[16:17], v9 offset:3072
    ds_read_b64_tr_b16 v[18:19], v9 offset:3328
    s_waitcnt lgkmcnt(0)
    v_mfma_f32_32x32x16_bf16 v[68:83], v[16:19], v[56:59], v[68:83]
    v_mfma_f32_32x32x16_bf16 v[84:99], v[16:19], v[60:63], v[84:99]
    v_mfma_f32_32x32x16_bf16 v[100:115], v[16:19], v[64:67], v[100:115]
    s_add_u32 s4, s53, 0
    s_mov_b32 m0, s4
    s_add_u32 s5, s52, 524288
    buffer_load_dwordx4 v8, s[8:11], s5 offen lds
    s_add_u32 s4, s53, 1024
    s_mov_b32 m0, s4
    s_add_u32 s5, s52, 540672
    buffer_load_dwordx4 v8, s[8:11], s5 offen lds
    s_add_u32 s4, s53, 2048
    s_mov_b32 m0, s4
    s_add_u32 s5, s52, 557056
    buffer_load_dwordx4 v8, s[8:11], s5 offen lds
    s_add_u32 s4, s53, 3072
    s_mov_b32 m0, s4
    s_add_u32 s5, s52, 573440
    buffer_load_dwordx4 v8, s[8:11], s5 offen lds
    s_mov_b32 s60, 31744
    buffer_load_dwordx4 v[56:59], v10, s[12:15], s60 offen
    buffer_load_dwordx4 v[60:63], v116, s[12:15], s60 offen
    buffer_load_dwordx4 v[64:67], v117, s[12:15], s60 offen
    s_waitcnt vmcnt(13)
    ds_read_b64_tr_b16 v[12:13], v9 offset:4096
    ds_read_b64_tr_b16 v[14:15], v9 offset:4352
    s_waitcnt lgkmcnt(0)
    v_mfma_f32_32x32x16_bf16 v[68:83], v[12:15], v[20:23], v[68:83]
    v_mfma_f32_32x32x16_bf16 v[84:99], v[12:15], v[24:27], v[84:99]
    v_mfma_f32_32x32x16_bf16 v[100:115], v[12:15], v[28:31], v[100:115]
    s_mov_b32 s60, 32768
    buffer_load_dwordx4 v[20:23], v10, s[12:15], s60 offen
    buffer_load_dwordx4 v[24:27], v116, s[12:15], s60 offen
    buffer_load_dwordx4 v[28:31], v117, s[12:15], s60 offen
    s_waitcnt vmcnt(13)
    ds_read_b64_tr_b16 v[16:17], v9 offset:5120
    ds_read_b64_tr_b16 v[18:19], v9 offset:5376
    s_waitcnt lgkmcnt(0)
    v_mfma_f32_32x32x16_bf16 v[68:83], v[16:19], v[32:35], v[68:83]
    v_mfma_f32_32x32x16_bf16 v[84:99], v[16:19], v[36:39], v[84:99]
    v_mfma_f32_32x32x16_bf16 v[100:115], v[16:19], v[40:43], v[100:115]
    s_mov_b32 s60, 33792
    buffer_load_dwordx4 v[32:35], v10, s[12:15], s60 offen
    buffer_load_dwordx4 v[36:39], v116, s[12:15], s60 offen
    buffer_load_dwordx4 v[40:43], v117, s[12:15], s60 offen
    s_waitcnt vmcnt(13)
    ds_read_b64_tr_b16 v[12:13], v9 offset:6144
    ds_read_b64_tr_b16 v[14:15], v9 offset:6400
    s_waitcnt lgkmcnt(0)
    v_mfma_f32_32x32x16_bf16 v[68:83], v[12:15], v[44:47], v[68:83]
    v_mfma_f32_32x32x16_bf16 v[84:99], v[12:15], v[48:51], v[84:99]
    v_mfma_f32_32x32x16_bf16 v[100:115], v[12:15], v[52:55], v[100:115]
    s_mov_b32 s60, 34816
    buffer_load_dwordx4 v[44:47], v10, s[12:15], s60 offen
    buffer_load_dwordx4 v[48:51], v116, s[12:15], s60 offen
    buffer_load_dwordx4 v[52:55], v117, s[12:15], s60 offen
    s_waitcnt vmcnt(9)
    ds_read_b64_tr_b16 v[16:17], v9 offset:7168
    ds_read_b64_tr_b16 v[18:19], v9 offset:7424
    s_waitcnt lgkmcnt(0)
    v_mfma_f32_32x32x16_bf16 v[68:83], v[16:19], v[56:59], v[68:83]
    v_mfma_f32_32x32x16_bf16 v[84:99], v[16:19], v[60:63], v[84:99]
    v_mfma_f32_32x32x16_bf16 v[100:115], v[16:19], v[64:67], v[100:115]
    s_add_u32 s4, s53, 4096
    s_mov_b32 m0, s4
    s_add_u32 s5, s52, 589824
    buffer_load_dwordx4 v8, s[8:11], s5 offen lds
    s_add_u32 s4, s53, 5120
    s_mov_b32 m0, s4
    s_add_u32 s5, s52, 606208
    buffer_load_dwordx4 v8, s[8:11], s5 offen lds
    s_add_u32 s4, s53, 6144
    s_mov_b32 m0, s4
    s_add_u32 s5, s52, 622592
    buffer_load_dwordx4 v8, s[8:11], s5 offen lds
    s_add_u32 s4, s53, 7168
    s_mov_b32 m0, s4
    s_add_u32 s5, s52, 638976
    buffer_load_dwordx4 v8, s[8:11], s5 offen lds
    s_mov_b32 s60, 35840
    buffer_load_dwordx4 v[56:59], v10, s[12:15], s60 offen
    buffer_load_dwordx4 v[60:63], v116, s[12:15], s60 offen
    buffer_load_dwordx4 v[64:67], v117, s[12:15], s60 offen
    s_waitcnt vmcnt(13)
    ds_read_b64_tr_b16 v[12:13], v9 offset:0
    ds_read_b64_tr_b16 v[14:15], v9 offset:256
    s_waitcnt lgkmcnt(0)
    v_mfma_f32_32x32x16_bf16 v[68:83], v[12:15], v[20:23], v[68:83]
    v_mfma_f32_32x32x16_bf16 v[84:99], v[12:15], v[24:27], v[84:99]
    v_mfma_f32_32x32x16_bf16 v[100:115], v[12:15], v[28:31], v[100:115]
    s_mov_b32 s60, 36864
    buffer_load_dwordx4 v[20:23], v10, s[12:15], s60 offen
    buffer_load_dwordx4 v[24:27], v116, s[12:15], s60 offen
    buffer_load_dwordx4 v[28:31], v117, s[12:15], s60 offen
    s_waitcnt vmcnt(13)
    ds_read_b64_tr_b16 v[16:17], v9 offset:1024
    ds_read_b64_tr_b16 v[18:19], v9 offset:1280
    s_waitcnt lgkmcnt(0)
    v_mfma_f32_32x32x16_bf16 v[68:83], v[16:19], v[32:35], v[68:83]
    v_mfma_f32_32x32x16_bf16 v[84:99], v[16:19], v[36:39], v[84:99]
    v_mfma_f32_32x32x16_bf16 v[100:115], v[16:19], v[40:43], v[100:115]
    s_mov_b32 s60, 37888
    buffer_load_dwordx4 v[32:35], v10, s[12:15], s60 offen
    buffer_load_dwordx4 v[36:39], v116, s[12:15], s60 offen
    buffer_load_dwordx4 v[40:43], v117, s[12:15], s60 offen
    s_waitcnt vmcnt(13)
    ds_read_b64_tr_b16 v[12:13], v9 offset:2048
    ds_read_b64_tr_b16 v[14:15], v9 offset:2304
    s_waitcnt lgkmcnt(0)
    v_mfma_f32_32x32x16_bf16 v[68:83], v[12:15], v[44:47], v[68:83]
    v_mfma_f32_32x32x16_bf16 v[84:99], v[12:15], v[48:51], v[84:99]
    v_mfma_f32_32x32x16_bf16 v[100:115], v[12:15], v[52:55], v[100:115]
    s_mov_b32 s60, 38912
    buffer_load_dwordx4 v[44:47], v10, s[12:15], s60 offen
    buffer_load_dwordx4 v[48:51], v116, s[12:15], s60 offen
    buffer_load_dwordx4 v[52:55], v117, s[12:15], s60 offen
    s_waitcnt vmcnt(9)
    ds_read_b64_tr_b16 v[16:17], v9 offset:3072
    ds_read_b64_tr_b16 v[18:19], v9 offset:3328
    s_waitcnt lgkmcnt(0)
    v_mfma_f32_32x32x16_bf16 v[68:83], v[16:19], v[56:59], v[68:83]
    v_mfma_f32_32x32x16_bf16 v[84:99], v[16:19], v[60:63], v[84:99]
    v_mfma_f32_32x32x16_bf16 v[100:115], v[16:19], v[64:67], v[100:115]
    s_add_u32 s4, s53, 0
    s_mov_b32 m0, s4
    s_add_u32 s5, s52, 655360
    buffer_load_dwordx4 v8, s[8:11], s5 offen lds
    s_add_u32 s4, s53, 1024
    s_mov_b32 m0, s4
    s_add_u32 s5, s52, 671744
    buffer_load_dwordx4 v8, s[8:11], s5 offen lds
    s_add_u32 s4, s53, 2048
    s_mov_b32 m0, s4
    s_add_u32 s5, s52, 688128
    buffer_load_dwordx4 v8, s[8:11], s5 offen lds
    s_add_u32 s4, s53, 3072
    s_mov_b32 m0, s4
    s_add_u32 s5, s52, 704512
    buffer_load_dwordx4 v8, s[8:11], s5 offen lds
    s_mov_b32 s60, 39936
    buffer_load_dwordx4 v[56:59], v10, s[12:15], s60 offen
    buffer_load_dwordx4 v[60:63], v116, s[12:15], s60 offen
    buffer_load_dwordx4 v[64:67], v117, s[12:15], s60 offen
    s_waitcnt vmcnt(13)
    ds_read_b64_tr_b16 v[12:13], v9 offset:4096
    ds_read_b64_tr_b16 v[14:15], v9 offset:4352
    s_waitcnt lgkmcnt(0)
    v_mfma_f32_32x32x16_bf16 v[68:83], v[12:15], v[20:23], v[68:83]
    v_mfma_f32_32x32x16_bf16 v[84:99], v[12:15], v[24:27], v[84:99]
    v_mfma_f32_32x32x16_bf16 v[100:115], v[12:15], v[28:31], v[100:115]
    s_mov_b32 s60, 40960
    buffer_load_dwordx4 v[20:23], v10, s[12:15], s60 offen
    buffer_load_dwordx4 v[24:27], v116, s[12:15], s60 offen
    buffer_load_dwordx4 v[28:31], v117, s[12:15], s60 offen
    s_waitcnt vmcnt(13)
    ds_read_b64_tr_b16 v[16:17], v9 offset:5120
    ds_read_b64_tr_b16 v[18:19], v9 offset:5376
    s_waitcnt lgkmcnt(0)
    v_mfma_f32_32x32x16_bf16 v[68:83], v[16:19], v[32:35], v[68:83]
    v_mfma_f32_32x32x16_bf16 v[84:99], v[16:19], v[36:39], v[84:99]
    v_mfma_f32_32x32x16_bf16 v[100:115], v[16:19], v[40:43], v[100:115]
    s_mov_b32 s60, 41984
    buffer_load_dwordx4 v[32:35], v10, s[12:15], s60 offen
    buffer_load_dwordx4 v[36:39], v116, s[12:15], s60 offen
    buffer_load_dwordx4 v[40:43], v117, s[12:15], s60 offen
    s_waitcnt vmcnt(13)
    ds_read_b64_tr_b16 v[12:13], v9 offset:6144
    ds_read_b64_tr_b16 v[14:15], v9 offset:6400
    s_waitcnt lgkmcnt(0)
    v_mfma_f32_32x32x16_bf16 v[68:83], v[12:15], v[44:47], v[68:83]
    v_mfma_f32_32x32x16_bf16 v[84:99], v[12:15], v[48:51], v[84:99]
    v_mfma_f32_32x32x16_bf16 v[100:115], v[12:15], v[52:55], v[100:115]
    s_mov_b32 s60, 43008
    buffer_load_dwordx4 v[44:47], v10, s[12:15], s60 offen
    buffer_load_dwordx4 v[48:51], v116, s[12:15], s60 offen
    buffer_load_dwordx4 v[52:55], v117, s[12:15], s60 offen
    s_waitcnt vmcnt(9)
    ds_read_b64_tr_b16 v[16:17], v9 offset:7168
    ds_read_b64_tr_b16 v[18:19], v9 offset:7424
    s_waitcnt lgkmcnt(0)
    v_mfma_f32_32x32x16_bf16 v[68:83], v[16:19], v[56:59], v[68:83]
    v_mfma_f32_32x32x16_bf16 v[84:99], v[16:19], v[60:63], v[84:99]
    v_mfma_f32_32x32x16_bf16 v[100:115], v[16:19], v[64:67], v[100:115]
    s_add_u32 s4, s53, 4096
    s_mov_b32 m0, s4
    s_add_u32 s5, s52, 720896
    buffer_load_dwordx4 v8, s[8:11], s5 offen lds
    s_add_u32 s4, s53, 5120
    s_mov_b32 m0, s4
    s_add_u32 s5, s52, 737280
    buffer_load_dwordx4 v8, s[8:11], s5 offen lds
    s_add_u32 s4, s53, 6144
    s_mov_b32 m0, s4
    s_add_u32 s5, s52, 753664
    buffer_load_dwordx4 v8, s[8:11], s5 offen lds
    s_add_u32 s4, s53, 7168
    s_mov_b32 m0, s4
    s_add_u32 s5, s52, 770048
    buffer_load_dwordx4 v8, s[8:11], s5 offen lds
    s_mov_b32 s60, 44032
    buffer_load_dwordx4 v[56:59], v10, s[12:15], s60 offen
    buffer_load_dwordx4 v[60:63], v116, s[12:15], s60 offen
    buffer_load_dwordx4 v[64:67], v117, s[12:15], s60 offen
    s_waitcnt vmcnt(13)
    ds_read_b64_tr_b16 v[12:13], v9 offset:0
    ds_read_b64_tr_b16 v[14:15], v9 offset:256
    s_waitcnt lgkmcnt(0)
    v_mfma_f32_32x32x16_bf16 v[68:83], v[12:15], v[20:23], v[68:83]
    v_mfma_f32_32x32x16_bf16 v[84:99], v[12:15], v[24:27], v[84:99]
    v_mfma_f32_32x32x16_bf16 v[100:115], v[12:15], v[28:31], v[100:115]
    s_mov_b32 s60, 45056
    buffer_load_dwordx4 v[20:23], v10, s[12:15], s60 offen
    buffer_load_dwordx4 v[24:27], v116, s[12:15], s60 offen
    buffer_load_dwordx4 v[28:31], v117, s[12:15], s60 offen
    s_waitcnt vmcnt(13)
    ds_read_b64_tr_b16 v[16:17], v9 offset:1024
    ds_read_b64_tr_b16 v[18:19], v9 offset:1280
    s_waitcnt lgkmcnt(0)
    v_mfma_f32_32x32x16_bf16 v[68:83], v[16:19], v[32:35], v[68:83]
    v_mfma_f32_32x32x16_bf16 v[84:99], v[16:19], v[36:39], v[84:99]
    v_mfma_f32_32x32x16_bf16 v[100:115], v[16:19], v[40:43], v[100:115]
    s_mov_b32 s60, 46080
    buffer_load_dwordx4 v[32:35], v10, s[12:15], s60 offen
    buffer_load_dwordx4 v[36:39], v116, s[12:15], s60 offen
    buffer_load_dwordx4 v[40:43], v117, s[12:15], s60 offen
    s_waitcnt vmcnt(13)
    ds_read_b64_tr_b16 v[12:13], v9 offset:2048
    ds_read_b64_tr_b16 v[14:15], v9 offset:2304
    s_waitcnt lgkmcnt(0)
    v_mfma_f32_32x32x16_bf16 v[68:83], v[12:15], v[44:47], v[68:83]
    v_mfma_f32_32x32x16_bf16 v[84:99], v[12:15], v[48:51], v[84:99]
    v_mfma_f32_32x32x16_bf16 v[100:115], v[12:15], v[52:55], v[100:115]
    s_mov_b32 s60, 47104
    buffer_load_dwordx4 v[44:47], v10, s[12:15], s60 offen
    buffer_load_dwordx4 v[48:51], v116, s[12:15], s60 offen
    buffer_load_dwordx4 v[52:55], v117, s[12:15], s60 offen
    s_waitcnt vmcnt(9)
    ds_read_b64_tr_b16 v[16:17], v9 offset:3072
    ds_read_b64_tr_b16 v[18:19], v9 offset:3328
    s_waitcnt lgkmcnt(0)
    v_mfma_f32_32x32x16_bf16 v[68:83], v[16:19], v[56:59], v[68:83]
    v_mfma_f32_32x32x16_bf16 v[84:99], v[16:19], v[60:63], v[84:99]
    v_mfma_f32_32x32x16_bf16 v[100:115], v[16:19], v[64:67], v[100:115]
    s_add_u32 s4, s53, 0
    s_mov_b32 m0, s4
    s_add_u32 s5, s52, 786432
    buffer_load_dwordx4 v8, s[8:11], s5 offen lds
    s_add_u32 s4, s53, 1024
    s_mov_b32 m0, s4
    s_add_u32 s5, s52, 802816
    buffer_load_dwordx4 v8, s[8:11], s5 offen lds
    s_add_u32 s4, s53, 2048
    s_mov_b32 m0, s4
    s_add_u32 s5, s52, 819200
    buffer_load_dwordx4 v8, s[8:11], s5 offen lds
    s_add_u32 s4, s53, 3072
    s_mov_b32 m0, s4
    s_add_u32 s5, s52, 835584
    buffer_load_dwordx4 v8, s[8:11], s5 offen lds
    s_mov_b32 s60, 48128
    buffer_load_dwordx4 v[56:59], v10, s[12:15], s60 offen
    buffer_load_dwordx4 v[60:63], v116, s[12:15], s60 offen
    buffer_load_dwordx4 v[64:67], v117, s[12:15], s60 offen
    s_waitcnt vmcnt(13)
    ds_read_b64_tr_b16 v[12:13], v9 offset:4096
    ds_read_b64_tr_b16 v[14:15], v9 offset:4352
    s_waitcnt lgkmcnt(0)
    v_mfma_f32_32x32x16_bf16 v[68:83], v[12:15], v[20:23], v[68:83]
    v_mfma_f32_32x32x16_bf16 v[84:99], v[12:15], v[24:27], v[84:99]
    v_mfma_f32_32x32x16_bf16 v[100:115], v[12:15], v[28:31], v[100:115]
    s_mov_b32 s60, 49152
    buffer_load_dwordx4 v[20:23], v10, s[12:15], s60 offen
    buffer_load_dwordx4 v[24:27], v116, s[12:15], s60 offen
    buffer_load_dwordx4 v[28:31], v117, s[12:15], s60 offen
    s_waitcnt vmcnt(13)
    ds_read_b64_tr_b16 v[16:17], v9 offset:5120
    ds_read_b64_tr_b16 v[18:19], v9 offset:5376
    s_waitcnt lgkmcnt(0)
    v_mfma_f32_32x32x16_bf16 v[68:83], v[16:19], v[32:35], v[68:83]
    v_mfma_f32_32x32x16_bf16 v[84:99], v[16:19], v[36:39], v[84:99]
    v_mfma_f32_32x32x16_bf16 v[100:115], v[16:19], v[40:43], v[100:115]
    s_mov_b32 s60, 50176
    buffer_load_dwordx4 v[32:35], v10, s[12:15], s60 offen
    buffer_load_dwordx4 v[36:39], v116, s[12:15], s60 offen
    buffer_load_dwordx4 v[40:43], v117, s[12:15], s60 offen
    s_waitcnt vmcnt(13)
    ds_read_b64_tr_b16 v[12:13], v9 offset:6144
    ds_read_b64_tr_b16 v[14:15], v9 offset:6400
    s_waitcnt lgkmcnt(0)
    v_mfma_f32_32x32x16_bf16 v[68:83], v[12:15], v[44:47], v[68:83]
    v_mfma_f32_32x32x16_bf16 v[84:99], v[12:15], v[48:51], v[84:99]
    v_mfma_f32_32x32x16_bf16 v[100:115], v[12:15], v[52:55], v[100:115]
    s_mov_b32 s60, 51200
    buffer_load_dwordx4 v[44:47], v10, s[12:15], s60 offen
    buffer_load_dwordx4 v[48:51], v116, s[12:15], s60 offen
    buffer_load_dwordx4 v[52:55], v117, s[12:15], s60 offen
    s_waitcnt vmcnt(9)
    ds_read_b64_tr_b16 v[16:17], v9 offset:7168
    ds_read_b64_tr_b16 v[18:19], v9 offset:7424
    s_waitcnt lgkmcnt(0)
    v_mfma_f32_32x32x16_bf16 v[68:83], v[16:19], v[56:59], v[68:83]
    v_mfma_f32_32x32x16_bf16 v[84:99], v[16:19], v[60:63], v[84:99]
    v_mfma_f32_32x32x16_bf16 v[100:115], v[16:19], v[64:67], v[100:115]
    s_add_u32 s4, s53, 4096
    s_mov_b32 m0, s4
    s_add_u32 s5, s52, 851968
    buffer_load_dwordx4 v8, s[8:11], s5 offen lds
    s_add_u32 s4, s53, 5120
    s_mov_b32 m0, s4
    s_add_u32 s5, s52, 868352
    buffer_load_dwordx4 v8, s[8:11], s5 offen lds
    s_add_u32 s4, s53, 6144
    s_mov_b32 m0, s4
    s_add_u32 s5, s52, 884736
    buffer_load_dwordx4 v8, s[8:11], s5 offen lds
    s_add_u32 s4, s53, 7168
    s_mov_b32 m0, s4
    s_add_u32 s5, s52, 901120
    buffer_load_dwordx4 v8, s[8:11], s5 offen lds
    s_mov_b32 s60, 52224
    buffer_load_dwordx4 v[56:59], v10, s[12:15], s60 offen
    buffer_load_dwordx4 v[60:63], v116, s[12:15], s60 offen
    buffer_load_dwordx4 v[64:67], v117, s[12:15], s60 offen
    s_waitcnt vmcnt(13)
    ds_read_b64_tr_b16 v[12:13], v9 offset:0
    ds_read_b64_tr_b16 v[14:15], v9 offset:256
    s_waitcnt lgkmcnt(0)
    v_mfma_f32_32x32x16_bf16 v[68:83], v[12:15], v[20:23], v[68:83]
    v_mfma_f32_32x32x16_bf16 v[84:99], v[12:15], v[24:27], v[84:99]
    v_mfma_f32_32x32x16_bf16 v[100:115], v[12:15], v[28:31], v[100:115]
    s_mov_b32 s60, 53248
    buffer_load_dwordx4 v[20:23], v10, s[12:15], s60 offen
    buffer_load_dwordx4 v[24:27], v116, s[12:15], s60 offen
    buffer_load_dwordx4 v[28:31], v117, s[12:15], s60 offen
    s_waitcnt vmcnt(13)
    ds_read_b64_tr_b16 v[16:17], v9 offset:1024
    ds_read_b64_tr_b16 v[18:19], v9 offset:1280
    s_waitcnt lgkmcnt(0)
    v_mfma_f32_32x32x16_bf16 v[68:83], v[16:19], v[32:35], v[68:83]
    v_mfma_f32_32x32x16_bf16 v[84:99], v[16:19], v[36:39], v[84:99]
    v_mfma_f32_32x32x16_bf16 v[100:115], v[16:19], v[40:43], v[100:115]
    s_mov_b32 s60, 54272
    buffer_load_dwordx4 v[32:35], v10, s[12:15], s60 offen
    buffer_load_dwordx4 v[36:39], v116, s[12:15], s60 offen
    buffer_load_dwordx4 v[40:43], v117, s[12:15], s60 offen
    s_waitcnt vmcnt(13)
    ds_read_b64_tr_b16 v[12:13], v9 offset:2048
    ds_read_b64_tr_b16 v[14:15], v9 offset:2304
    s_waitcnt lgkmcnt(0)
    v_mfma_f32_32x32x16_bf16 v[68:83], v[12:15], v[44:47], v[68:83]
    v_mfma_f32_32x32x16_bf16 v[84:99], v[12:15], v[48:51], v[84:99]
    v_mfma_f32_32x32x16_bf16 v[100:115], v[12:15], v[52:55], v[100:115]
    s_mov_b32 s60, 55296
    buffer_load_dwordx4 v[44:47], v10, s[12:15], s60 offen
    buffer_load_dwordx4 v[48:51], v116, s[12:15], s60 offen
    buffer_load_dwordx4 v[52:55], v117, s[12:15], s60 offen
    s_waitcnt vmcnt(9)
    ds_read_b64_tr_b16 v[16:17], v9 offset:3072
    ds_read_b64_tr_b16 v[18:19], v9 offset:3328
    s_waitcnt lgkmcnt(0)
    v_mfma_f32_32x32x16_bf16 v[68:83], v[16:19], v[56:59], v[68:83]
    v_mfma_f32_32x32x16_bf16 v[84:99], v[16:19], v[60:63], v[84:99]
    v_mfma_f32_32x32x16_bf16 v[100:115], v[16:19], v[64:67], v[100:115]
    s_add_u32 s4, s53, 0
    s_mov_b32 m0, s4
    s_add_u32 s5, s52, 917504
    buffer_load_dwordx4 v8, s[8:11], s5 offen lds
    s_add_u32 s4, s53, 1024
    s_mov_b32 m0, s4
    s_add_u32 s5, s52, 933888
    buffer_load_dwordx4 v8, s[8:11], s5 offen lds
    s_add_u32 s4, s53, 2048
    s_mov_b32 m0, s4
    s_add_u32 s5, s52, 950272
    buffer_load_dwordx4 v8, s[8:11], s5 offen lds
    s_add_u32 s4, s53, 3072
    s_mov_b32 m0, s4
    s_add_u32 s5, s52, 966656
    buffer_load_dwordx4 v8, s[8:11], s5 offen lds
    s_mov_b32 s60, 56320
    buffer_load_dwordx4 v[56:59], v10, s[12:15], s60 offen
    buffer_load_dwordx4 v[60:63], v116, s[12:15], s60 offen
    buffer_load_dwordx4 v[64:67], v117, s[12:15], s60 offen
    s_waitcnt vmcnt(13)
    ds_read_b64_tr_b16 v[12:13], v9 offset:4096
    ds_read_b64_tr_b16 v[14:15], v9 offset:4352
    s_waitcnt lgkmcnt(0)
    v_mfma_f32_32x32x16_bf16 v[68:83], v[12:15], v[20:23], v[68:83]
    v_mfma_f32_32x32x16_bf16 v[84:99], v[12:15], v[24:27], v[84:99]
    v_mfma_f32_32x32x16_bf16 v[100:115], v[12:15], v[28:31], v[100:115]
    s_mov_b32 s60, 57344
    buffer_load_dwordx4 v[20:23], v10, s[12:15], s60 offen
    buffer_load_dwordx4 v[24:27], v116, s[12:15], s60 offen
    buffer_load_dwordx4 v[28:31], v117, s[12:15], s60 offen
    s_waitcnt vmcnt(13)
    ds_read_b64_tr_b16 v[16:17], v9 offset:5120
    ds_read_b64_tr_b16 v[18:19], v9 offset:5376
    s_waitcnt lgkmcnt(0)
    v_mfma_f32_32x32x16_bf16 v[68:83], v[16:19], v[32:35], v[68:83]
    v_mfma_f32_32x32x16_bf16 v[84:99], v[16:19], v[36:39], v[84:99]
    v_mfma_f32_32x32x16_bf16 v[100:115], v[16:19], v[40:43], v[100:115]
    s_mov_b32 s60, 58368
    buffer_load_dwordx4 v[32:35], v10, s[12:15], s60 offen
    buffer_load_dwordx4 v[36:39], v116, s[12:15], s60 offen
    buffer_load_dwordx4 v[40:43], v117, s[12:15], s60 offen
    s_waitcnt vmcnt(13)
    ds_read_b64_tr_b16 v[12:13], v9 offset:6144
    ds_read_b64_tr_b16 v[14:15], v9 offset:6400
    s_waitcnt lgkmcnt(0)
    v_mfma_f32_32x32x16_bf16 v[68:83], v[12:15], v[44:47], v[68:83]
    v_mfma_f32_32x32x16_bf16 v[84:99], v[12:15], v[48:51], v[84:99]
    v_mfma_f32_32x32x16_bf16 v[100:115], v[12:15], v[52:55], v[100:115]
    s_mov_b32 s60, 59392
    buffer_load_dwordx4 v[44:47], v10, s[12:15], s60 offen
    buffer_load_dwordx4 v[48:51], v116, s[12:15], s60 offen
    buffer_load_dwordx4 v[52:55], v117, s[12:15], s60 offen
    s_waitcnt vmcnt(9)
    ds_read_b64_tr_b16 v[16:17], v9 offset:7168
    ds_read_b64_tr_b16 v[18:19], v9 offset:7424
    s_waitcnt lgkmcnt(0)
    v_mfma_f32_32x32x16_bf16 v[68:83], v[16:19], v[56:59], v[68:83]
    v_mfma_f32_32x32x16_bf16 v[84:99], v[16:19], v[60:63], v[84:99]
    v_mfma_f32_32x32x16_bf16 v[100:115], v[16:19], v[64:67], v[100:115]
    s_add_u32 s4, s53, 4096
    s_mov_b32 m0, s4
    s_add_u32 s5, s52, 983040
    buffer_load_dwordx4 v8, s[8:11], s5 offen lds
    s_add_u32 s4, s53, 5120
    s_mov_b32 m0, s4
    s_add_u32 s5, s52, 999424
    buffer_load_dwordx4 v8, s[8:11], s5 offen lds
    s_add_u32 s4, s53, 6144
    s_mov_b32 m0, s4
    s_add_u32 s5, s52, 1015808
    buffer_load_dwordx4 v8, s[8:11], s5 offen lds
    s_add_u32 s4, s53, 7168
    s_mov_b32 m0, s4
    s_add_u32 s5, s52, 1032192
    buffer_load_dwordx4 v8, s[8:11], s5 offen lds
    s_mov_b32 s60, 60416
    buffer_load_dwordx4 v[56:59], v10, s[12:15], s60 offen
    buffer_load_dwordx4 v[60:63], v116, s[12:15], s60 offen
    buffer_load_dwordx4 v[64:67], v117, s[12:15], s60 offen
    s_waitcnt vmcnt(13)
    ds_read_b64_tr_b16 v[12:13], v9 offset:0
    ds_read_b64_tr_b16 v[14:15], v9 offset:256
    s_waitcnt lgkmcnt(0)
    v_mfma_f32_32x32x16_bf16 v[68:83], v[12:15], v[20:23], v[68:83]
    v_mfma_f32_32x32x16_bf16 v[84:99], v[12:15], v[24:27], v[84:99]
    v_mfma_f32_32x32x16_bf16 v[100:115], v[12:15], v[28:31], v[100:115]
    s_mov_b32 s60, 61440
    buffer_load_dwordx4 v[20:23], v10, s[12:15], s60 offen
    buffer_load_dwordx4 v[24:27], v116, s[12:15], s60 offen
    buffer_load_dwordx4 v[28:31], v117, s[12:15], s60 offen
    s_waitcnt vmcnt(13)
    ds_read_b64_tr_b16 v[16:17], v9 offset:1024
    ds_read_b64_tr_b16 v[18:19], v9 offset:1280
    s_waitcnt lgkmcnt(0)
    v_mfma_f32_32x32x16_bf16 v[68:83], v[16:19], v[32:35], v[68:83]
    v_mfma_f32_32x32x16_bf16 v[84:99], v[16:19], v[36:39], v[84:99]
    v_mfma_f32_32x32x16_bf16 v[100:115], v[16:19], v[40:43], v[100:115]
    s_mov_b32 s60, 62464
    buffer_load_dwordx4 v[32:35], v10, s[12:15], s60 offen
    buffer_load_dwordx4 v[36:39], v116, s[12:15], s60 offen
    buffer_load_dwordx4 v[40:43], v117, s[12:15], s60 offen
    s_waitcnt vmcnt(13)
    ds_read_b64_tr_b16 v[12:13], v9 offset:2048
    ds_read_b64_tr_b16 v[14:15], v9 offset:2304
    s_waitcnt lgkmcnt(0)
    v_mfma_f32_32x32x16_bf16 v[68:83], v[12:15], v[44:47], v[68:83]
    v_mfma_f32_32x32x16_bf16 v[84:99], v[12:15], v[48:51], v[84:99]
    v_mfma_f32_32x32x16_bf16 v[100:115], v[12:15], v[52:55], v[100:115]
    s_mov_b32 s60, 63488
    buffer_load_dwordx4 v[44:47], v10, s[12:15], s60 offen
    buffer_load_dwordx4 v[48:51], v116, s[12:15], s60 offen
    buffer_load_dwordx4 v[52:55], v117, s[12:15], s60 offen
    s_waitcnt vmcnt(9)
    ds_read_b64_tr_b16 v[16:17], v9 offset:3072
    ds_read_b64_tr_b16 v[18:19], v9 offset:3328
    s_waitcnt lgkmcnt(0)
    v_mfma_f32_32x32x16_bf16 v[68:83], v[16:19], v[56:59], v[68:83]
    v_mfma_f32_32x32x16_bf16 v[84:99], v[16:19], v[60:63], v[84:99]
    v_mfma_f32_32x32x16_bf16 v[100:115], v[16:19], v[64:67], v[100:115]
    s_mov_b32 s60, 64512
    buffer_load_dwordx4 v[56:59], v10, s[12:15], s60 offen
    buffer_load_dwordx4 v[60:63], v116, s[12:15], s60 offen
    buffer_load_dwordx4 v[64:67], v117, s[12:15], s60 offen
    s_waitcnt vmcnt(9)
    ds_read_b64_tr_b16 v[12:13], v9 offset:4096
    ds_read_b64_tr_b16 v[14:15], v9 offset:4352
    s_waitcnt lgkmcnt(0)
    v_mfma_f32_32x32x16_bf16 v[68:83], v[12:15], v[20:23], v[68:83]
    v_mfma_f32_32x32x16_bf16 v[84:99], v[12:15], v[24:27], v[84:99]
    v_mfma_f32_32x32x16_bf16 v[100:115], v[12:15], v[28:31], v[100:115]
    s_waitcnt vmcnt(6)
    ds_read_b64_tr_b16 v[16:17], v9 offset:5120
    ds_read_b64_tr_b16 v[18:19], v9 offset:5376
    s_waitcnt lgkmcnt(0)
    v_mfma_f32_32x32x16_bf16 v[68:83], v[16:19], v[32:35], v[68:83]
    v_mfma_f32_32x32x16_bf16 v[84:99], v[16:19], v[36:39], v[84:99]
    v_mfma_f32_32x32x16_bf16 v[100:115], v[16:19], v[40:43], v[100:115]
    s_waitcnt vmcnt(3)
    ds_read_b64_tr_b16 v[12:13], v9 offset:6144
    ds_read_b64_tr_b16 v[14:15], v9 offset:6400
    s_waitcnt lgkmcnt(0)
    v_mfma_f32_32x32x16_bf16 v[68:83], v[12:15], v[44:47], v[68:83]
    v_mfma_f32_32x32x16_bf16 v[84:99], v[12:15], v[48:51], v[84:99]
    v_mfma_f32_32x32x16_bf16 v[100:115], v[12:15], v[52:55], v[100:115]
    s_waitcnt vmcnt(0)
    ds_read_b64_tr_b16 v[16:17], v9 offset:7168
    ds_read_b64_tr_b16 v[18:19], v9 offset:7424
    s_waitcnt lgkmcnt(0)
    v_mfma_f32_32x32x16_bf16 v[68:83], v[16:19], v[56:59], v[68:83]
    v_mfma_f32_32x32x16_bf16 v[84:99], v[16:19], v[60:63], v[84:99]
    v_mfma_f32_32x32x16_bf16 v[100:115], v[16:19], v[64:67], v[100:115]
    s_waitcnt lgkmcnt(0)
    s_barrier
    s_mul_i32 s4, s3, 12288
    v_lshlrev_b32 v6, 2, v1
    v_add_u32 v6, s4, v6
    s_nop 4
    ds_write_b32 v6, v68 offset:0
    ds_write_b32 v6, v69 offset:256
    ds_write_b32 v6, v70 offset:512
    ds_write_b32 v6, v71 offset:768
    ds_write_b32 v6, v72 offset:1024
    ds_write_b32 v6, v73 offset:1280
    ds_write_b32 v6, v74 offset:1536
    ds_write_b32 v6, v75 offset:1792
    ds_write_b32 v6, v76 offset:2048
    ds_write_b32 v6, v77 offset:2304
    ds_write_b32 v6, v78 offset:2560
    ds_write_b32 v6, v79 offset:2816
    ds_write_b32 v6, v80 offset:3072
    ds_write_b32 v6, v81 offset:3328
    ds_write_b32 v6, v82 offset:3584
    ds_write_b32 v6, v83 offset:3840
    ds_write_b32 v6, v84 offset:4096
    ds_write_b32 v6, v85 offset:4352
    ds_write_b32 v6, v86 offset:4608
    ds_write_b32 v6, v87 offset:4864
    ds_write_b32 v6, v88 offset:5120
    ds_write_b32 v6, v89 offset:5376
    ds_write_b32 v6, v90 offset:5632
    ds_write_b32 v6, v91 offset:5888
    ds_write_b32 v6, v92 offset:6144
    ds_write_b32 v6, v93 offset:6400
    ds_write_b32 v6, v94 offset:6656
    ds_write_b32 v6, v95 offset:6912
    ds_write_b32 v6, v96 offset:7168
    ds_write_b32 v6, v97 offset:7424
    ds_write_b32 v6, v98 offset:7680
    ds_write_b32 v6, v99 offset:7936
    ds_write_b32 v6, v100 offset:8192
    ds_write_b32 v6, v101 offset:8448
    ds_write_b32 v6, v102 offset:8704
    ds_write_b32 v6, v103 offset:8960
    ds_write_b32 v6, v104 offset:9216
    ds_write_b32 v6, v105 offset:9472
    ds_write_b32 v6, v106 offset:9728
    ds_write_b32 v6, v107 offset:9984
    ds_write_b32 v6, v108 offset:10240
    ds_write_b32 v6, v109 offset:10496
    ds_write_b32 v6, v110 offset:10752
    ds_write_b32 v6, v111 offset:11008
    ds_write_b32 v6, v112 offset:11264
    ds_write_b32 v6, v113 offset:11520
    ds_write_b32 v6, v114 offset:11776
    ds_write_b32 v6, v115 offset:12032
    s_waitcnt lgkmcnt(0)
    s_barrier
    s_lshl_b32 s4, s3, 10
    v_lshlrev_b32 v6, 2, v1
    v_add_u32 v6, s4, v6
    ds_read_b32 v20, v6 offset:0
    ds_read_b32 v21, v6 offset:256
    ds_read_b32 v22, v6 offset:512
    ds_read_b32 v23, v6 offset:768
    ds_read_b32 v24, v6 offset:12288
    ds_read_b32 v25, v6 offset:12544
    ds_read_b32 v26, v6 offset:12800
    ds_read_b32 v27, v6 offset:13056
    ds_read_b32 v28, v6 offset:24576
    ds_read_b32 v29, v6 offset:24832
    ds_read_b32 v30, v6 offset:25088
    ds_read_b32 v31, v6 offset:25344
    ds_read_b32 v32, v6 offset:36864
    ds_read_b32 v33, v6 offset:37120
    ds_read_b32 v34, v6 offset:37376
    ds_read_b32 v35, v6 offset:37632
    ds_read_b32 v36, v6 offset:4096
    ds_read_b32 v37, v6 offset:4352
    ds_read_b32 v38, v6 offset:4608
    ds_read_b32 v39, v6 offset:4864
    ds_read_b32 v40, v6 offset:16384
    ds_read_b32 v41, v6 offset:16640
    ds_read_b32 v42, v6 offset:16896
    ds_read_b32 v43, v6 offset:17152
    ds_read_b32 v44, v6 offset:28672
    ds_read_b32 v45, v6 offset:28928
    ds_read_b32 v46, v6 offset:29184
    ds_read_b32 v47, v6 offset:29440
    ds_read_b32 v48, v6 offset:40960
    ds_read_b32 v49, v6 offset:41216
    ds_read_b32 v50, v6 offset:41472
    ds_read_b32 v51, v6 offset:41728
    ds_read_b32 v52, v6 offset:8192
    ds_read_b32 v53, v6 offset:8448
    ds_read_b32 v54, v6 offset:8704
    ds_read_b32 v55, v6 offset:8960
    ds_read_b32 v56, v6 offset:20480
    ds_read_b32 v57, v6 offset:20736
    ds_read_b32 v58, v6 offset:20992
    ds_read_b32 v59, v6 offset:21248
    ds_read_b32 v60, v6 offset:32768
    ds_read_b32 v61, v6 offset:33024
    ds_read_b32 v62, v6 offset:33280
    ds_read_b32 v63, v6 offset:33536
    ds_read_b32 v64, v6 offset:45056
    ds_read_b32 v65, v6 offset:45312
    ds_read_b32 v66, v6 offset:45568
    ds_read_b32 v67, v6 offset:45824
    s_mul_i32 s4, s28, 80
    v_add_u32 v7, s4, v5
    v_lshlrev_b32 v7, 10, v7
    s_lshl_b32 s4, s29, 6
    s_lshl_b32 s5, s3, 4
    s_add_u32 s4, s4, s5
    v_add_u32 v7, s4, v7
    v_lshl_add_u32 v7, v4, 3, v7
    s_waitcnt lgkmcnt(15)
    v_add_f32 v20, v20, v24
    v_add_f32 v28, v28, v32
    v_add_f32 v20, v20, v28
    v_add_f32 v21, v21, v25
    v_add_f32 v29, v29, v33
    v_add_f32 v21, v21, v29
    v_add_f32 v22, v22, v26
    v_add_f32 v30, v30, v34
    v_add_f32 v22, v22, v30
    v_add_f32 v23, v23, v27
    v_add_f32 v31, v31, v35
    v_add_f32 v23, v23, v31
    v_cvt_pk_bf16_f32 v20, v20, v21
    v_cvt_pk_bf16_f32 v21, v22, v23
    buffer_store_dwordx2 v[20:21], v7, s[16:19], 0 offen offset:0
    v_add_f32 v36, v36, v40
    v_add_f32 v44, v44, v48
    v_add_f32 v36, v36, v44
    v_add_f32 v37, v37, v41
    v_add_f32 v45, v45, v49
    v_add_f32 v37, v37, v45
    v_add_f32 v38, v38, v42
    v_add_f32 v46, v46, v50
    v_add_f32 v38, v38, v46
    v_add_f32 v39, v39, v43
    v_add_f32 v47, v47, v51
    v_add_f32 v39, v39, v47
    v_cvt_pk_bf16_f32 v36, v36, v37
    v_cvt_pk_bf16_f32 v37, v38, v39
    v_add_u32 v6, 32768, v7
    buffer_store_dwordx2 v[36:37], v6, s[16:19], 0 offen
    v_cmp_gt_u32 vcc, 16, v5
    s_nop 0
    s_and_saveexec_b64 s[58:59], vcc
    s_waitcnt lgkmcnt(11)
    v_add_f32 v52, v52, v56
    s_waitcnt lgkmcnt(3)
    v_add_f32 v60, v60, v64
    v_add_f32 v52, v52, v60
    v_add_f32 v53, v53, v57
    s_waitcnt lgkmcnt(2)
    v_add_f32 v61, v61, v65
    v_add_f32 v53, v53, v61
    v_add_f32 v54, v54, v58
    s_waitcnt lgkmcnt(1)
    v_add_f32 v62, v62, v66
    v_add_f32 v54, v54, v62
    v_add_f32 v55, v55, v59
    s_waitcnt lgkmcnt(0)
    v_add_f32 v63, v63, v67
    v_add_f32 v55, v55, v63
    v_cvt_pk_bf16_f32 v52, v52, v53
    v_cvt_pk_bf16_f32 v53, v54, v55
    v_add_u32 v6, 65536, v7
    buffer_store_dwordx2 v[52:53], v6, s[16:19], 0 offen
    s_mov_b64 exec, s[58:59]
B_end:
    s_endpgm
.section .rodata,"a"
.p2align 6
.amdhsa_kernel gqa_attn_kernel
  .amdhsa_next_free_vgpr 231
  .amdhsa_next_free_sgpr 102
  .amdhsa_accum_offset 232
  .amdhsa_group_segment_fixed_size 0
  .amdhsa_kernarg_size 64
  .amdhsa_user_sgpr_count 2
  .amdhsa_user_sgpr_kernarg_segment_ptr 1
  .amdhsa_system_sgpr_workgroup_id_x 1
.end_amdhsa_kernel
.p2align 6
.amdhsa_kernel gqa_oproj_kernel
  .amdhsa_next_free_vgpr 118
  .amdhsa_next_free_sgpr 102
  .amdhsa_accum_offset 120
  .amdhsa_group_segment_fixed_size 0
  .amdhsa_kernarg_size 64
  .amdhsa_user_sgpr_count 2
  .amdhsa_user_sgpr_kernarg_segment_ptr 1
  .amdhsa_system_sgpr_workgroup_id_x 1
.end_amdhsa_kernel
```
